```python
import torch

def _softmax(x, axis=-1):
    return torch.softmax(x, dim=axis)
def _gelu(x):
    return torch.nn.functional.gelu(x, approximate="tanh")
def _silu(x):
    return torch.nn.functional.silu(x)
def _sigmoid(x):
    return torch.sigmoid(x)
def _layernorm(x, axis=-1, eps=1e-5):
    m = x.mean(dim=axis, keepdim=True)
    v = x.var(dim=axis, keepdim=True, unbiased=False)
    return (x - m) / torch.sqrt(v + eps)
def _scatter_add(tgt, idx, src, axis=0):
    return tgt.clone().index_add_(axis, idx, src)
def _segment_sum(src, seg, n):
    out = torch.zeros((n,) + src.shape[1:], dtype=src.dtype)
    return out.index_add_(0, seg, src)
def _pad(x, pw):
    flat = tuple(v for pair in reversed(pw) for v in pair)
    return torch.nn.functional.pad(x, flat)

kernel_name = 'parallel_sum__sliding_local_dilated__dense_activation_relu__prompt'

def setup_inputs():

    _w = (lambda a: (lambda t: t.to(torch.bfloat16) if t.is_floating_point() else t)(torch.as_tensor(a)))
    def _A_setup():
        B, S, D = 1, 2048, 512
        return {
            "x": _w((lambda *s: torch.randn(*s, dtype=torch.bfloat16) * 0.05)(B, S, D)),
            "wqkv": _w((lambda *s: torch.randn(*s, dtype=torch.bfloat16) * 0.05)(D, 3 * D)),
            "wo": _w((lambda *s: torch.randn(*s, dtype=torch.bfloat16) * 0.05)(D, D)),
        }
    _A_in = _A_setup()

    def _B_setup():
        B, S, D, Dff = 1, 2048, 512, 1376
        return {
            "x": _w((lambda *s: torch.randn(*s, dtype=torch.bfloat16) * 0.05)(B, S, D)),
            "w1": _w((lambda *s: torch.randn(*s, dtype=torch.bfloat16) * 0.05)(D, Dff)),
            "w2": _w((lambda *s: torch.randn(*s, dtype=torch.bfloat16) * 0.05)(Dff, D)),
        }
    _B_in = _B_setup()

    return {
        "A_x": _A_in["x"],
        "A_wqkv": _A_in["wqkv"],
        "A_wo": _A_in["wo"],
        "B_x": _B_in["x"],
        "B_w1": _B_in["w1"],
        "B_w2": _B_in["w2"],
    }

def reference(A_x, A_wqkv, A_wo, B_x, B_w1, B_w2):
    def _A_ref(x, wqkv, wo):
        B, S, D = x.shape
        H = 32; Dh = D // H
        W, dil = 8, 2
        qkv = (lambda x, *d: x.permute(*d))((x @ wqkv).reshape(B, S, 3, H, Dh), 2, 0, 3, 1, 4)
        q, k, v = qkv[0], qkv[1], qkv[2]
        scale = Dh ** -0.5
        pos = torch.arange(S)
        off = torch.arange(W) * dil
        idx = pos[:, None] - off[None, :]
        mask = idx >= 0
        idx_c = torch.where(mask, idx, 0).reshape(-1)
        kg = k[:, :, idx_c, :].reshape(B, H, S, W, Dh)
        vg = v[:, :, idx_c, :].reshape(B, H, S, W, Dh)
        logits = torch.einsum("bhsd,bhswd->bhsw", q, kg) * scale
        logits = torch.where(mask[None, None, :, :], logits, -1e9)
        attn = _softmax(logits, axis=-1)
        o = torch.einsum("bhsw,bhswd->bhsd", attn, vg)
        return (lambda x, *d: x.permute(*d))(o, 0, 2, 1, 3).reshape(B, S, D) @ wo

    def _B_ref(x, w1, w2):
        h = torch.einsum("bsd,df->bsf", x, w1)
        zero = torch.zeros_like(h)
        h = torch.maximum(h, zero)
        return torch.einsum("bsf,fd->bsd", h, w2)

    x = A_x
    xn = _layernorm(x, axis=-1)
    return x + _A_ref(xn, A_wqkv, A_wo) + _B_ref(xn, B_w1, B_w2)
```

```asm
; @launch grid=(256,1,1) block=(256,1,1) lds=163840
.amdgcn_target "amdgcn-amd-amdhsa--gfx950"
.text
.globl parallel_sum__sliding_local_dilated__dense_activation_relu__prompt_kernel
.p2align 12
.p2align 8
.type parallel_sum__sliding_local_dilated__dense_activation_relu__prompt_kernel,@function
parallel_sum__sliding_local_dilated__dense_activation_relu__prompt_kernel:
  s_cmp_ge_u32 s2, 256
  s_cbranch_scc1 L_end
  s_mov_b32 s86, 0
  s_load_dwordx4 s[24:27], s[0:1], 0
  s_load_dwordx2 s[38:39], s[0:1], 64
  s_load_dwordx4 s[32:35], s[0:1], 32
  s_load_dwordx2 s[28:29], s[0:1], 16
  s_load_dwordx2 s[36:37], s[0:1], 48
  v_lshrrev_b32 v1, 6, v0
  v_and_b32 v209, 63, v0
  s_and_b32 s40, s2, 7
  v_readfirstlane_b32 s3, v1
  s_lshr_b32 s41, s2, 3
  v_lshlrev_b32 v208, 4, v209
  s_and_b32 s45, s3, 1
  s_lshr_b32 s46, s3, 1
  s_and_b32 s61, s40, 1
  s_lshl_b32 s59, s61, 4
  s_lshr_b32 s61, s40, 1
  s_lshl_b32 s61, s61, 2
  s_add_u32 s59, s59, s61
  s_lshr_b32 s61, s41, 3
  s_and_b32 s60, s41, 7
  s_lshr_b32 s96, s60, 0
  s_add_u32 s61, s61, s96
  s_and_b32 s61, s61, 3
  s_add_u32 s59, s59, s61
  s_and_b32 s61, s40, 1
  s_lshr_b32 s96, s40, 1
  s_cmp_lt_u32 s41, 18
  s_cbranch_scc0 L_ffn_decode
  s_cmp_ge_u32 s41, 9
  s_cselect_b32 s97, 9, 0
  s_cselect_b32 s98, 1, 0
  s_sub_u32 s42, s41, s97
  s_mul_i32 s61, s61, 9
  s_add_u32 s42, s42, s61
  s_lshl_b32 s43, s96, 1
  s_add_u32 s43, s43, s98
  s_mul_i32 s44, s42, 57
  s_mul_i32 s101, s40, 18
  s_add_u32 s101, s101, s41
  s_branch L_att
L_ffn_decode:
  s_sub_u32 s97, s41, 18
  s_xor_b32 s96, s96, 3
  s_mul_i32 s96, s96, 14
  s_add_u32 s97, s97, s96
  s_lshr_b32 s43, s97, 3
  s_and_b32 s97, s97, 7
  s_lshl_b32 s61, s61, 3
  s_add_u32 s42, s61, s97
  s_lshl_b32 s44, s42, 6
  s_mul_i32 s101, s42, 6
  s_add_u32 s101, s101, s43
  s_add_u32 s101, s101, 144
  s_cmp_eq_u32 s43, 6
  s_cbranch_scc1 L_wide
L_ffn:
  s_lshl_b32 s61, s44, 1
  s_add_u32 s61, s61, s46
  s_lshl_b32 s96, s45, 6
  s_add_u32 s61, s61, s96
  s_lshl_b32 s61, s61, 10
  v_lshrrev_b32 v1, 3, v209
  v_lshrrev_b32 v2, 4, v209
  v_and_b32 v3, 7, v209
  v_xor_b32 v3, v3, v2
  v_lshlrev_b32 v1, 11, v1
  v_add_u32 v1, s61, v1
  v_lshl_add_u32 v170, v3, 4, v1
  v_xor_b32 v3, 4, v3
  v_lshl_add_u32 v171, v3, 4, v1
  v_add_u32 v171, 0x4000, v171
  v_add_u32 v172, 0x8000, v170
  v_add_u32 v173, 0x8000, v171
  s_lshl_b32 s54, s3, 12
  s_mul_i32 s55, s3, 6144
  s_add_u32 s55, s55, 0x4000
  s_mul_i32 s96, s3, 44032
  s_mul_i32 s97, s43, 384
  s_add_u32 s96, s96, s97
  v_add_u32 v1, 0, v209
  v_mul_u32_u24 v2, 171, v1
  v_lshrrev_b32 v2, 12, v2
  v_mul_u32_u24 v3, 24, v2
  v_sub_u32 v1, v1, v3
  v_lshrrev_b32 v3, 2, v1
  v_bfe_u32 v4, v2, 1, 1
  v_xor_b32 v3, v3, v4
  v_and_b32 v1, 3, v1
  v_mul_u32_u24 v2, 2752, v2
  v_lshl_add_u32 v1, v1, 4, v2
  v_lshl_add_u32 v1, v3, 6, v1
  v_add_u32 v174, s96, v1
  v_add_u32 v1, 64, v209
  v_mul_u32_u24 v2, 171, v1
  v_lshrrev_b32 v2, 12, v2
  v_mul_u32_u24 v3, 24, v2
  v_sub_u32 v1, v1, v3
  v_lshrrev_b32 v3, 2, v1
  v_bfe_u32 v4, v2, 1, 1
  v_xor_b32 v3, v3, v4
  v_and_b32 v1, 3, v1
  v_mul_u32_u24 v2, 2752, v2
  v_lshl_add_u32 v1, v1, 4, v2
  v_lshl_add_u32 v1, v3, 6, v1
  v_add_u32 v175, s96, v1
  v_add_u32 v1, 128, v209
  v_mul_u32_u24 v2, 171, v1
  v_lshrrev_b32 v2, 12, v2
  v_mul_u32_u24 v3, 24, v2
  v_sub_u32 v1, v1, v3
  v_lshrrev_b32 v3, 2, v1
  v_bfe_u32 v4, v2, 1, 1
  v_xor_b32 v3, v3, v4
  v_and_b32 v1, 3, v1
  v_mul_u32_u24 v2, 2752, v2
  v_lshl_add_u32 v1, v1, 4, v2
  v_lshl_add_u32 v1, v3, 6, v1
  v_add_u32 v176, s96, v1
  s_waitcnt lgkmcnt(0)
  s_mov_b32 s4, s24
  s_and_b32 s5, s25, 0xffff
  s_mov_b32 s6, 2097152
  s_mov_b32 s7, 0x00020000
  s_mov_b32 s8, s32
  s_and_b32 s9, s33, 0xffff
  s_mov_b32 s10, 1409024
  s_mov_b32 s11, 0x00020000
  s_mov_b32 s12, s38
  s_and_b32 s13, s39, 0xffff
  s_mov_b32 s14, 0x10000000
  s_mov_b32 s15, 0x00020000
  s_mov_b32 s16, s36
  s_and_b32 s17, s37, 0xffff
  s_mov_b32 s18, 2097152
  s_mov_b32 s19, 0x00020000
  s_mov_b32 s51, 0
  s_mov_b32 s52, 0
  s_mov_b32 s53, 22016
  s_add_u32 m0, s54, 0
  s_nop 0
  buffer_load_dwordx4 v170, s[4:7], s51 offen lds
  s_and_b32 s61, s40, 1
  s_lshl_b32 s61, s61, 9
  s_lshr_b32 s96, s40, 1
  s_lshl_b32 s96, s96, 7
  s_add_u32 s61, s61, s96
  s_lshl_b32 s96, s41, 2
  s_add_u32 s61, s61, s96
  s_add_u32 s61, s61, s3
  s_lshl_b32 s90, s61, 11
  s_mul_i32 s61, s101, 2185
  s_add_u32 m0, s54, 1024
  s_nop 0
  buffer_load_dwordx4 v171, s[4:7], s51 offen lds
  s_lshr_b32 s61, s61, 16
  s_mul_i32 s96, s61, 30
  s_sub_u32 s96, s101, s96
  s_lshl_b32 s96, s96, 2
  s_add_u32 s96, s96, s3
  s_mul_i32 s97, s61, 240
  s_add_u32 s97, s97, s96
  s_lshl_b32 s97, s97, 10
  s_add_u32 s91, s97, 262144
  s_lshl_b32 s61, s61, 7
  s_add_u32 m0, s54, 2048
  s_nop 0
  buffer_load_dwordx4 v172, s[4:7], s51 offen lds
  v_and_b32 v1, 7, v209
  v_lshlrev_b32 v1, 4, v1
  v_add_u32 v1, s61, v1
  v_lshrrev_b32 v2, 3, v209
  v_lshl_add_u32 v16, v2, 10, v1
  v_and_b32 v3, 3, v2
  v_lshrrev_b32 v2, 2, v2
  v_lshl_add_u32 v3, v2, 3, v3
  v_lshl_add_u32 v17, v3, 10, v1
  s_mov_b32 s99, s96
  s_add_u32 m0, s54, 3072
  s_nop 0
  buffer_load_dwordx4 v173, s[4:7], s51 offen lds
  s_lshr_b32 s61, s40, 1
  s_sub_u32 s96, s41, 18
  s_cmp_lt_u32 s96, 6
  s_cbranch_scc1 L_csq_1
  s_xor_b32 s61, s61, 3
  s_cmp_lt_u32 s96, 12
  s_cbranch_scc1 L_csf_2
  s_min_u32 s61, s61, 1
  s_lshl_b32 s61, s61, 1
  s_add_u32 s61, s61, s96
  s_add_u32 s61, s61, 30
  s_branch L_csd_3
L_csf_2:
  s_mul_i32 s61, s61, 6
  s_add_u32 s61, s61, s96
  s_add_u32 s61, s61, 18
  s_branch L_csd_3
L_csq_1:
  s_lshl_b32 s61, s61, 1
  s_and_b32 s97, s96, 1
  s_add_u32 s61, s61, s97
  s_lshr_b32 s97, s96, 1
  s_lshl_b32 s97, s97, 3
  s_add_u32 s61, s61, s97
L_csd_3:
  s_add_u32 m0, s55, 0
  s_nop 0
  buffer_load_dwordx4 v174, s[8:11], s52 offen lds
  s_and_b32 s96, s40, 1
  s_lshl_b32 s50, s61, 6
  s_mul_i32 s97, s96, 2944
  s_add_u32 s50, s50, s97
  s_lshl_b32 s97, s3, 4
  s_add_u32 s50, s50, s97
  s_lshl_b32 s50, s50, 4
  s_add_u32 s50, s50, 131072
  s_lshl_b32 s96, s96, 8
  s_lshl_b32 s97, s3, 6
  s_add_u32 m0, s55, 1024
  s_nop 0
  buffer_load_dwordx4 v175, s[8:11], s52 offen lds
  s_add_u32 s96, s96, s97
  v_lshrrev_b32 v1, 3, v209
  v_add_u32 v1, s96, v1
  v_bfe_u32 v2, v209, 4, 2
  v_lshlrev_b32 v2, 1, v2
  v_and_b32 v3, 7, v209
  v_xor_b32 v2, v2, v3
  v_lshlrev_b32 v2, 4, v2
  s_lshl_b32 s49, s3, 13
  s_add_u32 s49, s49, 122880
  s_add_u32 m0, s55, 2048
  s_nop 0
  buffer_load_dwordx4 v176, s[8:11], s52 offen lds
  s_cmp_ge_u32 s61, 24
  s_mov_b32 s97, 3072
  s_cselect_b32 s48, 2752, s97
  s_cselect_b32 s96, 24, 0
  s_sub_u32 s96, s61, s96
  s_lshl_b32 s96, s96, 7
  v_mul_u32_u24 v1, s48, v1
  v_add3_u32 v234, v1, v2, s96
  s_lshl_b32 s48, s48, 3
  s_mov_b32 s98, s61
  s_add_u32 m0, s55, 3072
  s_nop 0
  buffer_load_dwordx4 v174, s[8:11], s53 offen lds
  s_mov_b32 s23, 0x00020000
  s_cmp_lt_u32 s99, 32
  s_cbranch_scc1 L_b2o_4
  s_mov_b32 s20, s34
  s_and_b32 s21, s35, 0xffff
  s_mov_b32 s22, 1409024
  s_sub_u32 s99, s99, 32
  s_lshl_b32 s99, s99, 14
  s_add_u32 s100, s99, 4096
  v_mov_b32 v16, v17
  s_mov_b32 s37, 0x80008000
  s_branch L_b2s_5
L_b2o_4:
  s_mov_b32 s20, s28
  s_and_b32 s21, s29, 0xffff
  s_mov_b32 s22, 524288
  s_lshl_b32 s99, s99, 14
  s_add_u32 s100, s99, 8192
  s_mov_b32 s37, 0
L_b2s_5:
  s_add_u32 m0, s55, 4096
  s_nop 0
  buffer_load_dwordx4 v175, s[8:11], s53 offen lds
  s_mov_b32 s95, 0x00020000
  s_cmp_ge_u32 s98, 24
  s_cbranch_scc1 L_csw_6
  s_mov_b32 s92, s26
  s_and_b32 s93, s27, 0xffff
  s_mov_b32 s94, 1572864
  s_branch L_css_7
L_csw_6:
  s_mov_b32 s92, s32
  s_and_b32 s93, s33, 0xffff
  s_mov_b32 s94, 1409024
L_css_7:
  s_add_u32 m0, s55, 5120
  s_nop 0
  buffer_load_dwordx4 v176, s[8:11], s53 offen lds
  s_mov_b32 s47, 0
  v_and_b32 v1, 31, v209
  s_lshl_b32 s61, s45, 6
  v_add_u32 v1, s61, v1
  v_lshlrev_b32 v1, 7, v1
  v_bfe_u32 v2, v209, 1, 3
  v_lshrrev_b32 v3, 5, v209
  v_xor_b32 v2, v2, v3
  v_xor_b32 v4, 0, v2
  v_lshl_add_u32 v160, v4, 4, v1
  s_lshl_b32 m0, s3, 11
  s_add_u32 m0, m0, 155648
  s_nop 0
  buffer_load_dwordx4 v16, s[20:23], s99 offen lds
  s_add_u32 m0, m0, 1024
  s_nop 0
  buffer_load_dwordx4 v16, s[20:23], s100 offen lds
  v_mov_b32 v210, 0
  buffer_load_dword v210, v210, s[12:15], 0 offen sc1
  s_mov_b32 s51, 128
  s_mov_b32 s52, 176128
  s_mov_b32 s53, 198144
  s_add_u32 m0, s54, 40960
  s_nop 0
  buffer_load_dwordx4 v170, s[4:7], s51 offen lds
  v_xor_b32 v4, 2, v2
  v_lshl_add_u32 v161, v4, 4, v1
  v_xor_b32 v4, 4, v2
  v_lshl_add_u32 v162, v4, 4, v1
  v_xor_b32 v4, 6, v2
  v_lshl_add_u32 v163, v4, 4, v1
  v_bfe_u32 v1, v209, 2, 2
  v_lshrrev_b32 v2, 5, v209
  v_lshl_add_u32 v1, v2, 3, v1
  v_mul_u32_u24 v1, 384, v1
  s_add_u32 m0, s54, 41984
  s_nop 0
  buffer_load_dwordx4 v171, s[4:7], s51 offen lds
  v_bfe_u32 v2, v209, 4, 1
  v_lshl_add_u32 v1, v2, 5, v1
  v_and_b32 v2, 3, v209
  v_lshl_add_u32 v1, v2, 3, v1
  v_add_u32 v1, 0x4000, v1
  v_bfe_u32 v2, v209, 3, 1
  v_xor_b32 v2, s46, v2
  v_lshl_add_u32 v168, v2, 6, v1
  s_add_u32 m0, s54, 43008
  s_nop 0
  buffer_load_dwordx4 v172, s[4:7], s51 offen lds
  s_add_u32 m0, s54, 44032
  s_nop 0
  buffer_load_dwordx4 v173, s[4:7], s51 offen lds
  s_add_u32 m0, s55, 40960
  s_nop 0
  buffer_load_dwordx4 v174, s[8:11], s52 offen lds
  s_add_u32 m0, s55, 41984
  s_nop 0
  buffer_load_dwordx4 v175, s[8:11], s52 offen lds
  s_add_u32 m0, s55, 43008
  s_nop 0
  buffer_load_dwordx4 v176, s[8:11], s52 offen lds
  s_add_u32 m0, s55, 44032
  s_nop 0
  buffer_load_dwordx4 v174, s[8:11], s53 offen lds
  s_add_u32 m0, s55, 45056
  s_nop 0
  buffer_load_dwordx4 v175, s[8:11], s53 offen lds
  s_add_u32 m0, s55, 46080
  s_nop 0
  buffer_load_dwordx4 v176, s[8:11], s53 offen lds
  s_cmp_lg_u32 s3, 1
  s_cbranch_scc1 L_tskip_ffn_0
  s_mov_b32 s86, 1
  s_branch L_stub_ffn_0
L_tret_ffn_0:
  s_mov_b32 s86, 0
L_tskip_ffn_0:
  s_cmp_lg_u32 s3, 2
  s_cbranch_scc1 L_tskip_ffn_1
  s_mov_b32 s86, 1
  s_branch L_stub_ffn_1
L_tret_ffn_1:
  s_mov_b32 s86, 0
L_tskip_ffn_1:
  s_cmp_lg_u32 s3, 3
  s_cbranch_scc1 L_tskip_ffn_2
  s_mov_b32 s86, 1
  s_branch L_stub_ffn_2
L_tret_ffn_2:
  s_mov_b32 s86, 0
L_tskip_ffn_2:
  s_mov_b32 s51, 256
  s_mov_b32 s52, 352256
  s_mov_b32 s53, 374272
  s_add_u32 m0, s54, 81920
  s_nop 0
  buffer_load_dwordx4 v170, s[4:7], s51 offen lds
  s_add_u32 m0, s54, 82944
  s_nop 0
  buffer_load_dwordx4 v171, s[4:7], s51 offen lds
  s_add_u32 m0, s54, 83968
  s_nop 0
  buffer_load_dwordx4 v172, s[4:7], s51 offen lds
  s_add_u32 m0, s54, 84992
  s_nop 0
  buffer_load_dwordx4 v173, s[4:7], s51 offen lds
  s_add_u32 m0, s55, 81920
  s_nop 0
  buffer_load_dwordx4 v174, s[8:11], s52 offen lds
  s_add_u32 m0, s55, 82944
  s_nop 0
  buffer_load_dwordx4 v175, s[8:11], s52 offen lds
  s_add_u32 m0, s55, 83968
  s_nop 0
  buffer_load_dwordx4 v176, s[8:11], s52 offen lds
  v_lshrrev_b32 v1, 5, v209
  v_bfe_u32 v2, v209, 2, 2
  v_lshl_add_u32 v1, v1, 3, v2
  v_lshlrev_b32 v1, 7, v1
  v_and_b32 v2, 1, v209
  v_lshl_add_u32 v1, v2, 5, v1
  v_bfe_u32 v2, v209, 4, 1
  v_lshl_add_u32 v1, v2, 4, v1
  v_bfe_u32 v2, v209, 1, 1
  v_lshl_add_u32 v1, v2, 3, v1
  s_lshl_b32 s61, s3, 11
  s_add_u32 s61, s61, 155648
  v_add_u32 v1, s61, v1
  s_waitcnt vmcnt(18)
  ds_read_b64_tr_b16 v[20:21], v1 offset:0
  ds_read_b64_tr_b16 v[22:23], v1 offset:512
  ds_read_b64_tr_b16 v[24:25], v1 offset:64
  ds_read_b64_tr_b16 v[26:27], v1 offset:576
  s_waitcnt vmcnt(17)
  v_readfirstlane_b32 s56, v210
  s_nop 0
  s_mul_i32 s56, s56, 0x9E3779B1
  s_add_u32 s56, s56, 0x7F4A7C15
  s_not_b32 s57, s56
  s_and_b32 s61, s56, 63
  s_lshr_b32 s96, s56, 6
  s_and_b32 s96, s96, 62
  s_and_b32 s97, s56, 1
  s_or_b32 s96, s96, s97
  s_lshl_b32 s96, s96, 8
  s_or_b32 s61, s61, s96
  v_lshrrev_b32 v2, 5, v209
  v_lshlrev_b32 v2, 3, v2
  v_lshrrev_b32 v2, v2, s61
  v_lshlrev_b32 v3, 15, v2
  v_lshl_or_b32 v3, v2, 30, v3
  v_and_b32 v28, s37, v3
  v_lshrrev_b32 v2, 2, v2
  v_lshlrev_b32 v3, 15, v2
  v_lshl_or_b32 v3, v2, 30, v3
  v_and_b32 v30, s37, v3
  v_lshrrev_b32 v2, 2, v2
  v_lshlrev_b32 v3, 15, v2
  v_lshl_or_b32 v3, v2, 30, v3
  v_and_b32 v31, s37, v3
  v_xor_b32 v29, s37, v28
  s_add_u32 s61, s91, 122880
  s_waitcnt lgkmcnt(0)
  v_xor_b32 v20, v28, v20
  v_xor_b32 v21, v29, v21
  v_xor_b32 v22, v30, v22
  v_xor_b32 v23, v31, v23
  v_xor_b32 v24, v28, v24
  v_xor_b32 v25, v29, v25
  v_xor_b32 v26, v30, v26
  v_xor_b32 v27, v31, v27
  buffer_store_dwordx4 v[20:23], v208, s[12:15], s91 offen sc1
  buffer_store_dwordx4 v[24:27], v208, s[12:15], s61 offen sc1
  s_barrier
  ds_read_b128 v[112:115], v160
  ds_read_b64_tr_b16 v[128:129], v168 offset:0
  ds_read_b64_tr_b16 v[130:131], v168 offset:1536
  ds_read_b64_tr_b16 v[132:133], v168 offset:128
  ds_read_b64_tr_b16 v[134:135], v168 offset:1664
  ds_read_b64_tr_b16 v[136:137], v168 offset:256
  ds_read_b64_tr_b16 v[138:139], v168 offset:1792
  ds_read_b128 v[116:119], v160 offset:4096
  s_waitcnt lgkmcnt(5)
  v_mfma_f32_32x32x16_bf16 v[0:15], v[128:131], v[112:115], 0
  ds_read_b128 v[120:123], v161
  ds_read_b64_tr_b16 v[144:145], v168 offset:6144
  v_min_u32 v183, 29, v209
  s_mul_i32 s61, s60, 30
  s_add_u32 m0, s55, 84992
  s_waitcnt lgkmcnt(5)
  v_mfma_f32_32x32x16_bf16 v[32:47], v[132:135], v[112:115], 0
  buffer_load_dwordx4 v174, s[8:11], s53 offen lds
  ds_read_b64_tr_b16 v[146:147], v168 offset:7680
  ds_read_b64_tr_b16 v[148:149], v168 offset:6272
  v_add_u32 v183, s61, v183
  v_lshlrev_b32 v183, 3, v183
  s_waitcnt lgkmcnt(5)
  v_mfma_f32_32x32x16_bf16 v[64:79], v[136:139], v[112:115], 0
  ds_read_b64_tr_b16 v[150:151], v168 offset:7808
  ds_read_b64_tr_b16 v[152:153], v168 offset:6400
  v_add_u32 v215, 12288, v183
  v_and_b32 v182, 31, v209
  s_lshl_b32 s61, s45, 10
  s_waitcnt lgkmcnt(6)
  v_mfma_f32_32x32x16_bf16 v[16:31], v[128:131], v[116:119], 0
  ds_read_b64_tr_b16 v[154:155], v168 offset:7936
  ds_read_b128 v[124:127], v161 offset:4096
  s_add_u32 s96, s44, 0
  v_add_u32 v183, s96, v182
  s_add_u32 m0, s55, 86016
  v_mfma_f32_32x32x16_bf16 v[48:63], v[132:135], v[116:119], 0
  buffer_load_dwordx4 v175, s[8:11], s53 offen lds
  v_min_u32 v183, 0x3ff, v183
  v_add_u32 v183, s61, v183
  v_lshlrev_b32 v183, 4, v183
  v_add_u32 v211, 65536, v183
  v_mfma_f32_32x32x16_bf16 v[80:95], v[136:139], v[116:119], 0
  s_add_u32 s96, s44, 32
  v_add_u32 v183, s96, v182
  v_min_u32 v183, 0x3ff, v183
  v_add_u32 v183, s61, v183
  v_lshlrev_b32 v183, 4, v183
  s_waitcnt lgkmcnt(5)
  v_mfma_f32_32x32x16_bf16 v[0:15], v[144:147], v[120:123], v[0:15]
  ds_read_b128 v[112:115], v162
  ds_read_b64_tr_b16 v[128:129], v168 offset:12288
  v_add_u32 v160, 0xa000, v160
  v_add_u32 v161, 0xa000, v161
  s_add_u32 m0, s55, 87040
  s_waitcnt lgkmcnt(5)
  v_mfma_f32_32x32x16_bf16 v[32:47], v[148:151], v[120:123], v[32:47]
  buffer_load_dwordx4 v176, s[8:11], s53 offen lds
  ds_read_b64_tr_b16 v[130:131], v168 offset:13824
  ds_read_b64_tr_b16 v[132:133], v168 offset:12416
  v_add_u32 v212, 65536, v183
  v_lshrrev_b32 v183, 5, v209
  s_waitcnt lgkmcnt(5)
  v_mfma_f32_32x32x16_bf16 v[64:79], v[152:155], v[120:123], v[64:79]
  ds_read_b64_tr_b16 v[134:135], v168 offset:13952
  ds_read_b64_tr_b16 v[136:137], v168 offset:12544
  v_mul_u32_u24 v183, 2944, v183
  v_add_u32 v183, v183, v182
  s_mul_i32 s61, s43, 192
  s_waitcnt lgkmcnt(6)
  v_mfma_f32_32x32x16_bf16 v[16:31], v[144:147], v[124:127], v[16:31]
  buffer_load_dwordx4 v[190:193], v208, s[4:7], s90 offen
  ds_read_b64_tr_b16 v[138:139], v168 offset:14080
  ds_read_b128 v[116:119], v162 offset:4096
  s_lshl_b32 s96, s46, 5
  s_add_u32 s61, s61, s96
  v_mfma_f32_32x32x16_bf16 v[48:63], v[148:151], v[124:127], v[48:63]
  s_add_u32 s61, s61, 1536
  v_add_u32 v184, s61, v183
  v_lshlrev_b32 v184, 4, v184
  v_add_u32 v213, 131072, v184
  s_lshl_b32 s61, s60, 1
  v_mfma_f32_32x32x16_bf16 v[80:95], v[152:155], v[124:127], v[80:95]
  buffer_load_dwordx4 v[194:197], v208, s[4:7], s90 offen offset:1024
  s_add_u32 s61, s61, s46
  s_mul_i32 s97, s61, 122880
  s_xor_b32 s61, s61, 1
  s_mul_i32 s98, s61, 122880
  s_waitcnt lgkmcnt(5)
  v_mfma_f32_32x32x16_bf16 v[0:15], v[128:131], v[112:115], v[0:15]
  ds_read_b128 v[120:123], v163
  ds_read_b64_tr_b16 v[144:145], v168 offset:18432
  v_add_u32 v162, 0xa000, v162
  s_mul_i32 s96, s3, 18432
  s_add_u32 s96, s96, 294912
  s_waitcnt lgkmcnt(5)
  v_mfma_f32_32x32x16_bf16 v[32:47], v[132:135], v[112:115], v[32:47]
  ds_read_b64_tr_b16 v[146:147], v168 offset:19968
  ds_read_b64_tr_b16 v[148:149], v168 offset:18560
  s_add_u32 s88, s97, s96
  s_add_u32 s89, s98, s96
  s_mul_i32 s29, s3, -14336
  s_waitcnt lgkmcnt(5)
  v_mfma_f32_32x32x16_bf16 v[64:79], v[136:139], v[112:115], v[64:79]
  ds_read_b64_tr_b16 v[150:151], v168 offset:20096
  ds_read_b64_tr_b16 v[152:153], v168 offset:18688
  s_add_u32 s29, s29, 57344
  s_lshl_b32 s32, s3, 12
  s_sub_u32 s32, s32, 106496
  s_waitcnt lgkmcnt(6)
  v_mfma_f32_32x32x16_bf16 v[16:31], v[128:131], v[116:119], v[16:31]
  ds_read_b64_tr_b16 v[154:155], v168 offset:20224
  ds_read_b128 v[124:127], v163 offset:4096
  v_mfma_f32_32x32x16_bf16 v[48:63], v[132:135], v[116:119], v[48:63]
  v_mfma_f32_32x32x16_bf16 v[80:95], v[136:139], v[116:119], v[80:95]
  v_add_u32 v163, 0xa000, v163
  v_add_u32 v168, 0xa000, v168
  s_waitcnt vmcnt(5)
  s_waitcnt lgkmcnt(0)
  s_barrier
  s_cmp_eq_u32 s3, 0
  s_cbranch_scc0 L_nob2pub_8
  s_lshl_b32 s36, s101, 3
  s_add_u32 s36, s36, 12288
  v_mov_b32 v253, s36
  v_mov_b32 v252, 2147483392
  v_cmp_gt_u32 s[30:31], 1, v209
  s_nop 1
  v_cndmask_b32 v253, v252, v253, s[30:31]
  v_mov_b32 v254, s56
  v_mov_b32 v255, s57
  buffer_store_dwordx2 v[254:255], v253, s[12:15], 0 offen sc1
L_nob2pub_8:
L_stub_ffn_0:
  s_cmp_eq_u32 s86, 1
  s_cbranch_scc1 L_tret_ffn_0
  s_mov_b32 s51, 384
  s_mov_b32 s52, 528384
  s_mov_b32 s53, 550400
  v_mfma_f32_32x32x16_bf16 v[0:15], v[144:147], v[120:123], v[0:15]
  ds_read_b128 v[112:115], v160
  ds_read_b64_tr_b16 v[128:129], v168 offset:0
  s_add_u32 m0, s54, 0
  v_mfma_f32_32x32x16_bf16 v[32:47], v[148:151], v[120:123], v[32:47]
  buffer_load_dwordx4 v170, s[4:7], s51 offen lds
  ds_read_b64_tr_b16 v[130:131], v168 offset:1536
  ds_read_b64_tr_b16 v[132:133], v168 offset:128
  v_mfma_f32_32x32x16_bf16 v[64:79], v[152:155], v[120:123], v[64:79]
  ds_read_b64_tr_b16 v[134:135], v168 offset:1664
  ds_read_b64_tr_b16 v[136:137], v168 offset:256
  s_add_u32 m0, s54, 1024
  v_mfma_f32_32x32x16_bf16 v[16:31], v[144:147], v[124:127], v[16:31]
  buffer_load_dwordx4 v171, s[4:7], s51 offen lds
  ds_read_b64_tr_b16 v[138:139], v168 offset:1792
  ds_read_b128 v[116:119], v160 offset:4096
  v_mfma_f32_32x32x16_bf16 v[48:63], v[148:151], v[124:127], v[48:63]
  s_add_u32 m0, s54, 2048
  v_mfma_f32_32x32x16_bf16 v[80:95], v[152:155], v[124:127], v[80:95]
  buffer_load_dwordx4 v172, s[4:7], s51 offen lds
  s_waitcnt lgkmcnt(5)
  v_mfma_f32_32x32x16_bf16 v[0:15], v[128:131], v[112:115], v[0:15]
  ds_read_b128 v[120:123], v161
  ds_read_b64_tr_b16 v[144:145], v168 offset:6144
  s_add_u32 m0, s54, 3072
  s_waitcnt lgkmcnt(5)
  v_mfma_f32_32x32x16_bf16 v[32:47], v[132:135], v[112:115], v[32:47]
  buffer_load_dwordx4 v173, s[4:7], s51 offen lds
  ds_read_b64_tr_b16 v[146:147], v168 offset:7680
  ds_read_b64_tr_b16 v[148:149], v168 offset:6272
  s_add_u32 m0, s55, 0
  s_waitcnt lgkmcnt(5)
  v_mfma_f32_32x32x16_bf16 v[64:79], v[136:139], v[112:115], v[64:79]
  buffer_load_dwordx4 v174, s[8:11], s52 offen lds
  ds_read_b64_tr_b16 v[150:151], v168 offset:7808
  ds_read_b64_tr_b16 v[152:153], v168 offset:6400
  s_add_u32 m0, s49, 0
  s_waitcnt lgkmcnt(6)
  v_mfma_f32_32x32x16_bf16 v[16:31], v[128:131], v[116:119], v[16:31]
  buffer_load_dwordx4 v234, s[92:95], s47 offen lds
  ds_read_b64_tr_b16 v[154:155], v168 offset:7936
  ds_read_b128 v[124:127], v161 offset:4096
  s_add_u32 m0, s49, 1024
  s_add_u32 s47, s47, s48
  v_mfma_f32_32x32x16_bf16 v[48:63], v[132:135], v[116:119], v[48:63]
  buffer_load_dwordx4 v234, s[92:95], s47 offen lds
  s_add_u32 m0, s49, 2048
  s_add_u32 s47, s47, s48
  v_mfma_f32_32x32x16_bf16 v[80:95], v[136:139], v[116:119], v[80:95]
  buffer_load_dwordx4 v234, s[92:95], s47 offen lds
  s_waitcnt lgkmcnt(5)
  v_mfma_f32_32x32x16_bf16 v[0:15], v[144:147], v[120:123], v[0:15]
  ds_read_b128 v[112:115], v162
  ds_read_b64_tr_b16 v[128:129], v168 offset:12288
  v_add_u32 v160, 0xa000, v160
  v_add_u32 v161, 0xa000, v161
  s_add_u32 m0, s55, 1024
  s_waitcnt lgkmcnt(5)
  v_mfma_f32_32x32x16_bf16 v[32:47], v[148:151], v[120:123], v[32:47]
  buffer_load_dwordx4 v175, s[8:11], s52 offen lds
  ds_read_b64_tr_b16 v[130:131], v168 offset:13824
  ds_read_b64_tr_b16 v[132:133], v168 offset:12416
  s_add_u32 m0, s55, 2048
  s_waitcnt lgkmcnt(5)
  v_mfma_f32_32x32x16_bf16 v[64:79], v[152:155], v[120:123], v[64:79]
  buffer_load_dwordx4 v176, s[8:11], s52 offen lds
  ds_read_b64_tr_b16 v[134:135], v168 offset:13952
  ds_read_b64_tr_b16 v[136:137], v168 offset:12544
  s_add_u32 m0, s49, 3072
  s_add_u32 s47, s47, s48
  s_waitcnt lgkmcnt(6)
  v_mfma_f32_32x32x16_bf16 v[16:31], v[144:147], v[124:127], v[16:31]
  buffer_load_dwordx4 v234, s[92:95], s47 offen lds
  ds_read_b64_tr_b16 v[138:139], v168 offset:14080
  ds_read_b128 v[116:119], v162 offset:4096
  s_add_u32 m0, s49, 4096
  s_add_u32 s47, s47, s48
  v_mfma_f32_32x32x16_bf16 v[48:63], v[148:151], v[124:127], v[48:63]
  buffer_load_dwordx4 v234, s[92:95], s47 offen lds
  s_add_u32 m0, s49, 5120
  s_add_u32 s47, s47, s48
  v_mfma_f32_32x32x16_bf16 v[80:95], v[152:155], v[124:127], v[80:95]
  buffer_load_dwordx4 v234, s[92:95], s47 offen lds
  s_waitcnt lgkmcnt(5)
  v_mfma_f32_32x32x16_bf16 v[0:15], v[128:131], v[112:115], v[0:15]
  ds_read_b128 v[120:123], v163
  ds_read_b64_tr_b16 v[144:145], v168 offset:18432
  v_add_u32 v162, 0xa000, v162
  s_waitcnt vmcnt(13)
  s_add_u32 m0, s55, 3072
  s_waitcnt lgkmcnt(5)
  v_mfma_f32_32x32x16_bf16 v[32:47], v[132:135], v[112:115], v[32:47]
  buffer_load_dwordx4 v174, s[8:11], s53 offen lds
  ds_read_b64_tr_b16 v[146:147], v168 offset:19968
  ds_read_b64_tr_b16 v[148:149], v168 offset:18560
  v_mov_b32 v182, 0x3f803f80
  s_add_u32 m0, s55, 4096
  s_waitcnt lgkmcnt(5)
  v_mfma_f32_32x32x16_bf16 v[64:79], v[136:139], v[112:115], v[64:79]
  buffer_load_dwordx4 v175, s[8:11], s53 offen lds
  ds_read_b64_tr_b16 v[150:151], v168 offset:20096
  ds_read_b64_tr_b16 v[152:153], v168 offset:18688
  v_mov_b32 v198, 0
  s_add_u32 m0, s55, 5120
  s_waitcnt lgkmcnt(6)
  v_mfma_f32_32x32x16_bf16 v[16:31], v[128:131], v[116:119], v[16:31]
  buffer_load_dwordx4 v176, s[8:11], s53 offen lds
  ds_read_b64_tr_b16 v[154:155], v168 offset:20224
  ds_read_b128 v[124:127], v163 offset:4096
  s_add_u32 m0, s49, 6144
  s_add_u32 s47, s47, s48
  v_mfma_f32_32x32x16_bf16 v[48:63], v[132:135], v[116:119], v[48:63]
  buffer_load_dwordx4 v234, s[92:95], s47 offen lds
  v_mov_b32 v199, 0
  v_mov_b32 v200, 0
  s_add_u32 m0, s49, 7168
  s_add_u32 s47, s47, s48
  v_mfma_f32_32x32x16_bf16 v[80:95], v[136:139], v[116:119], v[80:95]
  buffer_load_dwordx4 v234, s[92:95], s47 offen lds
  v_mov_b32 v201, 0
  v_dot2c_f32_bf16 v198, v190, v182
  v_dot2c_f32_bf16 v199, v190, v190
  v_dot2c_f32_bf16 v200, v194, v182
  v_add_u32 v163, 0xa000, v163
  v_add_u32 v168, 0xa000, v168
  s_waitcnt lgkmcnt(0)
  s_barrier
  s_mov_b32 s51, 512
  s_mov_b32 s52, 704512
  s_mov_b32 s53, 726528
  v_mfma_f32_32x32x16_bf16 v[0:15], v[144:147], v[120:123], v[0:15]
  ds_read_b128 v[112:115], v160
  ds_read_b64_tr_b16 v[128:129], v168 offset:0
  v_dot2c_f32_bf16 v201, v194, v194
  v_dot2c_f32_bf16 v198, v191, v182
  s_add_u32 m0, s54, 40960
  v_mfma_f32_32x32x16_bf16 v[32:47], v[148:151], v[120:123], v[32:47]
  buffer_load_dwordx4 v170, s[4:7], s51 offen lds
  ds_read_b64_tr_b16 v[130:131], v168 offset:1536
  ds_read_b64_tr_b16 v[132:133], v168 offset:128
  v_dot2c_f32_bf16 v199, v191, v191
  v_dot2c_f32_bf16 v200, v195, v182
  v_mfma_f32_32x32x16_bf16 v[64:79], v[152:155], v[120:123], v[64:79]
  ds_read_b64_tr_b16 v[134:135], v168 offset:1664
  ds_read_b64_tr_b16 v[136:137], v168 offset:256
  v_dot2c_f32_bf16 v201, v195, v195
  v_dot2c_f32_bf16 v198, v192, v182
  s_add_u32 m0, s54, 41984
  v_mfma_f32_32x32x16_bf16 v[16:31], v[144:147], v[124:127], v[16:31]
  buffer_load_dwordx4 v171, s[4:7], s51 offen lds
  ds_read_b64_tr_b16 v[138:139], v168 offset:1792
  ds_read_b128 v[116:119], v160 offset:4096
  v_dot2c_f32_bf16 v199, v192, v192
  v_dot2c_f32_bf16 v200, v196, v182
  v_mfma_f32_32x32x16_bf16 v[48:63], v[148:151], v[124:127], v[48:63]
  v_dot2c_f32_bf16 v201, v196, v196
  v_dot2c_f32_bf16 v198, v193, v182
  v_dot2c_f32_bf16 v199, v193, v193
  v_dot2c_f32_bf16 v200, v197, v182
  s_add_u32 m0, s54, 43008
  v_mfma_f32_32x32x16_bf16 v[80:95], v[152:155], v[124:127], v[80:95]
  buffer_load_dwordx4 v172, s[4:7], s51 offen lds
  v_dot2c_f32_bf16 v201, v197, v197
  s_lshr_b32 s61, s90, 11
  v_lshrrev_b32 v202, 5, v209
  v_lshl_add_u32 v202, v202, 10, s61
  s_waitcnt lgkmcnt(5)
  v_mfma_f32_32x32x16_bf16 v[0:15], v[128:131], v[112:115], v[0:15]
  ds_read_b128 v[120:123], v161
  ds_read_b64_tr_b16 v[144:145], v168 offset:6144
  v_lshlrev_b32 v202, 4, v202
  v_permlane32_swap_b32 v198, v200
  s_add_u32 m0, s54, 44032
  s_waitcnt lgkmcnt(5)
  v_mfma_f32_32x32x16_bf16 v[32:47], v[132:135], v[112:115], v[32:47]
  buffer_load_dwordx4 v173, s[4:7], s51 offen lds
  ds_read_b64_tr_b16 v[146:147], v168 offset:7680
  ds_read_b64_tr_b16 v[148:149], v168 offset:6272
  v_permlane32_swap_b32 v199, v201
  v_add_u32 v202, 65536, v202
  s_waitcnt lgkmcnt(5)
  v_mfma_f32_32x32x16_bf16 v[64:79], v[136:139], v[112:115], v[64:79]
  ds_read_b64_tr_b16 v[150:151], v168 offset:7808
  ds_read_b64_tr_b16 v[152:153], v168 offset:6400
  v_and_b32 v203, 31, v209
  v_add_f32 v198, v198, v200
  v_add_f32 v199, v199, v201
  s_waitcnt lgkmcnt(6)
  v_mfma_f32_32x32x16_bf16 v[16:31], v[128:131], v[116:119], v[16:31]
  ds_read_b64_tr_b16 v[154:155], v168 offset:7936
  ds_read_b128 v[124:127], v161 offset:4096
  v_mov_b32 v186, 2147483392
  v_cmp_eq_u32 vcc, 0, v203
  s_add_u32 m0, s55, 40960
  v_mfma_f32_32x32x16_bf16 v[48:63], v[132:135], v[116:119], v[48:63]
  buffer_load_dwordx4 v174, s[8:11], s52 offen lds
  v_permlane16_swap_b32 v198, v199
  v_cndmask_b32 v202, v186, v202, vcc
  v_mov_b32 v185, s56
  v_add_f32 v198, v198, v199
  v_mfma_f32_32x32x16_bf16 v[80:95], v[136:139], v[116:119], v[80:95]
  s_nop 0
  v_add_f32_dpp v198, v198, v198 row_ror:8 row_mask:0xf bank_mask:0xf
  s_nop 1
  v_add_f32_dpp v198, v198, v198 row_ror:4 row_mask:0xf bank_mask:0xf
  s_nop 1
  v_add_f32_dpp v198, v198, v198 row_ror:2 row_mask:0xf bank_mask:0xf
  s_nop 1
  v_add_f32_dpp v198, v198, v198 row_ror:1 row_mask:0xf bank_mask:0xf
  v_mov_b32 v199, v198
  s_waitcnt lgkmcnt(5)
  v_mfma_f32_32x32x16_bf16 v[0:15], v[144:147], v[120:123], v[0:15]
  ds_read_b128 v[112:115], v162
  ds_read_b64_tr_b16 v[128:129], v168 offset:12288
  v_add_u32 v160, 0xfffec000, v160
  v_add_u32 v161, 0xfffec000, v161
  s_add_u32 m0, s55, 41984
  s_waitcnt lgkmcnt(5)
  v_mfma_f32_32x32x16_bf16 v[32:47], v[148:151], v[120:123], v[32:47]
  buffer_load_dwordx4 v175, s[8:11], s52 offen lds
  ds_read_b64_tr_b16 v[130:131], v168 offset:13824
  ds_read_b64_tr_b16 v[132:133], v168 offset:12416
  v_permlane16_swap_b32 v198, v199
  v_mul_f32 v198, 0xbb000000, v198
  s_waitcnt lgkmcnt(5)
  v_mfma_f32_32x32x16_bf16 v[64:79], v[152:155], v[120:123], v[64:79]
  ds_read_b64_tr_b16 v[134:135], v168 offset:13952
  ds_read_b64_tr_b16 v[136:137], v168 offset:12544
  v_mul_f32 v199, 0x3b000000, v199
  v_fma_f32 v199, -v198, v198, v199
  v_cvt_pk_bf16_f32 v182, v198, v198
  s_waitcnt lgkmcnt(6)
  v_mfma_f32_32x32x16_bf16 v[16:31], v[144:147], v[124:127], v[16:31]
  ds_read_b64_tr_b16 v[138:139], v168 offset:14080
  ds_read_b128 v[116:119], v162 offset:4096
  v_max_f32 v199, 0, v199
  v_and_b32 v203, 0xffff0000, v182
  s_add_u32 m0, s55, 43008
  v_mfma_f32_32x32x16_bf16 v[48:63], v[148:151], v[124:127], v[48:63]
  buffer_load_dwordx4 v176, s[8:11], s52 offen lds
  v_add_f32 v199, 0x3727c5ac, v199
  v_sub_f32 v203, v198, v203
  v_rsq_f32 v184, v199
  v_cvt_pk_bf16_f32 v183, v203, 0
  v_mfma_f32_32x32x16_bf16 v[80:95], v[152:155], v[124:127], v[80:95]
  buffer_store_dwordx4 v[182:185], v202, s[12:15], 0 offen sc1
  s_waitcnt lgkmcnt(5)
  v_mfma_f32_32x32x16_bf16 v[0:15], v[128:131], v[112:115], v[0:15]
  ds_read_b128 v[120:123], v163
  ds_read_b64_tr_b16 v[144:145], v168 offset:18432
  v_add_u32 v162, 0xfffec000, v162
  s_add_u32 m0, s55, 44032
  s_waitcnt lgkmcnt(5)
  v_mfma_f32_32x32x16_bf16 v[32:47], v[132:135], v[112:115], v[32:47]
  buffer_load_dwordx4 v174, s[8:11], s53 offen lds
  ds_read_b64_tr_b16 v[146:147], v168 offset:19968
  ds_read_b64_tr_b16 v[148:149], v168 offset:18560
  s_waitcnt lgkmcnt(5)
  v_mfma_f32_32x32x16_bf16 v[64:79], v[136:139], v[112:115], v[64:79]
  ds_read_b64_tr_b16 v[150:151], v168 offset:20096
  ds_read_b64_tr_b16 v[152:153], v168 offset:18688
  s_add_u32 m0, s55, 45056
  s_waitcnt lgkmcnt(6)
  v_mfma_f32_32x32x16_bf16 v[16:31], v[128:131], v[116:119], v[16:31]
  buffer_load_dwordx4 v175, s[8:11], s53 offen lds
  ds_read_b64_tr_b16 v[154:155], v168 offset:20224
  ds_read_b128 v[124:127], v163 offset:4096
  v_mfma_f32_32x32x16_bf16 v[48:63], v[132:135], v[116:119], v[48:63]
  s_add_u32 m0, s55, 46080
  v_mfma_f32_32x32x16_bf16 v[80:95], v[136:139], v[116:119], v[80:95]
  buffer_load_dwordx4 v176, s[8:11], s53 offen lds
  v_add_u32 v163, 0xfffec000, v163
  v_add_u32 v168, 0xfffec000, v168
  s_waitcnt vmcnt(11)
  s_waitcnt lgkmcnt(0)
  s_barrier
  s_mov_b32 s51, 640
  s_mov_b32 s52, 880640
  s_mov_b32 s53, 902656
  v_mfma_f32_32x32x16_bf16 v[0:15], v[144:147], v[120:123], v[0:15]
  ds_read_b128 v[112:115], v160
  ds_read_b64_tr_b16 v[128:129], v168 offset:0
  v_bfe_u32 v186, v209, 2, 2
  v_lshrrev_b32 v187, 4, v209
  s_add_u32 m0, s54, 81920
  v_mfma_f32_32x32x16_bf16 v[32:47], v[148:151], v[120:123], v[32:47]
  buffer_load_dwordx4 v170, s[4:7], s51 offen lds
  ds_read_b64_tr_b16 v[130:131], v168 offset:1536
  ds_read_b64_tr_b16 v[132:133], v168 offset:128
  v_lshl_add_u32 v186, v187, 2, v186
  s_add_u32 m0, s54, 82944
  v_mfma_f32_32x32x16_bf16 v[64:79], v[152:155], v[120:123], v[64:79]
  buffer_load_dwordx4 v171, s[4:7], s51 offen lds
  ds_read_b64_tr_b16 v[134:135], v168 offset:1664
  ds_read_b64_tr_b16 v[136:137], v168 offset:256
  v_bfe_u32 v187, v186, 1, 2
  v_lshlrev_b32 v187, 1, v187
  v_mfma_f32_32x32x16_bf16 v[16:31], v[144:147], v[124:127], v[16:31]
  ds_read_b64_tr_b16 v[138:139], v168 offset:1792
  ds_read_b128 v[116:119], v160 offset:4096
  v_bfe_u32 v188, v209, 1, 1
  s_lshl_b32 s61, s3, 1
  s_add_u32 m0, s54, 83968
  v_mfma_f32_32x32x16_bf16 v[48:63], v[148:151], v[124:127], v[48:63]
  buffer_load_dwordx4 v172, s[4:7], s51 offen lds
  v_or_b32 v188, s61, v188
  v_xor_b32 v187, v187, v188
  v_lshlrev_b32 v187, 4, v187
  v_lshl_add_u32 v186, v186, 7, v187
  v_mfma_f32_32x32x16_bf16 v[80:95], v[152:155], v[124:127], v[80:95]
  buffer_load_dwordx2 v[254:255], v215, s[12:15], 0 offen sc1
  v_and_b32 v187, 1, v209
  v_lshl_add_u32 v186, v187, 3, v186
  v_add_u32 v186, 122880, v186
  v_mov_b32 v226, 0x3f803f80
  s_waitcnt lgkmcnt(5)
  v_mfma_f32_32x32x16_bf16 v[0:15], v[128:131], v[112:115], v[0:15]
  ds_read_b128 v[120:123], v161
  ds_read_b64_tr_b16 v[144:145], v168 offset:6144
  v_mov_b32 v227, 0x3f803f80
  v_mov_b32 v228, 0x3f803f80
  s_add_u32 m0, s54, 84992
  s_waitcnt lgkmcnt(5)
  v_mfma_f32_32x32x16_bf16 v[32:47], v[132:135], v[112:115], v[32:47]
  buffer_load_dwordx4 v173, s[4:7], s51 offen lds
  ds_read_b64_tr_b16 v[146:147], v168 offset:7680
  ds_read_b64_tr_b16 v[148:149], v168 offset:6272
  v_mov_b32 v229, 0x3f803f80
  ds_read_b64_tr_b16 a[208:209], v186 offset:0
  s_waitcnt lgkmcnt(6)
  v_mfma_f32_32x32x16_bf16 v[64:79], v[136:139], v[112:115], v[64:79]
  ds_read_b64_tr_b16 v[150:151], v168 offset:7808
  ds_read_b64_tr_b16 v[152:153], v168 offset:6400
  ds_read_b64_tr_b16 a[210:211], v186 offset:2048
  ds_read_b64_tr_b16 a[212:213], v186 offset:4096
  ds_read_b64_tr_b16 a[214:215], v186 offset:6144
  s_waitcnt lgkmcnt(10)
  v_mfma_f32_32x32x16_bf16 v[16:31], v[128:131], v[116:119], v[16:31]
  ds_read_b64_tr_b16 v[154:155], v168 offset:7936
  ds_read_b128 v[124:127], v161 offset:4096
  ds_read_b64_tr_b16 a[216:217], v186 offset:8192
  ds_read_b64_tr_b16 a[218:219], v186 offset:10240
  s_add_u32 m0, s55, 81920
  v_mfma_f32_32x32x16_bf16 v[48:63], v[132:135], v[116:119], v[48:63]
  buffer_load_dwordx4 v174, s[8:11], s52 offen lds
  ds_read_b64_tr_b16 a[220:221], v186 offset:12288
  ds_read_b64_tr_b16 a[222:223], v186 offset:14336
  ds_read_b64_tr_b16 a[224:225], v186 offset:16384
  ds_read_b64_tr_b16 a[226:227], v186 offset:18432
  v_mfma_f32_32x32x16_bf16 v[80:95], v[136:139], v[116:119], v[80:95]
  ds_read_b64_tr_b16 a[228:229], v186 offset:20480
  ds_read_b64_tr_b16 a[230:231], v186 offset:22528
  ds_read_b64_tr_b16 a[232:233], v186 offset:24576
  ds_read_b64_tr_b16 a[234:235], v186 offset:26624
  ds_read_b64_tr_b16 a[236:237], v186 offset:28672
  s_waitcnt lgkmcnt(15)
  v_mfma_f32_32x32x16_bf16 v[0:15], v[144:147], v[120:123], v[0:15]
  ds_read_b128 v[112:115], v162
  ds_read_b64_tr_b16 v[128:129], v168 offset:12288
  v_add_u32 v160, 0xa000, v160
  v_add_u32 v161, 0xa000, v161
  s_add_u32 m0, s55, 82944
  v_mfma_f32_32x32x16_bf16 v[32:47], v[148:151], v[120:123], v[32:47]
  buffer_load_dwordx4 v175, s[8:11], s52 offen lds
  ds_read_b64_tr_b16 v[130:131], v168 offset:13824
  ds_read_b64_tr_b16 v[132:133], v168 offset:12416
  ds_read_b64_tr_b16 a[238:239], v186 offset:30720
  v_lshl_add_u32 v187, v209, 4, s50
  s_waitcnt lgkmcnt(15)
  v_mfma_f32_32x32x16_bf16 v[64:79], v[152:155], v[120:123], v[64:79]
  ds_read_b64_tr_b16 v[134:135], v168 offset:13952
  ds_read_b64_tr_b16 v[136:137], v168 offset:12544
  v_mov_b32 v188, 2147483392
  v_cmp_gt_u32 vcc, 16, v209
  s_nop 1
  v_cndmask_b32 v188, v188, v187, vcc
  v_mfma_f32_32x32x16_bf16 v[16:31], v[144:147], v[124:127], v[16:31]
  ds_read_b64_tr_b16 v[138:139], v168 offset:14080
  ds_read_b128 v[116:119], v162 offset:4096
  v_mfma_f32_16x16x32_bf16 v[198:201], v[226:229], a[208:211], 0
  v_mfma_f32_16x16x32_bf16 v[202:205], v[226:229], a[212:215], 0
  s_add_u32 m0, s55, 83968
  v_mfma_f32_32x32x16_bf16 v[48:63], v[148:151], v[124:127], v[48:63]
  buffer_load_dwordx4 v176, s[8:11], s52 offen lds
  s_waitcnt lgkmcnt(15)
  v_mfma_f32_16x16x32_bf16 v[198:201], v[226:229], a[216:219], v[198:201]
  v_mfma_f32_16x16x32_bf16 v[202:205], v[226:229], a[220:223], v[202:205]
  s_waitcnt lgkmcnt(14)
  v_mfma_f32_32x32x16_bf16 v[80:95], v[152:155], v[124:127], v[80:95]
  v_mfma_f32_16x16x32_bf16 v[198:201], v[226:229], a[224:227], v[198:201]
  s_waitcnt lgkmcnt(12)
  v_mfma_f32_16x16x32_bf16 v[202:205], v[226:229], a[228:231], v[202:205]
  s_waitcnt lgkmcnt(10)
  v_mfma_f32_16x16x32_bf16 v[198:201], v[226:229], a[232:235], v[198:201]
  s_waitcnt lgkmcnt(6)
  v_mfma_f32_32x32x16_bf16 v[0:15], v[128:131], v[112:115], v[0:15]
  ds_read_b128 v[120:123], v163
  ds_read_b64_tr_b16 v[144:145], v168 offset:18432
  v_add_u32 v162, 0xa000, v162
  s_waitcnt lgkmcnt(6)
  s_add_u32 m0, s55, 84992
  s_waitcnt lgkmcnt(5)
  v_mfma_f32_32x32x16_bf16 v[32:47], v[132:135], v[112:115], v[32:47]
  buffer_load_dwordx4 v174, s[8:11], s53 offen lds
  ds_read_b64_tr_b16 v[146:147], v168 offset:19968
  ds_read_b64_tr_b16 v[148:149], v168 offset:18560
  v_mfma_f32_16x16x32_bf16 v[202:205], v[226:229], a[236:239], v[202:205]
  v_mov_b32 v184, s57
  s_waitcnt lgkmcnt(5)
  v_mfma_f32_32x32x16_bf16 v[64:79], v[136:139], v[112:115], v[64:79]
  ds_read_b64_tr_b16 v[150:151], v168 offset:20096
  ds_read_b64_tr_b16 v[152:153], v168 offset:18688
  v_mov_b32 v185, s56
  s_nop 1
  v_add_f32 v198, v198, v202
  s_add_u32 m0, s55, 86016
  s_waitcnt lgkmcnt(6)
  v_mfma_f32_32x32x16_bf16 v[16:31], v[128:131], v[116:119], v[16:31]
  buffer_load_dwordx4 v175, s[8:11], s53 offen lds
  ds_read_b64_tr_b16 v[154:155], v168 offset:20224
  ds_read_b128 v[124:127], v163 offset:4096
  v_cvt_pk_bf16_f32 v199, v198, v198
  v_and_b32 v199, 0xffff0000, v199
  v_mfma_f32_32x32x16_bf16 v[48:63], v[132:135], v[116:119], v[48:63]
  v_sub_f32 v200, v198, v199
  v_lshrrev_b32 v183, 16, v199
  v_cvt_pk_bf16_f32 v182, v199, v200
  buffer_store_dwordx4 v[182:185], v188, s[12:15], 0 offen sc1
  s_add_u32 m0, s55, 87040
  v_mfma_f32_32x32x16_bf16 v[80:95], v[136:139], v[116:119], v[80:95]
  buffer_load_dwordx4 v176, s[8:11], s53 offen lds
  s_and_b32 s61, s56, 63
  s_lshr_b32 s96, s56, 6
  s_and_b32 s96, s96, 62
  s_and_b32 s97, s56, 1
  v_add_u32 v163, 0xa000, v163
  v_add_u32 v168, 0xa000, v168
  s_waitcnt vmcnt(8)
  s_waitcnt lgkmcnt(0)
  s_barrier
  s_mov_b32 s58, 0
L_fchk_9:
  v_cmp_eq_u32 s[30:31], s56, v254
  v_cmp_eq_u32 s[34:35], s57, v255
  s_nop 0
  s_and_b64 s[30:31], s[30:31], s[34:35]
  s_cmp_eq_u64 s[30:31], exec
  s_cbranch_scc1 L_fok_10
  s_add_u32 s58, s58, 1
  s_cmp_ge_u32 s58, 262144
  s_cbranch_scc1 L_fok_10
  buffer_load_dwordx2 v[254:255], v215, s[12:15], 0 offen sc1
  s_waitcnt vmcnt(0)
  s_branch L_fchk_9
L_fok_10:
  s_mov_b32 s51, 768
  s_mov_b32 s52, 1056768
  s_mov_b32 s53, 1078784
  v_mfma_f32_32x32x16_bf16 v[0:15], v[144:147], v[120:123], v[0:15]
  ds_read_b128 v[112:115], v160
  ds_read_b64_tr_b16 v[128:129], v168 offset:0
  s_or_b32 s96, s96, s97
  s_lshl_b32 s96, s96, 8
  s_add_u32 m0, s54, 0
  v_mfma_f32_32x32x16_bf16 v[32:47], v[148:151], v[120:123], v[32:47]
  buffer_load_dwordx4 v170, s[4:7], s51 offen lds
  ds_read_b64_tr_b16 v[130:131], v168 offset:1536
  ds_read_b64_tr_b16 v[132:133], v168 offset:128
  s_or_b32 s61, s61, s96
  s_add_u32 m0, s54, 1024
  v_mfma_f32_32x32x16_bf16 v[64:79], v[152:155], v[120:123], v[64:79]
  buffer_load_dwordx4 v171, s[4:7], s51 offen lds
  ds_read_b64_tr_b16 v[134:135], v168 offset:1664
  ds_read_b64_tr_b16 v[136:137], v168 offset:256
  v_lshrrev_b32 v182, 5, v209
  v_lshlrev_b32 v182, 3, v182
  v_mfma_f32_32x32x16_bf16 v[16:31], v[144:147], v[124:127], v[16:31]
  ds_read_b64_tr_b16 v[138:139], v168 offset:1792
  ds_read_b128 v[116:119], v160 offset:4096
  v_lshrrev_b32 v182, v182, s61
  v_lshlrev_b32 v183, 15, v182
  s_add_u32 m0, s54, 2048
  v_mfma_f32_32x32x16_bf16 v[48:63], v[148:151], v[124:127], v[48:63]
  buffer_load_dwordx4 v172, s[4:7], s51 offen lds
  v_lshl_or_b32 v183, v182, 30, v183
  v_and_b32 v216, 0x80008000, v183
  v_lshrrev_b32 v182, 2, v182
  v_lshlrev_b32 v183, 15, v182
  v_mfma_f32_32x32x16_bf16 v[80:95], v[152:155], v[124:127], v[80:95]
  buffer_load_dwordx4 a[0:3], v208, s[12:15], s88 offen offset:0 sc1
  v_lshl_or_b32 v183, v182, 30, v183
  v_and_b32 v218, 0x80008000, v183
  v_lshrrev_b32 v182, 2, v182
  v_lshlrev_b32 v183, 15, v182
  s_waitcnt lgkmcnt(5)
  v_mfma_f32_32x32x16_bf16 v[0:15], v[128:131], v[112:115], v[0:15]
  ds_read_b128 v[120:123], v161
  ds_read_b64_tr_b16 v[144:145], v168 offset:6144
  v_lshl_or_b32 v183, v182, 30, v183
  v_and_b32 v219, 0x80008000, v183
  s_add_u32 m0, s54, 3072
  s_waitcnt lgkmcnt(5)
  v_mfma_f32_32x32x16_bf16 v[32:47], v[132:135], v[112:115], v[32:47]
  buffer_load_dwordx4 v173, s[4:7], s51 offen lds
  ds_read_b64_tr_b16 v[146:147], v168 offset:7680
  ds_read_b64_tr_b16 v[148:149], v168 offset:6272
  v_xor_b32 v217, 0x80008000, v216
  v_mov_b32 v238, 2147483392
  s_waitcnt lgkmcnt(5)
  v_mfma_f32_32x32x16_bf16 v[64:79], v[136:139], v[112:115], v[64:79]
  ds_read_b64_tr_b16 v[150:151], v168 offset:7808
  ds_read_b64_tr_b16 v[152:153], v168 offset:6400
  s_lshl_b32 s61, s59, 5
  s_add_u32 s96, s61, 24
  s_add_u32 m0, s55, 0
  s_waitcnt lgkmcnt(6)
  v_mfma_f32_32x32x16_bf16 v[16:31], v[128:131], v[116:119], v[16:31]
  buffer_load_dwordx4 v174, s[8:11], s52 offen lds
  ds_read_b64_tr_b16 v[154:155], v168 offset:7936
  ds_read_b128 v[124:127], v161 offset:4096
  s_mul_i32 s96, s96, 575
  s_lshr_b32 s96, s96, 15
  v_mfma_f32_32x32x16_bf16 v[48:63], v[132:135], v[116:119], v[48:63]
  s_max_u32 s61, s61, 7
  s_sub_u32 s61, s61, 7
  s_mul_i32 s61, s61, 575
  s_lshr_b32 s61, s61, 15
  s_sub_u32 s96, s96, s61
  v_mfma_f32_32x32x16_bf16 v[80:95], v[136:139], v[116:119], v[80:95]
  buffer_load_dwordx4 a[4:7], v208, s[12:15], s89 offen offset:0 sc1
  v_bfe_u32 v182, v209, 3, 1
  v_mul_u32_u24 v182, s96, v182
  v_add_u32 v182, s61, v182
  v_bfe_u32 v183, v209, 2, 1
  s_waitcnt lgkmcnt(5)
  v_mfma_f32_32x32x16_bf16 v[0:15], v[144:147], v[120:123], v[0:15]
  ds_read_b128 v[112:115], v162
  ds_read_b64_tr_b16 v[128:129], v168 offset:12288
  v_add_u32 v160, 0xa000, v160
  v_add_u32 v161, 0xa000, v161
  s_add_u32 m0, s55, 1024
  s_waitcnt lgkmcnt(5)
  v_mfma_f32_32x32x16_bf16 v[32:47], v[148:151], v[120:123], v[32:47]
  buffer_load_dwordx4 v175, s[8:11], s52 offen lds
  ds_read_b64_tr_b16 v[130:131], v168 offset:13824
  ds_read_b64_tr_b16 v[132:133], v168 offset:12416
  v_lshl_add_u32 v182, v182, 3, v183
  s_add_u32 m0, s55, 2048
  s_waitcnt lgkmcnt(5)
  v_mfma_f32_32x32x16_bf16 v[64:79], v[152:155], v[120:123], v[64:79]
  buffer_load_dwordx4 v176, s[8:11], s52 offen lds
  ds_read_b64_tr_b16 v[134:135], v168 offset:13952
  ds_read_b64_tr_b16 v[136:137], v168 offset:12544
  s_lshl_b32 s61, s3, 1
  v_add_u32 v182, s61, v182
  s_waitcnt lgkmcnt(6)
  v_mfma_f32_32x32x16_bf16 v[16:31], v[144:147], v[124:127], v[16:31]
  ds_read_b64_tr_b16 v[138:139], v168 offset:14080
  ds_read_b128 v[116:119], v162 offset:4096
  v_and_b32 v183, 3, v209
  v_lshl_add_u32 v182, v182, 2, v183
  v_lshlrev_b32 v182, 3, v182
  v_mfma_f32_32x32x16_bf16 v[48:63], v[148:151], v[124:127], v[48:63]
  buffer_load_dwordx4 a[8:11], v208, s[12:15], s88 offen offset:1024 sc1
  v_add_u32 v235, 4096, v182
  v_and_b32 v182, 31, v209
  v_lshrrev_b32 v183, 5, v209
  s_lshl_b32 s61, s59, 6
  v_mfma_f32_32x32x16_bf16 v[80:95], v[152:155], v[124:127], v[80:95]
  buffer_load_dwordx4 a[12:15], v208, s[12:15], s89 offen offset:1024 sc1
  s_add_u32 s61, s61, s45
  s_lshl_b32 s61, s61, 10
  s_lshl_b32 s96, s60, 7
  s_add_u32 s61, s61, s96
  s_waitcnt lgkmcnt(5)
  v_mfma_f32_32x32x16_bf16 v[0:15], v[128:131], v[112:115], v[0:15]
  ds_read_b128 v[120:123], v163
  ds_read_b64_tr_b16 v[144:145], v168 offset:18432
  v_add_u32 v162, 0xa000, v162
  s_lshl_b32 s96, s46, 6
  s_add_u32 m0, s55, 3072
  s_waitcnt lgkmcnt(5)
  v_mfma_f32_32x32x16_bf16 v[32:47], v[132:135], v[112:115], v[32:47]
  buffer_load_dwordx4 v174, s[8:11], s53 offen lds
  ds_read_b64_tr_b16 v[146:147], v168 offset:19968
  ds_read_b64_tr_b16 v[148:149], v168 offset:18560
  s_add_u32 s61, s61, s96
  s_add_u32 m0, s55, 4096
  s_waitcnt lgkmcnt(5)
  v_mfma_f32_32x32x16_bf16 v[64:79], v[136:139], v[112:115], v[64:79]
  buffer_load_dwordx4 v175, s[8:11], s53 offen lds
  ds_read_b64_tr_b16 v[150:151], v168 offset:20096
  ds_read_b64_tr_b16 v[152:153], v168 offset:18688
  v_lshlrev_b32 v184, 11, v182
  v_lshl_add_u32 v184, v183, 5, v184
  s_waitcnt lgkmcnt(6)
  v_mfma_f32_32x32x16_bf16 v[16:31], v[128:131], v[116:119], v[16:31]
  ds_read_b64_tr_b16 v[154:155], v168 offset:20224
L_stub_ffn_1:
  s_cmp_eq_u32 s86, 1
  s_cbranch_scc1 L_tret_ffn_1
  ds_read_b128 v[124:127], v163 offset:4096
  v_add_u32 v236, s61, v184
  s_lshl_b32 s61, s45, 10
  s_add_u32 m0, s55, 5120
  v_mfma_f32_32x32x16_bf16 v[48:63], v[132:135], v[116:119], v[48:63]
  buffer_load_dwordx4 v176, s[8:11], s53 offen lds
  s_lshl_b32 s96, s59, 5
  s_add_u32 s61, s61, s96
  v_add_u32 v182, s61, v182
  v_lshlrev_b32 v182, 4, v182
  v_mfma_f32_32x32x16_bf16 v[80:95], v[136:139], v[116:119], v[80:95]
  buffer_load_dwordx4 a[16:19], v208, s[12:15], s88 offen offset:2048 sc1
  v_add_u32 v237, 65536, v182
  s_mul_i32 s61, s45, 120832
  v_add_u32 v181, s61, v208
  s_xor_b32 s61, s45, 1
  v_add_u32 v163, 0xa000, v163
  v_add_u32 v168, 0xa000, v168
  s_waitcnt vmcnt(15)
  s_waitcnt lgkmcnt(0)
  s_barrier
  s_mov_b32 s51, 896
  s_mov_b32 s52, 1232896
  s_mov_b32 s53, 1254912
  v_mfma_f32_32x32x16_bf16 v[0:15], v[144:147], v[120:123], v[0:15]
  ds_read_b128 v[112:115], v160
  ds_read_b64_tr_b16 v[128:129], v168 offset:0
  s_mul_i32 s61, s61, 120832
  v_add_u32 v239, s61, v208
  s_add_u32 m0, s54, 40960
  v_mfma_f32_32x32x16_bf16 v[32:47], v[148:151], v[120:123], v[32:47]
  buffer_load_dwordx4 v170, s[4:7], s51 offen lds
  ds_read_b64_tr_b16 v[130:131], v168 offset:1536
  ds_read_b64_tr_b16 v[132:133], v168 offset:128
  s_lshl_b32 s61, s59, 1
  s_add_u32 m0, s54, 41984
  v_mfma_f32_32x32x16_bf16 v[64:79], v[152:155], v[120:123], v[64:79]
  buffer_load_dwordx4 v171, s[4:7], s51 offen lds
  ds_read_b64_tr_b16 v[134:135], v168 offset:1664
  ds_read_b64_tr_b16 v[136:137], v168 offset:256
  s_mul_i32 s61, s61, 120832
  s_add_u32 s61, s61, 3145728
  v_mfma_f32_32x32x16_bf16 v[16:31], v[144:147], v[124:127], v[16:31]
  ds_read_b64_tr_b16 v[138:139], v168 offset:1792
  ds_read_b128 v[116:119], v160 offset:4096
  s_mul_i32 s96, s3, 18
  s_add_u32 s96, s96, 32
  s_add_u32 m0, s54, 43008
  v_mfma_f32_32x32x16_bf16 v[48:63], v[148:151], v[124:127], v[48:63]
  buffer_load_dwordx4 v172, s[4:7], s51 offen lds
  s_lshl_b32 s97, s96, 10
  s_add_u32 s24, s61, s97
  s_add_u32 s38, s24, 4096
  s_add_u32 s39, s24, 8192
  v_mfma_f32_32x32x16_bf16 v[80:95], v[152:155], v[124:127], v[80:95]
  buffer_load_dwordx4 a[20:23], v208, s[12:15], s89 offen offset:2048 sc1
  s_add_u32 s1, s24, 12288
  s_add_u32 s0, s24, 16384
  s_lshl_b32 s96, s3, 2
  s_add_u32 s96, s96, 104
  s_waitcnt lgkmcnt(5)
  v_mfma_f32_32x32x16_bf16 v[0:15], v[128:131], v[112:115], v[0:15]
  ds_read_b128 v[120:123], v161
  ds_read_b64_tr_b16 v[144:145], v168 offset:6144
  s_lshl_b32 s97, s96, 10
  s_add_u32 s28, s61, s97
  s_add_u32 m0, s54, 44032
  s_waitcnt lgkmcnt(5)
  v_mfma_f32_32x32x16_bf16 v[32:47], v[132:135], v[112:115], v[32:47]
  buffer_load_dwordx4 v173, s[4:7], s51 offen lds
  ds_read_b64_tr_b16 v[146:147], v168 offset:7680
  ds_read_b64_tr_b16 v[148:149], v168 offset:6272
  s_add_u32 s97, s96, 2
  s_min_u32 s97, s97, 117
  s_waitcnt lgkmcnt(5)
  v_mfma_f32_32x32x16_bf16 v[64:79], v[136:139], v[112:115], v[64:79]
  ds_read_b64_tr_b16 v[150:151], v168 offset:7808
  ds_read_b64_tr_b16 v[152:153], v168 offset:6400
  s_lshl_b32 s97, s97, 10
  s_add_u32 s26, s61, s97
  s_add_u32 m0, s55, 40960
  s_waitcnt lgkmcnt(6)
  v_mfma_f32_32x32x16_bf16 v[16:31], v[128:131], v[116:119], v[16:31]
  buffer_load_dwordx4 v174, s[8:11], s52 offen lds
  ds_read_b64_tr_b16 v[154:155], v168 offset:7936
  ds_read_b128 v[124:127], v161 offset:4096
  s_add_u32 s97, s96, 3
  s_min_u32 s97, s97, 117
  v_mfma_f32_32x32x16_bf16 v[48:63], v[132:135], v[116:119], v[48:63]
  s_lshl_b32 s97, s97, 10
  s_add_u32 s27, s61, s97
  s_lshl_b32 s97, s3, 13
  s_add_u32 s25, s61, s97
  s_add_u32 s33, s25, 4096
  v_mfma_f32_32x32x16_bf16 v[80:95], v[136:139], v[116:119], v[80:95]
  buffer_load_dwordx4 a[24:27], v208, s[12:15], s88 offen offset:3072 sc1
  s_waitcnt lgkmcnt(5)
  v_mfma_f32_32x32x16_bf16 v[0:15], v[144:147], v[120:123], v[0:15]
  ds_read_b128 v[112:115], v162
  ds_read_b64_tr_b16 v[128:129], v168 offset:12288
  v_add_u32 v160, 0xfffec000, v160
  v_add_u32 v161, 0xfffec000, v161
  s_add_u32 m0, s55, 41984
  s_waitcnt lgkmcnt(5)
  v_mfma_f32_32x32x16_bf16 v[32:47], v[148:151], v[120:123], v[32:47]
  buffer_load_dwordx4 v175, s[8:11], s52 offen lds
  ds_read_b64_tr_b16 v[130:131], v168 offset:13824
  ds_read_b64_tr_b16 v[132:133], v168 offset:12416
  s_add_u32 m0, s55, 43008
  s_waitcnt lgkmcnt(5)
  v_mfma_f32_32x32x16_bf16 v[64:79], v[152:155], v[120:123], v[64:79]
  buffer_load_dwordx4 v176, s[8:11], s52 offen lds
  ds_read_b64_tr_b16 v[134:135], v168 offset:13952
  ds_read_b64_tr_b16 v[136:137], v168 offset:12544
  s_waitcnt lgkmcnt(6)
  v_mfma_f32_32x32x16_bf16 v[16:31], v[144:147], v[124:127], v[16:31]
  ds_read_b64_tr_b16 v[138:139], v168 offset:14080
  ds_read_b128 v[116:119], v162 offset:4096
  v_mfma_f32_32x32x16_bf16 v[48:63], v[148:151], v[124:127], v[48:63]
  buffer_load_dwordx4 a[28:31], v208, s[12:15], s89 offen offset:3072 sc1
  s_add_u32 s88, s88, 4096
  v_mfma_f32_32x32x16_bf16 v[80:95], v[152:155], v[124:127], v[80:95]
  buffer_load_dwordx4 a[32:35], v208, s[12:15], s88 offen offset:0 sc1
  s_waitcnt lgkmcnt(5)
  v_mfma_f32_32x32x16_bf16 v[0:15], v[128:131], v[112:115], v[0:15]
  ds_read_b128 v[120:123], v163
  ds_read_b64_tr_b16 v[144:145], v168 offset:18432
  v_add_u32 v162, 0xfffec000, v162
  s_add_u32 m0, s55, 44032
  s_waitcnt lgkmcnt(5)
  v_mfma_f32_32x32x16_bf16 v[32:47], v[132:135], v[112:115], v[32:47]
  buffer_load_dwordx4 v174, s[8:11], s53 offen lds
  ds_read_b64_tr_b16 v[146:147], v168 offset:19968
  ds_read_b64_tr_b16 v[148:149], v168 offset:18560
  s_add_u32 m0, s55, 45056
  s_waitcnt lgkmcnt(5)
  v_mfma_f32_32x32x16_bf16 v[64:79], v[136:139], v[112:115], v[64:79]
  buffer_load_dwordx4 v175, s[8:11], s53 offen lds
  ds_read_b64_tr_b16 v[150:151], v168 offset:20096
  ds_read_b64_tr_b16 v[152:153], v168 offset:18688
  s_waitcnt lgkmcnt(6)
  v_mfma_f32_32x32x16_bf16 v[16:31], v[128:131], v[116:119], v[16:31]
  ds_read_b64_tr_b16 v[154:155], v168 offset:20224
  ds_read_b128 v[124:127], v163 offset:4096
  s_add_u32 m0, s55, 46080
  v_mfma_f32_32x32x16_bf16 v[48:63], v[132:135], v[116:119], v[48:63]
  buffer_load_dwordx4 v176, s[8:11], s53 offen lds
  s_add_u32 s89, s89, 4096
  v_mfma_f32_32x32x16_bf16 v[80:95], v[136:139], v[116:119], v[80:95]
  buffer_load_dwordx4 a[36:39], v208, s[12:15], s89 offen offset:0 sc1
  v_add_u32 v163, 0xfffec000, v163
  v_add_u32 v168, 0xfffec000, v168
  s_waitcnt vmcnt(16)
  s_waitcnt lgkmcnt(0)
  s_barrier
  v_mfma_f32_32x32x16_bf16 v[0:15], v[144:147], v[120:123], v[0:15]
  ds_read_b128 v[112:115], v160
  ds_read_b64_tr_b16 v[128:129], v168 offset:0
  v_mfma_f32_32x32x16_bf16 v[32:47], v[148:151], v[120:123], v[32:47]
  buffer_load_dwordx4 a[40:43], v208, s[12:15], s88 offen offset:1024 sc1
  ds_read_b64_tr_b16 v[130:131], v168 offset:1536
  ds_read_b64_tr_b16 v[132:133], v168 offset:128
  v_mfma_f32_32x32x16_bf16 v[64:79], v[152:155], v[120:123], v[64:79]
  ds_read_b64_tr_b16 v[134:135], v168 offset:1664
  ds_read_b64_tr_b16 v[136:137], v168 offset:256
  v_mfma_f32_32x32x16_bf16 v[16:31], v[144:147], v[124:127], v[16:31]
  buffer_load_dwordx4 a[44:47], v208, s[12:15], s89 offen offset:1024 sc1
  ds_read_b64_tr_b16 v[138:139], v168 offset:1792
  ds_read_b128 v[116:119], v160 offset:4096
  v_mfma_f32_32x32x16_bf16 v[48:63], v[148:151], v[124:127], v[48:63]
  v_mfma_f32_32x32x16_bf16 v[80:95], v[152:155], v[124:127], v[80:95]
  buffer_load_dwordx4 a[48:51], v208, s[12:15], s88 offen offset:2048 sc1
  s_waitcnt lgkmcnt(5)
  v_mfma_f32_32x32x16_bf16 v[0:15], v[128:131], v[112:115], v[0:15]
  ds_read_b128 v[120:123], v161
  ds_read_b64_tr_b16 v[144:145], v168 offset:6144
  s_waitcnt lgkmcnt(5)
  v_mfma_f32_32x32x16_bf16 v[32:47], v[132:135], v[112:115], v[32:47]
  buffer_load_dwordx4 v[182:185], v211, s[12:15], 0 offen sc1
  ds_read_b64_tr_b16 v[146:147], v168 offset:7680
  ds_read_b64_tr_b16 v[148:149], v168 offset:6272
  s_waitcnt lgkmcnt(5)
  v_mfma_f32_32x32x16_bf16 v[64:79], v[136:139], v[112:115], v[64:79]
  ds_read_b64_tr_b16 v[150:151], v168 offset:7808
  ds_read_b64_tr_b16 v[152:153], v168 offset:6400
  s_waitcnt lgkmcnt(6)
  v_mfma_f32_32x32x16_bf16 v[16:31], v[128:131], v[116:119], v[16:31]
  buffer_load_dwordx4 v[186:189], v212, s[12:15], 0 offen sc1
  ds_read_b64_tr_b16 v[154:155], v168 offset:7936
  ds_read_b128 v[124:127], v161 offset:4096
  v_mfma_f32_32x32x16_bf16 v[48:63], v[132:135], v[116:119], v[48:63]
  v_mfma_f32_32x32x16_bf16 v[80:95], v[136:139], v[116:119], v[80:95]
  buffer_load_dwordx4 v[190:193], v213, s[12:15], 0 offen offset:0 sc1
  s_waitcnt lgkmcnt(5)
  v_mfma_f32_32x32x16_bf16 v[0:15], v[144:147], v[120:123], v[0:15]
  ds_read_b128 v[112:115], v162
  ds_read_b64_tr_b16 v[128:129], v168 offset:12288
  v_add_u32 v160, 0xa000, v160
  v_add_u32 v161, 0xa000, v161
  s_waitcnt lgkmcnt(5)
  v_mfma_f32_32x32x16_bf16 v[32:47], v[148:151], v[120:123], v[32:47]
  buffer_load_dwordx4 v[194:197], v213, s[12:15], 0 offen offset:1024 sc1
  ds_read_b64_tr_b16 v[130:131], v168 offset:13824
  ds_read_b64_tr_b16 v[132:133], v168 offset:12416
  s_waitcnt lgkmcnt(5)
  v_mfma_f32_32x32x16_bf16 v[64:79], v[152:155], v[120:123], v[64:79]
  ds_read_b64_tr_b16 v[134:135], v168 offset:13952
  ds_read_b64_tr_b16 v[136:137], v168 offset:12544
  s_waitcnt lgkmcnt(6)
  v_mfma_f32_32x32x16_bf16 v[16:31], v[144:147], v[124:127], v[16:31]
  ds_read_b64_tr_b16 v[138:139], v168 offset:14080
  ds_read_b128 v[116:119], v162 offset:4096
  v_mfma_f32_32x32x16_bf16 v[48:63], v[148:151], v[124:127], v[48:63]
  buffer_load_dwordx4 v[198:201], v213, s[12:15], 0 offen offset:2048 sc1
  v_mfma_f32_32x32x16_bf16 v[80:95], v[152:155], v[124:127], v[80:95]
  s_waitcnt lgkmcnt(5)
  v_mfma_f32_32x32x16_bf16 v[0:15], v[128:131], v[112:115], v[0:15]
  ds_read_b128 v[120:123], v163
  ds_read_b64_tr_b16 v[144:145], v168 offset:18432
  v_add_u32 v162, 0xa000, v162
  s_waitcnt lgkmcnt(5)
  v_mfma_f32_32x32x16_bf16 v[32:47], v[132:135], v[112:115], v[32:47]
  buffer_load_dwordx4 a[52:55], v208, s[12:15], s89 offen offset:2048 sc1
  ds_read_b64_tr_b16 v[146:147], v168 offset:19968
  ds_read_b64_tr_b16 v[148:149], v168 offset:18560
  s_waitcnt lgkmcnt(5)
  v_mfma_f32_32x32x16_bf16 v[64:79], v[136:139], v[112:115], v[64:79]
  ds_read_b64_tr_b16 v[150:151], v168 offset:20096
  ds_read_b64_tr_b16 v[152:153], v168 offset:18688
  s_waitcnt lgkmcnt(6)
  v_mfma_f32_32x32x16_bf16 v[16:31], v[128:131], v[116:119], v[16:31]
  buffer_load_dwordx4 a[56:59], v208, s[12:15], s88 offen offset:3072 sc1
  ds_read_b64_tr_b16 v[154:155], v168 offset:20224
  ds_read_b128 v[124:127], v163 offset:4096
  v_mfma_f32_32x32x16_bf16 v[48:63], v[132:135], v[116:119], v[48:63]
  v_mfma_f32_32x32x16_bf16 v[80:95], v[136:139], v[116:119], v[80:95]
  buffer_load_dwordx4 a[60:63], v208, s[12:15], s89 offen offset:3072 sc1
  v_add_u32 v163, 0xa000, v163
  v_add_u32 v168, 0xa000, v168
  s_waitcnt vmcnt(12)
  s_waitcnt lgkmcnt(0)
  s_barrier
  v_mfma_f32_32x32x16_bf16 v[0:15], v[144:147], v[120:123], v[0:15]
  ds_read_b128 v[112:115], v160
  ds_read_b64_tr_b16 v[128:129], v168 offset:0
  s_add_u32 s88, s88, 4096
  v_mfma_f32_32x32x16_bf16 v[32:47], v[148:151], v[120:123], v[32:47]
  buffer_load_dwordx4 a[64:67], v208, s[12:15], s88 offen offset:0 sc1
  ds_read_b64_tr_b16 v[130:131], v168 offset:1536
  ds_read_b64_tr_b16 v[132:133], v168 offset:128
  v_mfma_f32_32x32x16_bf16 v[64:79], v[152:155], v[120:123], v[64:79]
  ds_read_b64_tr_b16 v[134:135], v168 offset:1664
  ds_read_b64_tr_b16 v[136:137], v168 offset:256
  s_add_u32 s89, s89, 4096
  v_mfma_f32_32x32x16_bf16 v[16:31], v[144:147], v[124:127], v[16:31]
  buffer_load_dwordx4 a[68:71], v208, s[12:15], s89 offen offset:0 sc1
  ds_read_b64_tr_b16 v[138:139], v168 offset:1792
  ds_read_b128 v[116:119], v160 offset:4096
  v_mfma_f32_32x32x16_bf16 v[48:63], v[148:151], v[124:127], v[48:63]
  v_mfma_f32_32x32x16_bf16 v[80:95], v[152:155], v[124:127], v[80:95]
  buffer_load_dwordx4 a[72:75], v208, s[12:15], s88 offen offset:1024 sc1
  s_waitcnt lgkmcnt(5)
  v_mfma_f32_32x32x16_bf16 v[0:15], v[128:131], v[112:115], v[0:15]
  ds_read_b128 v[120:123], v161
  ds_read_b64_tr_b16 v[144:145], v168 offset:6144
  s_waitcnt lgkmcnt(5)
  v_mfma_f32_32x32x16_bf16 v[32:47], v[132:135], v[112:115], v[32:47]
  buffer_load_dwordx4 a[76:79], v208, s[12:15], s89 offen offset:1024 sc1
  ds_read_b64_tr_b16 v[146:147], v168 offset:7680
  ds_read_b64_tr_b16 v[148:149], v168 offset:6272
  s_waitcnt lgkmcnt(5)
  v_mfma_f32_32x32x16_bf16 v[64:79], v[136:139], v[112:115], v[64:79]
  ds_read_b64_tr_b16 v[150:151], v168 offset:7808
  ds_read_b64_tr_b16 v[152:153], v168 offset:6400
  s_waitcnt vmcnt(7)
  s_mov_b32 s58, 0
L_gchk_11:
  v_cmp_eq_u32 vcc, s56, v185
  v_cmp_eq_u32 s[62:63], s56, v189
  s_nop 0
  s_and_b64 vcc, vcc, s[62:63]
  v_cmp_eq_u32 s[62:63], s56, v193
  s_nop 0
  s_and_b64 vcc, vcc, s[62:63]
  v_cmp_eq_u32 s[62:63], s56, v197
  s_nop 0
  s_and_b64 vcc, vcc, s[62:63]
  v_cmp_eq_u32 s[62:63], s56, v201
  s_nop 0
  s_and_b64 vcc, vcc, s[62:63]
  s_cmp_eq_u64 vcc, exec
  s_cbranch_scc1 L_gok_12
  s_add_u32 s58, s58, 1
  s_cmp_ge_u32 s58, 262144
  s_cbranch_scc1 L_gok_12
  buffer_load_dwordx4 v[182:185], v211, s[12:15], 0 offen sc1
  buffer_load_dwordx4 v[186:189], v212, s[12:15], 0 offen sc1
  buffer_load_dwordx4 v[190:193], v213, s[12:15], 0 offen offset:0 sc1
  buffer_load_dwordx4 v[194:197], v213, s[12:15], 0 offen offset:1024 sc1
  buffer_load_dwordx4 v[198:201], v213, s[12:15], 0 offen offset:2048 sc1
  s_waitcnt vmcnt(0)
  s_branch L_gchk_11
L_gok_12:
  s_waitcnt lgkmcnt(6)
  v_mfma_f32_32x32x16_bf16 v[16:31], v[128:131], v[116:119], v[16:31]
  buffer_load_dwordx4 a[80:83], v208, s[12:15], s88 offen offset:2048 sc1
  ds_read_b64_tr_b16 v[154:155], v168 offset:7936
  ds_read_b128 v[124:127], v161 offset:4096
  v_mfma_f32_32x32x16_bf16 v[48:63], v[132:135], v[116:119], v[48:63]
  v_mfma_f32_32x32x16_bf16 v[80:95], v[136:139], v[116:119], v[80:95]
  buffer_load_dwordx4 a[84:87], v208, s[12:15], s89 offen offset:2048 sc1
  s_waitcnt lgkmcnt(5)
  v_mfma_f32_32x32x16_bf16 v[0:15], v[144:147], v[120:123], v[0:15]
  ds_read_b128 v[112:115], v162
  ds_read_b64_tr_b16 v[128:129], v168 offset:12288
  s_waitcnt lgkmcnt(5)
  v_mfma_f32_32x32x16_bf16 v[32:47], v[148:151], v[120:123], v[32:47]
  buffer_load_dwordx4 a[88:91], v208, s[12:15], s88 offen offset:3072 sc1
  ds_read_b64_tr_b16 v[130:131], v168 offset:13824
  ds_read_b64_tr_b16 v[132:133], v168 offset:12416
  s_waitcnt lgkmcnt(5)
  v_mfma_f32_32x32x16_bf16 v[64:79], v[152:155], v[120:123], v[64:79]
  ds_read_b64_tr_b16 v[134:135], v168 offset:13952
  ds_read_b64_tr_b16 v[136:137], v168 offset:12544
  s_waitcnt lgkmcnt(6)
  v_mfma_f32_32x32x16_bf16 v[16:31], v[144:147], v[124:127], v[16:31]
  buffer_load_dwordx4 a[92:95], v208, s[12:15], s89 offen offset:3072 sc1
  ds_read_b64_tr_b16 v[138:139], v168 offset:14080
  ds_read_b128 v[116:119], v162 offset:4096
  v_mfma_f32_32x32x16_bf16 v[48:63], v[148:151], v[124:127], v[48:63]
  s_add_u32 s88, s88, 4096
  v_mfma_f32_32x32x16_bf16 v[80:95], v[152:155], v[124:127], v[80:95]
  buffer_load_dwordx4 a[96:99], v208, s[12:15], s88 offen offset:0 sc1
  s_waitcnt lgkmcnt(5)
  v_mfma_f32_32x32x16_bf16 v[0:15], v[128:131], v[112:115], v[0:15]
  ds_read_b128 v[120:123], v163
  ds_read_b64_tr_b16 v[144:145], v168 offset:18432
  s_add_u32 s89, s89, 4096
  s_waitcnt lgkmcnt(5)
  v_mfma_f32_32x32x16_bf16 v[32:47], v[132:135], v[112:115], v[32:47]
  buffer_load_dwordx4 a[100:103], v208, s[12:15], s89 offen offset:0 sc1
  ds_read_b64_tr_b16 v[146:147], v168 offset:19968
  ds_read_b64_tr_b16 v[148:149], v168 offset:18560
  s_waitcnt lgkmcnt(5)
  v_mfma_f32_32x32x16_bf16 v[64:79], v[136:139], v[112:115], v[64:79]
  ds_read_b64_tr_b16 v[150:151], v168 offset:20096
  ds_read_b64_tr_b16 v[152:153], v168 offset:18688
  s_waitcnt lgkmcnt(6)
  v_mfma_f32_32x32x16_bf16 v[16:31], v[128:131], v[116:119], v[16:31]
  buffer_load_dwordx4 a[104:107], v208, s[12:15], s88 offen offset:1024 sc1
  ds_read_b64_tr_b16 v[154:155], v168 offset:20224
  ds_read_b128 v[124:127], v163 offset:4096
  v_mfma_f32_32x32x16_bf16 v[48:63], v[132:135], v[116:119], v[48:63]
  v_mfma_f32_32x32x16_bf16 v[80:95], v[136:139], v[116:119], v[80:95]
  buffer_load_dwordx4 a[108:111], v208, s[12:15], s89 offen offset:1024 sc1
  s_waitcnt lgkmcnt(5)
  v_mfma_f32_32x32x16_bf16 v[0:15], v[144:147], v[120:123], v[0:15]
  s_waitcnt lgkmcnt(3)
  v_mfma_f32_32x32x16_bf16 v[32:47], v[148:151], v[120:123], v[32:47]
  buffer_load_dwordx4 a[112:115], v208, s[12:15], s88 offen offset:2048 sc1
  s_waitcnt lgkmcnt(1)
  v_mfma_f32_32x32x16_bf16 v[64:79], v[152:155], v[120:123], v[64:79]
  s_waitcnt lgkmcnt(0)
  v_mfma_f32_32x32x16_bf16 v[16:31], v[144:147], v[124:127], v[16:31]
  buffer_load_dwordx4 a[116:119], v208, s[12:15], s89 offen offset:2048 sc1
  v_mfma_f32_32x32x16_bf16 v[48:63], v[148:151], v[124:127], v[48:63]
  v_mfma_f32_32x32x16_bf16 v[80:95], v[152:155], v[124:127], v[80:95]
  buffer_load_dwordx4 a[120:123], v208, s[12:15], s88 offen offset:3072 sc1
  v_mfma_f32_32x32x8_bf16 v[0:15], v[190:191], v[182:183], v[0:15]
  v_mfma_f32_32x32x8_bf16 v[16:31], v[190:191], v[186:187], v[16:31]
  v_mfma_f32_32x32x8_bf16 v[32:47], v[194:195], v[182:183], v[32:47]
  v_mfma_f32_32x32x8_bf16 v[48:63], v[194:195], v[186:187], v[48:63]
  v_mfma_f32_32x32x8_bf16 v[64:79], v[198:199], v[182:183], v[64:79]
  v_mfma_f32_32x32x8_bf16 v[80:95], v[198:199], v[186:187], v[80:95]
  s_lshl_b32 s61, s42, 1
  s_add_u32 s61, s61, 0
  s_lshl_b32 s61, s61, 1
  s_add_u32 s61, s61, s45
  s_mul_i32 s61, s61, 118
  s_mul_i32 s96, s43, 12
  s_add_u32 s61, s61, s96
  s_add_u32 s61, s61, 32
  s_lshl_b32 s96, s46, 1
  s_add_u32 s61, s61, s96
  s_lshl_b32 s61, s61, 10
  s_add_u32 s99, s61, 3145728
  s_lshl_b32 s61, s42, 1
  s_add_u32 s61, s61, 1
  s_lshl_b32 s61, s61, 1
  s_add_u32 s61, s61, s45
  s_mul_i32 s61, s61, 118
  s_mul_i32 s96, s43, 12
  s_add_u32 s61, s61, s96
  s_add_u32 s61, s61, 32
  s_lshl_b32 s96, s46, 1
  s_add_u32 s61, s61, s96
  s_lshl_b32 s61, s61, 10
  s_add_u32 s100, s61, 3145728
  v_cvt_pk_bf16_f32 v112, v0, v1
  v_cvt_pk_bf16_f32 v113, v2, v3
  v_cvt_pk_bf16_f32 v114, v4, v5
  v_cvt_pk_bf16_f32 v115, v6, v7
  v_pk_max_i16 v112, v112, 0
  v_pk_max_i16 v113, v113, 0
  v_pk_max_i16 v114, v114, 0
  v_pk_max_i16 v115, v115, 0
  v_or_b32 v112, v216, v112
  v_or_b32 v113, v217, v113
  v_or_b32 v114, v218, v114
  v_or_b32 v115, v219, v115
  buffer_store_dwordx4 v[112:115], v208, s[12:15], s99 offen offset:0 sc1
  v_cvt_pk_bf16_f32 v116, v8, v9
  v_cvt_pk_bf16_f32 v117, v10, v11
  v_cvt_pk_bf16_f32 v118, v12, v13
  v_cvt_pk_bf16_f32 v119, v14, v15
  v_pk_max_i16 v116, v116, 0
  v_pk_max_i16 v117, v117, 0
  v_pk_max_i16 v118, v118, 0
  v_pk_max_i16 v119, v119, 0
  v_or_b32 v116, v216, v116
  v_or_b32 v117, v217, v117
  v_or_b32 v118, v218, v118
  v_or_b32 v119, v219, v119
  buffer_store_dwordx4 v[116:119], v208, s[12:15], s99 offen offset:1024 sc1
  s_add_u32 s99, s99, 4096
  v_cvt_pk_bf16_f32 v120, v16, v17
  v_cvt_pk_bf16_f32 v121, v18, v19
  v_cvt_pk_bf16_f32 v122, v20, v21
  v_cvt_pk_bf16_f32 v123, v22, v23
  v_pk_max_i16 v120, v120, 0
  v_pk_max_i16 v121, v121, 0
  v_pk_max_i16 v122, v122, 0
  v_pk_max_i16 v123, v123, 0
  v_or_b32 v120, v216, v120
  v_or_b32 v121, v217, v121
  v_or_b32 v122, v218, v122
  v_or_b32 v123, v219, v123
  buffer_store_dwordx4 v[120:123], v208, s[12:15], s100 offen offset:0 sc1
  v_cvt_pk_bf16_f32 v124, v24, v25
  v_cvt_pk_bf16_f32 v125, v26, v27
  v_cvt_pk_bf16_f32 v126, v28, v29
  v_cvt_pk_bf16_f32 v127, v30, v31
  v_pk_max_i16 v124, v124, 0
  v_pk_max_i16 v125, v125, 0
  v_pk_max_i16 v126, v126, 0
  v_pk_max_i16 v127, v127, 0
  v_or_b32 v124, v216, v124
  v_or_b32 v125, v217, v125
  v_or_b32 v126, v218, v126
  v_or_b32 v127, v219, v127
  buffer_store_dwordx4 v[124:127], v208, s[12:15], s100 offen offset:1024 sc1
  s_add_u32 s100, s100, 4096
  v_cvt_pk_bf16_f32 v128, v32, v33
  v_cvt_pk_bf16_f32 v129, v34, v35
  v_cvt_pk_bf16_f32 v130, v36, v37
  v_cvt_pk_bf16_f32 v131, v38, v39
  v_pk_max_i16 v128, v128, 0
  v_pk_max_i16 v129, v129, 0
  v_pk_max_i16 v130, v130, 0
  v_pk_max_i16 v131, v131, 0
  v_or_b32 v128, v216, v128
  v_or_b32 v129, v217, v129
  v_or_b32 v130, v218, v130
  v_or_b32 v131, v219, v131
  buffer_store_dwordx4 v[128:131], v208, s[12:15], s99 offen offset:0 sc1
  v_cvt_pk_bf16_f32 v132, v40, v41
  v_cvt_pk_bf16_f32 v133, v42, v43
  v_cvt_pk_bf16_f32 v134, v44, v45
  v_cvt_pk_bf16_f32 v135, v46, v47
  v_pk_max_i16 v132, v132, 0
  v_pk_max_i16 v133, v133, 0
  v_pk_max_i16 v134, v134, 0
  v_pk_max_i16 v135, v135, 0
  v_or_b32 v132, v216, v132
  v_or_b32 v133, v217, v133
  v_or_b32 v134, v218, v134
  v_or_b32 v135, v219, v135
  buffer_store_dwordx4 v[132:135], v208, s[12:15], s99 offen offset:1024 sc1
  s_add_u32 s99, s99, 4096
  v_cvt_pk_bf16_f32 v136, v48, v49
  v_cvt_pk_bf16_f32 v137, v50, v51
  v_cvt_pk_bf16_f32 v138, v52, v53
  v_cvt_pk_bf16_f32 v139, v54, v55
  v_pk_max_i16 v136, v136, 0
  v_pk_max_i16 v137, v137, 0
  v_pk_max_i16 v138, v138, 0
  v_pk_max_i16 v139, v139, 0
  v_or_b32 v136, v216, v136
  v_or_b32 v137, v217, v137
  v_or_b32 v138, v218, v138
  v_or_b32 v139, v219, v139
  buffer_store_dwordx4 v[136:139], v208, s[12:15], s100 offen offset:0 sc1
  v_cvt_pk_bf16_f32 v140, v56, v57
  v_cvt_pk_bf16_f32 v141, v58, v59
  v_cvt_pk_bf16_f32 v142, v60, v61
  v_cvt_pk_bf16_f32 v143, v62, v63
  v_pk_max_i16 v140, v140, 0
  v_pk_max_i16 v141, v141, 0
  v_pk_max_i16 v142, v142, 0
  v_pk_max_i16 v143, v143, 0
  v_or_b32 v140, v216, v140
  v_or_b32 v141, v217, v141
  v_or_b32 v142, v218, v142
  v_or_b32 v143, v219, v143
  buffer_store_dwordx4 v[140:143], v208, s[12:15], s100 offen offset:1024 sc1
  s_add_u32 s100, s100, 4096
  v_cvt_pk_bf16_f32 v112, v64, v65
  v_cvt_pk_bf16_f32 v113, v66, v67
  v_cvt_pk_bf16_f32 v114, v68, v69
  v_cvt_pk_bf16_f32 v115, v70, v71
  v_pk_max_i16 v112, v112, 0
  v_pk_max_i16 v113, v113, 0
  v_pk_max_i16 v114, v114, 0
  v_pk_max_i16 v115, v115, 0
  v_or_b32 v112, v216, v112
  v_or_b32 v113, v217, v113
  v_or_b32 v114, v218, v114
  v_or_b32 v115, v219, v115
  buffer_store_dwordx4 v[112:115], v208, s[12:15], s99 offen offset:0 sc1
  v_cvt_pk_bf16_f32 v116, v72, v73
  v_cvt_pk_bf16_f32 v117, v74, v75
  v_cvt_pk_bf16_f32 v118, v76, v77
  v_cvt_pk_bf16_f32 v119, v78, v79
  v_pk_max_i16 v116, v116, 0
  v_pk_max_i16 v117, v117, 0
  v_pk_max_i16 v118, v118, 0
  v_pk_max_i16 v119, v119, 0
  v_or_b32 v116, v216, v116
  v_or_b32 v117, v217, v117
  v_or_b32 v118, v218, v118
  v_or_b32 v119, v219, v119
  buffer_store_dwordx4 v[116:119], v208, s[12:15], s99 offen offset:1024 sc1
  v_cvt_pk_bf16_f32 v120, v80, v81
  v_cvt_pk_bf16_f32 v121, v82, v83
  v_cvt_pk_bf16_f32 v122, v84, v85
  v_cvt_pk_bf16_f32 v123, v86, v87
  v_pk_max_i16 v120, v120, 0
  v_pk_max_i16 v121, v121, 0
  v_pk_max_i16 v122, v122, 0
  v_pk_max_i16 v123, v123, 0
  v_or_b32 v120, v216, v120
  v_or_b32 v121, v217, v121
  v_or_b32 v122, v218, v122
  v_or_b32 v123, v219, v123
  buffer_store_dwordx4 v[120:123], v208, s[12:15], s100 offen offset:0 sc1
  v_cvt_pk_bf16_f32 v124, v88, v89
  v_cvt_pk_bf16_f32 v125, v90, v91
  v_cvt_pk_bf16_f32 v126, v92, v93
  v_cvt_pk_bf16_f32 v127, v94, v95
  v_pk_max_i16 v124, v124, 0
  v_pk_max_i16 v125, v125, 0
  v_pk_max_i16 v126, v126, 0
  v_pk_max_i16 v127, v127, 0
  v_or_b32 v124, v216, v124
  v_or_b32 v125, v217, v125
  v_or_b32 v126, v218, v126
  v_or_b32 v127, v219, v127
  buffer_store_dwordx4 v[124:127], v208, s[12:15], s100 offen offset:1024 sc1
  buffer_load_dwordx4 a[124:127], v208, s[12:15], s89 offen offset:3072 sc1
  s_add_u32 s88, s88, 4096
  buffer_load_dwordx4 a[128:131], v208, s[12:15], s88 offen offset:0 sc1
  s_add_u32 s89, s89, 4096
  buffer_load_dwordx4 a[132:135], v208, s[12:15], s89 offen offset:0 sc1
  buffer_load_dwordx4 a[136:139], v208, s[12:15], s88 offen offset:1024 sc1
  buffer_load_dwordx4 a[140:143], v208, s[12:15], s89 offen offset:1024 sc1
  s_add_u32 s88, s88, s29
  buffer_load_dwordx4 a[144:147], v208, s[12:15], s88 offen offset:0 sc1
  s_add_u32 s89, s89, s29
  buffer_load_dwordx4 a[148:151], v208, s[12:15], s89 offen offset:0 sc1
  buffer_load_dwordx4 a[152:155], v208, s[12:15], s88 offen offset:1024 sc1
  buffer_load_dwordx4 a[156:159], v208, s[12:15], s89 offen offset:1024 sc1
  buffer_load_dwordx4 a[160:163], v208, s[12:15], s88 offen offset:2048 sc1
  buffer_load_dwordx4 a[164:167], v208, s[12:15], s89 offen offset:2048 sc1
  buffer_load_dwordx4 a[168:171], v208, s[12:15], s88 offen offset:3072 sc1
  buffer_load_dwordx4 a[172:175], v208, s[12:15], s89 offen offset:3072 sc1
  s_add_u32 s88, s88, s32
  buffer_load_dwordx4 a[176:179], v208, s[12:15], s88 offen offset:0 sc1
  s_add_u32 s89, s89, s32
  buffer_load_dwordx4 a[180:183], v208, s[12:15], s89 offen offset:0 sc1
  buffer_load_dwordx4 a[184:187], v208, s[12:15], s88 offen offset:1024 sc1
  buffer_load_dwordx4 a[188:191], v208, s[12:15], s89 offen offset:1024 sc1
  buffer_load_dwordx4 a[192:195], v208, s[12:15], s88 offen offset:2048 sc1
  buffer_load_dwordx4 a[196:199], v208, s[12:15], s89 offen offset:2048 sc1
  buffer_load_dwordx4 a[200:203], v208, s[12:15], s88 offen offset:3072 sc1
  buffer_load_dwordx4 a[204:207], v208, s[12:15], s89 offen offset:3072 sc1
  s_add_u32 s88, s88, 4096
  buffer_load_dwordx4 a[208:211], v208, s[12:15], s88 offen offset:0 sc1
  s_add_u32 s89, s89, 4096
  buffer_load_dwordx4 a[212:215], v208, s[12:15], s89 offen offset:0 sc1
  buffer_load_dwordx4 a[216:219], v208, s[12:15], s88 offen offset:1024 sc1
  buffer_load_dwordx4 a[220:223], v208, s[12:15], s89 offen offset:1024 sc1
  buffer_load_dwordx4 a[224:227], v208, s[12:15], s88 offen offset:2048 sc1
  buffer_load_dwordx4 a[228:231], v208, s[12:15], s89 offen offset:2048 sc1
  buffer_load_dwordx4 a[232:235], v208, s[12:15], s88 offen offset:3072 sc1
  buffer_load_dwordx4 a[236:239], v208, s[12:15], s89 offen offset:3072 sc1
L_stub_ffn_2:
  s_cmp_eq_u32 s86, 1
  s_cbranch_scc1 L_tret_ffn_2
  buffer_load_dwordx4 v[64:67], v181, s[12:15], s24 offen offset:0 sc1
  buffer_load_dwordx4 v[68:71], v239, s[12:15], s24 offen offset:0 sc1
  buffer_load_dwordx4 v[72:75], v181, s[12:15], s24 offen offset:1024 sc1
  buffer_load_dwordx4 v[76:79], v239, s[12:15], s24 offen offset:1024 sc1
  buffer_load_dwordx4 v[80:83], v181, s[12:15], s24 offen offset:2048 sc1
  buffer_load_dwordx4 v[84:87], v239, s[12:15], s24 offen offset:2048 sc1
  buffer_load_dwordx4 v[88:91], v181, s[12:15], s24 offen offset:3072 sc1
  buffer_load_dwordx4 v[92:95], v239, s[12:15], s24 offen offset:3072 sc1
  buffer_load_dwordx4 v[96:99], v181, s[12:15], s38 offen offset:0 sc1
  buffer_load_dwordx4 v[100:103], v239, s[12:15], s38 offen offset:0 sc1
  buffer_load_dwordx4 v[104:107], v181, s[12:15], s38 offen offset:1024 sc1
  buffer_load_dwordx4 v[108:111], v239, s[12:15], s38 offen offset:1024 sc1
  buffer_load_dwordx4 v[112:115], v181, s[12:15], s38 offen offset:2048 sc1
  buffer_load_dwordx4 v[116:119], v239, s[12:15], s38 offen offset:2048 sc1
  buffer_load_dwordx4 v[120:123], v181, s[12:15], s38 offen offset:3072 sc1
  buffer_load_dwordx4 v[124:127], v239, s[12:15], s38 offen offset:3072 sc1
  s_mov_b32 s37, 0x80008000
  s_mov_b32 s58, 0
  s_branch L_p2
.p2align 12
L_att:
  s_lshl_b32 s61, s44, 1
  s_add_u32 s61, s61, s46
  s_lshl_b32 s96, s45, 6
  s_add_u32 s61, s61, s96
  s_lshl_b32 s61, s61, 10
  v_lshrrev_b32 v1, 3, v209
  v_lshrrev_b32 v2, 4, v209
  v_and_b32 v3, 7, v209
  v_xor_b32 v3, v3, v2
  v_lshlrev_b32 v1, 11, v1
  v_add_u32 v1, s61, v1
  v_lshl_add_u32 v170, v3, 4, v1
  v_xor_b32 v3, 4, v3
  v_lshl_add_u32 v171, v3, 4, v1
  v_add_u32 v171, 0x4000, v171
  v_add_u32 v172, 0x8000, v170
  v_add_u32 v173, 0x8000, v171
  s_lshl_b32 s54, s3, 12
  s_mul_i32 s55, s3, 6144
  s_add_u32 s55, s55, 0x4000
  s_mul_i32 s96, s3, 49152
  s_mul_i32 s97, s43, 128
  s_add_u32 s96, s96, s97
  v_add_u32 v1, 0, v209
  v_mul_u32_u24 v2, 171, v1
  v_lshrrev_b32 v2, 12, v2
  v_mul_u32_u24 v3, 24, v2
  v_sub_u32 v1, v1, v3
  v_lshrrev_b32 v3, 2, v1
  v_bfe_u32 v4, v2, 1, 1
  v_xor_b32 v3, v3, v4
  v_and_b32 v1, 3, v1
  v_mul_u32_u24 v2, 3072, v2
  v_lshl_add_u32 v1, v1, 4, v2
  v_lshrrev_b32 v4, 1, v3
  v_and_b32 v3, 1, v3
  v_lshl_add_u32 v1, v4, 10, v1
  v_lshl_add_u32 v1, v3, 6, v1
  v_add_u32 v174, s96, v1
  v_add_u32 v1, 64, v209
  v_mul_u32_u24 v2, 171, v1
  v_lshrrev_b32 v2, 12, v2
  v_mul_u32_u24 v3, 24, v2
  v_sub_u32 v1, v1, v3
  v_lshrrev_b32 v3, 2, v1
  v_bfe_u32 v4, v2, 1, 1
  v_xor_b32 v3, v3, v4
  v_and_b32 v1, 3, v1
  v_mul_u32_u24 v2, 3072, v2
  v_lshl_add_u32 v1, v1, 4, v2
  v_lshrrev_b32 v4, 1, v3
  v_and_b32 v3, 1, v3
  v_lshl_add_u32 v1, v4, 10, v1
  v_lshl_add_u32 v1, v3, 6, v1
  v_add_u32 v175, s96, v1
  v_add_u32 v1, 128, v209
  v_mul_u32_u24 v2, 171, v1
  v_lshrrev_b32 v2, 12, v2
  v_mul_u32_u24 v3, 24, v2
  v_sub_u32 v1, v1, v3
  v_lshrrev_b32 v3, 2, v1
  v_bfe_u32 v4, v2, 1, 1
  v_xor_b32 v3, v3, v4
  v_and_b32 v1, 3, v1
  v_mul_u32_u24 v2, 3072, v2
  v_lshl_add_u32 v1, v1, 4, v2
  v_lshrrev_b32 v4, 1, v3
  v_and_b32 v3, 1, v3
  v_lshl_add_u32 v1, v4, 10, v1
  v_lshl_add_u32 v1, v3, 6, v1
  v_add_u32 v176, s96, v1
  s_waitcnt lgkmcnt(0)
  s_mov_b32 s4, s24
  s_and_b32 s5, s25, 0xffff
  s_mov_b32 s6, 2097152
  s_mov_b32 s7, 0x00020000
  s_mov_b32 s8, s26
  s_and_b32 s9, s27, 0xffff
  s_mov_b32 s10, 1572864
  s_mov_b32 s11, 0x00020000
  s_mov_b32 s12, s38
  s_and_b32 s13, s39, 0xffff
  s_mov_b32 s14, 0x10000000
  s_mov_b32 s15, 0x00020000
  s_mov_b32 s16, s36
  s_and_b32 s17, s37, 0xffff
  s_mov_b32 s18, 2097152
  s_mov_b32 s19, 0x00020000
  s_mov_b32 s51, 0
  s_mov_b32 s52, 0
  s_mov_b32 s53, 24576
  s_add_u32 m0, s54, 0
  s_nop 0
  buffer_load_dwordx4 v170, s[4:7], s51 offen lds
  s_and_b32 s61, s40, 1
  s_lshl_b32 s61, s61, 9
  s_lshr_b32 s96, s40, 1
  s_lshl_b32 s96, s96, 7
  s_add_u32 s61, s61, s96
  s_lshl_b32 s96, s41, 2
  s_add_u32 s61, s61, s96
  s_add_u32 s61, s61, s3
  s_lshl_b32 s90, s61, 11
  s_mul_i32 s61, s101, 2185
  s_add_u32 m0, s54, 1024
  s_nop 0
  buffer_load_dwordx4 v171, s[4:7], s51 offen lds
  s_lshr_b32 s61, s61, 16
  s_mul_i32 s96, s61, 30
  s_sub_u32 s96, s101, s96
  s_lshl_b32 s96, s96, 2
  s_add_u32 s96, s96, s3
  s_mul_i32 s97, s61, 240
  s_add_u32 s97, s97, s96
  s_lshl_b32 s97, s97, 10
  s_add_u32 s91, s97, 262144
  s_lshl_b32 s61, s61, 7
  s_add_u32 m0, s54, 2048
  s_nop 0
  buffer_load_dwordx4 v172, s[4:7], s51 offen lds
  v_and_b32 v1, 7, v209
  v_lshlrev_b32 v1, 4, v1
  v_add_u32 v1, s61, v1
  v_lshrrev_b32 v2, 3, v209
  v_lshl_add_u32 v16, v2, 10, v1
  v_and_b32 v3, 3, v2
  v_lshrrev_b32 v2, 2, v2
  v_lshl_add_u32 v3, v2, 3, v3
  v_lshl_add_u32 v17, v3, 10, v1
  s_mov_b32 s99, s96
  s_add_u32 m0, s54, 3072
  s_nop 0
  buffer_load_dwordx4 v173, s[4:7], s51 offen lds
  s_mov_b32 s23, 0x00020000
  s_cmp_lt_u32 s99, 32
  s_cbranch_scc1 L_b2o_13
  s_mov_b32 s20, s34
  s_and_b32 s21, s35, 0xffff
  s_mov_b32 s22, 1409024
  s_sub_u32 s99, s99, 32
  s_lshl_b32 s99, s99, 14
  s_add_u32 s100, s99, 4096
  v_mov_b32 v16, v17
  s_mov_b32 s37, 0x80008000
  s_branch L_b2s_14
L_b2o_13:
  s_mov_b32 s20, s28
  s_and_b32 s21, s29, 0xffff
  s_mov_b32 s22, 524288
  s_lshl_b32 s99, s99, 14
  s_add_u32 s100, s99, 8192
  s_mov_b32 s37, 0
L_b2s_14:
  s_add_u32 m0, s55, 0
  s_nop 0
  buffer_load_dwordx4 v174, s[8:11], s52 offen lds
  v_and_b32 v1, 31, v209
  s_lshl_b32 s61, s45, 6
  v_add_u32 v1, s61, v1
  v_lshlrev_b32 v1, 7, v1
  v_bfe_u32 v2, v209, 1, 3
  v_lshrrev_b32 v3, 5, v209
  v_xor_b32 v2, v2, v3
  v_xor_b32 v4, 0, v2
  v_lshl_add_u32 v160, v4, 4, v1
  v_xor_b32 v4, 2, v2
  s_add_u32 m0, s55, 1024
  s_nop 0
  buffer_load_dwordx4 v175, s[8:11], s52 offen lds
  v_lshl_add_u32 v161, v4, 4, v1
  v_xor_b32 v4, 4, v2
  v_lshl_add_u32 v162, v4, 4, v1
  v_xor_b32 v4, 6, v2
  v_lshl_add_u32 v163, v4, 4, v1
  v_bfe_u32 v1, v209, 2, 2
  v_lshrrev_b32 v2, 5, v209
  v_lshl_add_u32 v1, v2, 3, v1
  v_mul_u32_u24 v1, 384, v1
  v_bfe_u32 v2, v209, 4, 1
  s_add_u32 m0, s55, 2048
  s_nop 0
  buffer_load_dwordx4 v176, s[8:11], s52 offen lds
  v_lshl_add_u32 v1, v2, 5, v1
  v_and_b32 v2, 3, v209
  v_lshl_add_u32 v1, v2, 3, v1
  v_add_u32 v1, 0x4000, v1
  v_bfe_u32 v2, v209, 3, 1
  v_xor_b32 v2, s46, v2
  v_lshl_add_u32 v168, v2, 6, v1
  s_add_u32 m0, s55, 3072
  s_nop 0
  buffer_load_dwordx4 v174, s[8:11], s53 offen lds
  s_add_u32 m0, s55, 4096
  s_nop 0
  buffer_load_dwordx4 v175, s[8:11], s53 offen lds
  s_add_u32 m0, s55, 5120
  s_nop 0
  buffer_load_dwordx4 v176, s[8:11], s53 offen lds
  s_lshl_b32 m0, s3, 11
  s_add_u32 m0, m0, 155648
  s_nop 0
  buffer_load_dwordx4 v16, s[20:23], s99 offen lds
  s_add_u32 m0, m0, 1024
  s_nop 0
  buffer_load_dwordx4 v16, s[20:23], s100 offen lds
  v_mov_b32 v210, 0
  buffer_load_dword v210, v210, s[12:15], 0 offen sc1
  s_mov_b32 s51, 128
  s_mov_b32 s52, 196608
  s_mov_b32 s53, 221184
  s_add_u32 m0, s54, 40960
  s_nop 0
  buffer_load_dwordx4 v170, s[4:7], s51 offen lds
  s_add_u32 m0, s54, 41984
  s_nop 0
  buffer_load_dwordx4 v171, s[4:7], s51 offen lds
  s_add_u32 m0, s54, 43008
  s_nop 0
  buffer_load_dwordx4 v172, s[4:7], s51 offen lds
  s_add_u32 m0, s54, 44032
  s_nop 0
  buffer_load_dwordx4 v173, s[4:7], s51 offen lds
  s_add_u32 m0, s55, 40960
  s_nop 0
  buffer_load_dwordx4 v174, s[8:11], s52 offen lds
  s_add_u32 m0, s55, 41984
  s_nop 0
  buffer_load_dwordx4 v175, s[8:11], s52 offen lds
  s_add_u32 m0, s55, 43008
  s_nop 0
  buffer_load_dwordx4 v176, s[8:11], s52 offen lds
  s_add_u32 m0, s55, 44032
  s_nop 0
  buffer_load_dwordx4 v174, s[8:11], s53 offen lds
  s_add_u32 m0, s55, 45056
  s_nop 0
  buffer_load_dwordx4 v175, s[8:11], s53 offen lds
  s_add_u32 m0, s55, 46080
  s_nop 0
  buffer_load_dwordx4 v176, s[8:11], s53 offen lds
  s_cmp_lg_u32 s3, 1
  s_cbranch_scc1 L_tskip_att_0
  s_mov_b32 s86, 1
  s_branch L_stub_att_0
L_tret_att_0:
  s_mov_b32 s86, 0
L_tskip_att_0:
  s_cmp_lg_u32 s3, 2
  s_cbranch_scc1 L_tskip_att_1
  s_mov_b32 s86, 1
  s_branch L_stub_att_1
L_tret_att_1:
  s_mov_b32 s86, 0
L_tskip_att_1:
  s_cmp_lg_u32 s3, 3
  s_cbranch_scc1 L_tskip_att_2
  s_mov_b32 s86, 1
  s_branch L_stub_att_2
L_tret_att_2:
  s_mov_b32 s86, 0
L_tskip_att_2:
  s_mov_b32 s51, 256
  s_mov_b32 s52, 393216
  s_mov_b32 s53, 417792
  s_add_u32 m0, s54, 81920
  s_nop 0
  buffer_load_dwordx4 v170, s[4:7], s51 offen lds
  s_add_u32 m0, s54, 82944
  s_nop 0
  buffer_load_dwordx4 v171, s[4:7], s51 offen lds
  s_add_u32 m0, s54, 83968
  s_nop 0
  buffer_load_dwordx4 v172, s[4:7], s51 offen lds
  s_add_u32 m0, s54, 84992
  s_nop 0
  buffer_load_dwordx4 v173, s[4:7], s51 offen lds
  s_add_u32 m0, s55, 81920
  s_nop 0
  buffer_load_dwordx4 v174, s[8:11], s52 offen lds
  s_add_u32 m0, s55, 82944
  s_nop 0
  buffer_load_dwordx4 v175, s[8:11], s52 offen lds
  s_add_u32 m0, s55, 83968
  s_nop 0
  buffer_load_dwordx4 v176, s[8:11], s52 offen lds
  v_lshrrev_b32 v1, 5, v209
  v_bfe_u32 v2, v209, 2, 2
  v_lshl_add_u32 v1, v1, 3, v2
  v_lshlrev_b32 v1, 7, v1
  v_and_b32 v2, 1, v209
  v_lshl_add_u32 v1, v2, 5, v1
  v_bfe_u32 v2, v209, 4, 1
  v_lshl_add_u32 v1, v2, 4, v1
  v_bfe_u32 v2, v209, 1, 1
  v_lshl_add_u32 v1, v2, 3, v1
  s_lshl_b32 s61, s3, 11
  s_add_u32 s61, s61, 155648
  v_add_u32 v1, s61, v1
  s_waitcnt vmcnt(18)
  ds_read_b64_tr_b16 v[20:21], v1 offset:0
  ds_read_b64_tr_b16 v[22:23], v1 offset:512
  ds_read_b64_tr_b16 v[24:25], v1 offset:64
  ds_read_b64_tr_b16 v[26:27], v1 offset:576
  s_waitcnt vmcnt(17)
  v_readfirstlane_b32 s56, v210
  s_nop 0
  s_mul_i32 s56, s56, 0x9E3779B1
  s_add_u32 s56, s56, 0x7F4A7C15
  s_not_b32 s57, s56
  s_and_b32 s61, s56, 63
  s_lshr_b32 s96, s56, 6
  s_and_b32 s96, s96, 62
  s_and_b32 s97, s56, 1
  s_or_b32 s96, s96, s97
  s_lshl_b32 s96, s96, 8
  s_or_b32 s61, s61, s96
  v_lshrrev_b32 v2, 5, v209
  v_lshlrev_b32 v2, 3, v2
  v_lshrrev_b32 v2, v2, s61
  v_lshlrev_b32 v3, 15, v2
  v_lshl_or_b32 v3, v2, 30, v3
  v_and_b32 v28, s37, v3
  v_lshrrev_b32 v2, 2, v2
  v_lshlrev_b32 v3, 15, v2
  v_lshl_or_b32 v3, v2, 30, v3
  v_and_b32 v30, s37, v3
  v_lshrrev_b32 v2, 2, v2
  v_lshlrev_b32 v3, 15, v2
  v_lshl_or_b32 v3, v2, 30, v3
  v_and_b32 v31, s37, v3
  v_xor_b32 v29, s37, v28
  s_add_u32 s61, s91, 122880
  s_waitcnt lgkmcnt(0)
  v_xor_b32 v20, v28, v20
  v_xor_b32 v21, v29, v21
  v_xor_b32 v22, v30, v22
  v_xor_b32 v23, v31, v23
  v_xor_b32 v24, v28, v24
  v_xor_b32 v25, v29, v25
  v_xor_b32 v26, v30, v26
  v_xor_b32 v27, v31, v27
  buffer_store_dwordx4 v[20:23], v208, s[12:15], s91 offen sc1
  buffer_store_dwordx4 v[24:27], v208, s[12:15], s61 offen sc1
  s_barrier
  ds_read_b128 v[112:115], v160
  ds_read_b64_tr_b16 v[128:129], v168 offset:0
  ds_read_b64_tr_b16 v[130:131], v168 offset:1536
  ds_read_b64_tr_b16 v[132:133], v168 offset:128
  ds_read_b64_tr_b16 v[134:135], v168 offset:1664
  ds_read_b64_tr_b16 v[136:137], v168 offset:256
  ds_read_b64_tr_b16 v[138:139], v168 offset:1792
  ds_read_b128 v[116:119], v160 offset:4096
  s_waitcnt lgkmcnt(5)
  v_mfma_f32_32x32x16_bf16 v[0:15], v[128:131], v[112:115], 0
  ds_read_b128 v[120:123], v161
  ds_read_b64_tr_b16 v[144:145], v168 offset:6144
  v_min_u32 v183, 29, v209
  s_mul_i32 s61, s60, 30
  s_add_u32 m0, s55, 84992
  s_waitcnt lgkmcnt(5)
  v_mfma_f32_32x32x16_bf16 v[32:47], v[132:135], v[112:115], 0
  buffer_load_dwordx4 v174, s[8:11], s53 offen lds
  ds_read_b64_tr_b16 v[146:147], v168 offset:7680
  ds_read_b64_tr_b16 v[148:149], v168 offset:6272
  v_add_u32 v183, s61, v183
  v_lshlrev_b32 v183, 3, v183
  s_waitcnt lgkmcnt(5)
  v_mfma_f32_32x32x16_bf16 v[64:79], v[112:115], v[136:139], 0
  ds_read_b64_tr_b16 v[150:151], v168 offset:7808
  ds_read_b64_tr_b16 v[152:153], v168 offset:6400
  v_add_u32 v215, 12288, v183
  v_and_b32 v182, 31, v209
  s_lshl_b32 s61, s45, 10
  s_waitcnt lgkmcnt(6)
  v_mfma_f32_32x32x16_bf16 v[16:31], v[128:131], v[116:119], 0
  ds_read_b64_tr_b16 v[154:155], v168 offset:7936
  ds_read_b128 v[124:127], v161 offset:4096
  s_add_u32 s96, s44, 0
  v_add_u32 v183, s96, v182
  s_add_u32 m0, s55, 86016
  v_mfma_f32_32x32x16_bf16 v[48:63], v[132:135], v[116:119], 0
  buffer_load_dwordx4 v175, s[8:11], s53 offen lds
  v_min_u32 v183, 0x3ff, v183
  v_add_u32 v183, s61, v183
  v_lshlrev_b32 v183, 4, v183
  v_add_u32 v211, 65536, v183
  v_mfma_f32_32x32x16_bf16 v[80:95], v[116:119], v[136:139], 0
  s_add_u32 s96, s44, 32
  v_add_u32 v183, s96, v182
  v_min_u32 v183, 0x3ff, v183
  v_add_u32 v183, s61, v183
  v_lshlrev_b32 v183, 4, v183
  s_waitcnt lgkmcnt(5)
  v_mfma_f32_32x32x16_bf16 v[0:15], v[144:147], v[120:123], v[0:15]
  ds_read_b128 v[112:115], v162
  ds_read_b64_tr_b16 v[128:129], v168 offset:12288
  v_add_u32 v160, 0xa000, v160
  v_add_u32 v161, 0xa000, v161
  s_add_u32 m0, s55, 87040
  s_waitcnt lgkmcnt(5)
  v_mfma_f32_32x32x16_bf16 v[32:47], v[148:151], v[120:123], v[32:47]
  buffer_load_dwordx4 v176, s[8:11], s53 offen lds
  ds_read_b64_tr_b16 v[130:131], v168 offset:13824
  ds_read_b64_tr_b16 v[132:133], v168 offset:12416
  v_add_u32 v212, 65536, v183
  v_lshrrev_b32 v183, 5, v209
  s_waitcnt lgkmcnt(5)
  v_mfma_f32_32x32x16_bf16 v[64:79], v[120:123], v[152:155], v[64:79]
  ds_read_b64_tr_b16 v[134:135], v168 offset:13952
  ds_read_b64_tr_b16 v[136:137], v168 offset:12544
  v_mul_u32_u24 v183, 2944, v183
  v_add_u32 v183, v183, v182
  s_lshl_b32 s61, s43, 6
  s_waitcnt lgkmcnt(6)
  v_mfma_f32_32x32x16_bf16 v[16:31], v[144:147], v[124:127], v[16:31]
  buffer_load_dwordx4 v[190:193], v208, s[4:7], s90 offen
  ds_read_b64_tr_b16 v[138:139], v168 offset:14080
  ds_read_b128 v[116:119], v162 offset:4096
  s_lshl_b32 s96, s46, 5
  s_add_u32 s61, s61, s96
  v_mfma_f32_32x32x16_bf16 v[48:63], v[148:151], v[124:127], v[48:63]
  v_add_u32 v184, s61, v183
  v_lshlrev_b32 v184, 4, v184
  v_add_u32 v213, 131072, v184
  s_lshl_b32 s61, s60, 1
  s_add_u32 s61, s61, s46
  v_mfma_f32_32x32x16_bf16 v[80:95], v[124:127], v[152:155], v[80:95]
  buffer_load_dwordx4 v[194:197], v208, s[4:7], s90 offen offset:1024
  s_mul_i32 s97, s61, 122880
  s_xor_b32 s61, s61, 1
  s_mul_i32 s98, s61, 122880
  s_mul_i32 s96, s3, 18432
  s_waitcnt lgkmcnt(5)
  v_mfma_f32_32x32x16_bf16 v[0:15], v[128:131], v[112:115], v[0:15]
  ds_read_b128 v[120:123], v163
  ds_read_b64_tr_b16 v[144:145], v168 offset:18432
  v_add_u32 v162, 0xa000, v162
  s_add_u32 s96, s96, 294912
  s_add_u32 s88, s97, s96
  s_waitcnt lgkmcnt(5)
  v_mfma_f32_32x32x16_bf16 v[32:47], v[132:135], v[112:115], v[32:47]
  ds_read_b64_tr_b16 v[146:147], v168 offset:19968
  ds_read_b64_tr_b16 v[148:149], v168 offset:18560
  s_add_u32 s89, s98, s96
  s_mul_i32 s29, s3, -14336
  s_add_u32 s29, s29, 57344
  s_waitcnt lgkmcnt(5)
  v_mfma_f32_32x32x16_bf16 v[64:79], v[112:115], v[136:139], v[64:79]
  ds_read_b64_tr_b16 v[150:151], v168 offset:20096
  ds_read_b64_tr_b16 v[152:153], v168 offset:18688
  s_lshl_b32 s32, s3, 12
  s_sub_u32 s32, s32, 106496
  s_waitcnt lgkmcnt(6)
  v_mfma_f32_32x32x16_bf16 v[16:31], v[128:131], v[116:119], v[16:31]
  ds_read_b64_tr_b16 v[154:155], v168 offset:20224
  ds_read_b128 v[124:127], v163 offset:4096
  v_mfma_f32_32x32x16_bf16 v[48:63], v[132:135], v[116:119], v[48:63]
  v_mfma_f32_32x32x16_bf16 v[80:95], v[116:119], v[136:139], v[80:95]
  v_add_u32 v163, 0xa000, v163
  v_add_u32 v168, 0xa000, v168
  s_waitcnt vmcnt(5)
  s_waitcnt lgkmcnt(0)
  s_barrier
  s_cmp_eq_u32 s3, 0
  s_cbranch_scc0 L_nob2pub_15
  s_lshl_b32 s36, s101, 3
  s_add_u32 s36, s36, 12288
  v_mov_b32 v253, s36
  v_mov_b32 v252, 2147483392
  v_cmp_gt_u32 s[30:31], 1, v209
  s_nop 1
  v_cndmask_b32 v253, v252, v253, s[30:31]
  v_mov_b32 v254, s56
  v_mov_b32 v255, s57
  buffer_store_dwordx2 v[254:255], v253, s[12:15], 0 offen sc1
L_nob2pub_15:
  s_mov_b32 s51, 384
  s_mov_b32 s52, 589824
  s_mov_b32 s53, 614400
  v_mfma_f32_32x32x16_bf16 v[0:15], v[144:147], v[120:123], v[0:15]
  ds_read_b128 v[112:115], v160
  ds_read_b64_tr_b16 v[128:129], v168 offset:0
  s_add_u32 m0, s54, 0
  v_mfma_f32_32x32x16_bf16 v[32:47], v[148:151], v[120:123], v[32:47]
  buffer_load_dwordx4 v170, s[4:7], s51 offen lds
  ds_read_b64_tr_b16 v[130:131], v168 offset:1536
  ds_read_b64_tr_b16 v[132:133], v168 offset:128
  v_mfma_f32_32x32x16_bf16 v[64:79], v[120:123], v[152:155], v[64:79]
  ds_read_b64_tr_b16 v[134:135], v168 offset:1664
  ds_read_b64_tr_b16 v[136:137], v168 offset:256
  s_add_u32 m0, s54, 1024
  v_mfma_f32_32x32x16_bf16 v[16:31], v[144:147], v[124:127], v[16:31]
  buffer_load_dwordx4 v171, s[4:7], s51 offen lds
  ds_read_b64_tr_b16 v[138:139], v168 offset:1792
  ds_read_b128 v[116:119], v160 offset:4096
  v_mfma_f32_32x32x16_bf16 v[48:63], v[148:151], v[124:127], v[48:63]
  s_add_u32 m0, s54, 2048
  v_mfma_f32_32x32x16_bf16 v[80:95], v[124:127], v[152:155], v[80:95]
  buffer_load_dwordx4 v172, s[4:7], s51 offen lds
  s_waitcnt lgkmcnt(5)
  v_mfma_f32_32x32x16_bf16 v[0:15], v[128:131], v[112:115], v[0:15]
  ds_read_b128 v[120:123], v161
  ds_read_b64_tr_b16 v[144:145], v168 offset:6144
  s_add_u32 m0, s54, 3072
  s_waitcnt lgkmcnt(5)
  v_mfma_f32_32x32x16_bf16 v[32:47], v[132:135], v[112:115], v[32:47]
  buffer_load_dwordx4 v173, s[4:7], s51 offen lds
  ds_read_b64_tr_b16 v[146:147], v168 offset:7680
  ds_read_b64_tr_b16 v[148:149], v168 offset:6272
  s_waitcnt lgkmcnt(5)
  v_mfma_f32_32x32x16_bf16 v[64:79], v[112:115], v[136:139], v[64:79]
  ds_read_b64_tr_b16 v[150:151], v168 offset:7808
  ds_read_b64_tr_b16 v[152:153], v168 offset:6400
  s_waitcnt lgkmcnt(6)
  v_mfma_f32_32x32x16_bf16 v[16:31], v[128:131], v[116:119], v[16:31]
  ds_read_b64_tr_b16 v[154:155], v168 offset:7936
  ds_read_b128 v[124:127], v161 offset:4096
  s_add_u32 m0, s55, 0
  v_mfma_f32_32x32x16_bf16 v[48:63], v[132:135], v[116:119], v[48:63]
  buffer_load_dwordx4 v174, s[8:11], s52 offen lds
  v_mfma_f32_32x32x16_bf16 v[80:95], v[116:119], v[136:139], v[80:95]
  s_waitcnt lgkmcnt(5)
  v_mfma_f32_32x32x16_bf16 v[0:15], v[144:147], v[120:123], v[0:15]
  ds_read_b128 v[112:115], v162
  ds_read_b64_tr_b16 v[128:129], v168 offset:12288
  v_add_u32 v160, 0xa000, v160
  v_add_u32 v161, 0xa000, v161
  s_add_u32 m0, s55, 1024
  s_waitcnt lgkmcnt(5)
  v_mfma_f32_32x32x16_bf16 v[32:47], v[148:151], v[120:123], v[32:47]
  buffer_load_dwordx4 v175, s[8:11], s52 offen lds
  ds_read_b64_tr_b16 v[130:131], v168 offset:13824
  ds_read_b64_tr_b16 v[132:133], v168 offset:12416
  s_waitcnt lgkmcnt(5)
  v_mfma_f32_32x32x16_bf16 v[64:79], v[120:123], v[152:155], v[64:79]
  ds_read_b64_tr_b16 v[134:135], v168 offset:13952
  ds_read_b64_tr_b16 v[136:137], v168 offset:12544
  s_waitcnt lgkmcnt(6)
  v_mfma_f32_32x32x16_bf16 v[16:31], v[144:147], v[124:127], v[16:31]
  ds_read_b64_tr_b16 v[138:139], v168 offset:14080
  ds_read_b128 v[116:119], v162 offset:4096
  s_add_u32 m0, s55, 2048
  v_mfma_f32_32x32x16_bf16 v[48:63], v[148:151], v[124:127], v[48:63]
  buffer_load_dwordx4 v176, s[8:11], s52 offen lds
  v_mfma_f32_32x32x16_bf16 v[80:95], v[124:127], v[152:155], v[80:95]
  s_waitcnt lgkmcnt(5)
  v_mfma_f32_32x32x16_bf16 v[0:15], v[128:131], v[112:115], v[0:15]
  ds_read_b128 v[120:123], v163
  ds_read_b64_tr_b16 v[144:145], v168 offset:18432
  v_add_u32 v162, 0xa000, v162
  s_waitcnt vmcnt(7)
  s_add_u32 m0, s55, 3072
  s_waitcnt lgkmcnt(5)
  v_mfma_f32_32x32x16_bf16 v[32:47], v[132:135], v[112:115], v[32:47]
  buffer_load_dwordx4 v174, s[8:11], s53 offen lds
  ds_read_b64_tr_b16 v[146:147], v168 offset:19968
  ds_read_b64_tr_b16 v[148:149], v168 offset:18560
  v_mov_b32 v182, 0x3f803f80
  v_mov_b32 v198, 0
  s_waitcnt lgkmcnt(5)
  v_mfma_f32_32x32x16_bf16 v[64:79], v[112:115], v[136:139], v[64:79]
  ds_read_b64_tr_b16 v[150:151], v168 offset:20096
  ds_read_b64_tr_b16 v[152:153], v168 offset:18688
  v_mov_b32 v199, 0
  v_mov_b32 v200, 0
  s_add_u32 m0, s55, 4096
  s_waitcnt lgkmcnt(6)
  v_mfma_f32_32x32x16_bf16 v[16:31], v[128:131], v[116:119], v[16:31]
  buffer_load_dwordx4 v175, s[8:11], s53 offen lds
  ds_read_b64_tr_b16 v[154:155], v168 offset:20224
  ds_read_b128 v[124:127], v163 offset:4096
  v_mov_b32 v201, 0
  v_dot2c_f32_bf16 v198, v190, v182
  v_mfma_f32_32x32x16_bf16 v[48:63], v[132:135], v[116:119], v[48:63]
  v_dot2c_f32_bf16 v199, v190, v190
  v_dot2c_f32_bf16 v200, v194, v182
  v_dot2c_f32_bf16 v201, v194, v194
  v_dot2c_f32_bf16 v198, v191, v182
  s_add_u32 m0, s55, 5120
  v_mfma_f32_32x32x16_bf16 v[80:95], v[116:119], v[136:139], v[80:95]
  buffer_load_dwordx4 v176, s[8:11], s53 offen lds
  v_dot2c_f32_bf16 v199, v191, v191
  v_dot2c_f32_bf16 v200, v195, v182
  v_dot2c_f32_bf16 v201, v195, v195
  v_dot2c_f32_bf16 v198, v192, v182
  v_add_u32 v163, 0xa000, v163
  v_add_u32 v168, 0xa000, v168
  s_waitcnt lgkmcnt(0)
  s_barrier
  s_mov_b32 s51, 512
  s_mov_b32 s52, 786432
  s_mov_b32 s53, 811008
  v_mfma_f32_32x32x16_bf16 v[0:15], v[144:147], v[120:123], v[0:15]
  ds_read_b128 v[112:115], v160
  ds_read_b64_tr_b16 v[128:129], v168 offset:0
  v_dot2c_f32_bf16 v199, v192, v192
  v_dot2c_f32_bf16 v200, v196, v182
  s_add_u32 m0, s54, 40960
  v_mfma_f32_32x32x16_bf16 v[32:47], v[148:151], v[120:123], v[32:47]
  buffer_load_dwordx4 v170, s[4:7], s51 offen lds
  ds_read_b64_tr_b16 v[130:131], v168 offset:1536
  ds_read_b64_tr_b16 v[132:133], v168 offset:128
  v_dot2c_f32_bf16 v201, v196, v196
  v_dot2c_f32_bf16 v198, v193, v182
  v_mfma_f32_32x32x16_bf16 v[64:79], v[120:123], v[152:155], v[64:79]
  ds_read_b64_tr_b16 v[134:135], v168 offset:1664
  ds_read_b64_tr_b16 v[136:137], v168 offset:256
  v_dot2c_f32_bf16 v199, v193, v193
  v_dot2c_f32_bf16 v200, v197, v182
  s_add_u32 m0, s54, 41984
  v_mfma_f32_32x32x16_bf16 v[16:31], v[144:147], v[124:127], v[16:31]
  buffer_load_dwordx4 v171, s[4:7], s51 offen lds
  ds_read_b64_tr_b16 v[138:139], v168 offset:1792
  ds_read_b128 v[116:119], v160 offset:4096
  v_dot2c_f32_bf16 v201, v197, v197
  s_lshr_b32 s61, s90, 11
  v_mfma_f32_32x32x16_bf16 v[48:63], v[148:151], v[124:127], v[48:63]
  v_lshrrev_b32 v202, 5, v209
  v_lshl_add_u32 v202, v202, 10, s61
  v_lshlrev_b32 v202, 4, v202
  v_permlane32_swap_b32 v198, v200
  s_add_u32 m0, s54, 43008
  v_mfma_f32_32x32x16_bf16 v[80:95], v[124:127], v[152:155], v[80:95]
  buffer_load_dwordx4 v172, s[4:7], s51 offen lds
  v_permlane32_swap_b32 v199, v201
  v_add_u32 v202, 65536, v202
  v_and_b32 v203, 31, v209
  v_add_f32 v198, v198, v200
  s_waitcnt lgkmcnt(5)
  v_mfma_f32_32x32x16_bf16 v[0:15], v[128:131], v[112:115], v[0:15]
  ds_read_b128 v[120:123], v161
  ds_read_b64_tr_b16 v[144:145], v168 offset:6144
  v_add_f32 v199, v199, v201
  v_mov_b32 v186, 2147483392
  s_add_u32 m0, s54, 44032
  s_waitcnt lgkmcnt(5)
  v_mfma_f32_32x32x16_bf16 v[32:47], v[132:135], v[112:115], v[32:47]
  buffer_load_dwordx4 v173, s[4:7], s51 offen lds
  ds_read_b64_tr_b16 v[146:147], v168 offset:7680
  ds_read_b64_tr_b16 v[148:149], v168 offset:6272
  v_cmp_eq_u32 vcc, 0, v203
  v_permlane16_swap_b32 v198, v199
  s_waitcnt lgkmcnt(5)
  v_mfma_f32_32x32x16_bf16 v[64:79], v[112:115], v[136:139], v[64:79]
  ds_read_b64_tr_b16 v[150:151], v168 offset:7808
  ds_read_b64_tr_b16 v[152:153], v168 offset:6400
  v_cndmask_b32 v202, v186, v202, vcc
  v_mov_b32 v185, s56
  v_add_f32 v198, v198, v199
  s_waitcnt lgkmcnt(6)
  v_mfma_f32_32x32x16_bf16 v[16:31], v[128:131], v[116:119], v[16:31]
  ds_read_b64_tr_b16 v[154:155], v168 offset:7936
  ds_read_b128 v[124:127], v161 offset:4096
  v_add_f32_dpp v198, v198, v198 row_ror:8 row_mask:0xf bank_mask:0xf
  s_nop 1
  v_add_f32_dpp v198, v198, v198 row_ror:4 row_mask:0xf bank_mask:0xf
  s_add_u32 m0, s55, 40960
  v_mfma_f32_32x32x16_bf16 v[48:63], v[132:135], v[116:119], v[48:63]
  buffer_load_dwordx4 v174, s[8:11], s52 offen lds
  v_add_f32_dpp v198, v198, v198 row_ror:2 row_mask:0xf bank_mask:0xf
  s_nop 1
  v_add_f32_dpp v198, v198, v198 row_ror:1 row_mask:0xf bank_mask:0xf
  v_mov_b32 v199, v198
  s_nop 1
  v_permlane16_swap_b32 v198, v199
  v_mfma_f32_32x32x16_bf16 v[80:95], v[116:119], v[136:139], v[80:95]
  v_mul_f32 v198, 0xbb000000, v198
L_stub_att_0:
  s_cmp_eq_u32 s86, 1
  s_cbranch_scc1 L_tret_att_0
  v_mul_f32 v199, 0x3b000000, v199
  v_fma_f32 v199, -v198, v198, v199
  v_cvt_pk_bf16_f32 v182, v198, v198
  v_max_f32 v199, 0, v199
  s_waitcnt lgkmcnt(5)
  v_mfma_f32_32x32x16_bf16 v[0:15], v[144:147], v[120:123], v[0:15]
  ds_read_b128 v[112:115], v162
  ds_read_b64_tr_b16 v[128:129], v168 offset:12288
  v_add_u32 v160, 0xfffec000, v160
  v_add_u32 v161, 0xfffec000, v161
  s_add_u32 m0, s55, 41984
  s_waitcnt lgkmcnt(5)
  v_mfma_f32_32x32x16_bf16 v[32:47], v[148:151], v[120:123], v[32:47]
  buffer_load_dwordx4 v175, s[8:11], s52 offen lds
  ds_read_b64_tr_b16 v[130:131], v168 offset:13824
  ds_read_b64_tr_b16 v[132:133], v168 offset:12416
  v_and_b32 v203, 0xffff0000, v182
  v_add_f32 v199, 0x3727c5ac, v199
  s_waitcnt lgkmcnt(5)
  v_mfma_f32_32x32x16_bf16 v[64:79], v[120:123], v[152:155], v[64:79]
  ds_read_b64_tr_b16 v[134:135], v168 offset:13952
  ds_read_b64_tr_b16 v[136:137], v168 offset:12544
  v_sub_f32 v203, v198, v203
  v_rsq_f32 v184, v199
  v_cvt_pk_bf16_f32 v183, v203, 0
  s_waitcnt lgkmcnt(6)
  v_mfma_f32_32x32x16_bf16 v[16:31], v[144:147], v[124:127], v[16:31]
  ds_read_b64_tr_b16 v[138:139], v168 offset:14080
  ds_read_b128 v[116:119], v162 offset:4096
  buffer_store_dwordx4 v[182:185], v202, s[12:15], 0 offen sc1
  s_nop 1
  v_and_b32 v182, 15, v209
  s_add_u32 m0, s55, 43008
  v_mfma_f32_32x32x16_bf16 v[48:63], v[148:151], v[124:127], v[48:63]
  buffer_load_dwordx4 v176, s[8:11], s52 offen lds
  v_lshrrev_b32 v183, 4, v209
  v_lshlrev_b32 v183, 2, v183
  v_sub_u32 v182, v182, v183
  v_mov_b32 v185, 0xf149f2ca
  v_mfma_f32_32x32x16_bf16 v[80:95], v[124:127], v[152:155], v[80:95]
  v_mov_b32 v224, 0
  v_mov_b32 v225, 0
  v_subrev_u32 v184, 0, v182
  v_cmp_gt_u32 vcc, 8, v184
  v_cmp_ge_i32 s[62:63], -9, v184
  s_waitcnt lgkmcnt(5)
  v_mfma_f32_32x32x16_bf16 v[0:15], v[128:131], v[112:115], v[0:15]
  ds_read_b128 v[120:123], v163
  ds_read_b64_tr_b16 v[144:145], v168 offset:18432
  v_add_u32 v162, 0xfffec000, v162
  v_cndmask_b32 v216, v185, 0, vcc
  s_add_u32 m0, s55, 44032
  s_waitcnt lgkmcnt(5)
  v_mfma_f32_32x32x16_bf16 v[32:47], v[132:135], v[112:115], v[32:47]
  buffer_load_dwordx4 v174, s[8:11], s53 offen lds
  ds_read_b64_tr_b16 v[146:147], v168 offset:19968
  ds_read_b64_tr_b16 v[148:149], v168 offset:18560
  v_cndmask_b32 v220, v185, 0, s[62:63]
  v_mov_b32 v186, 0xffff
  s_waitcnt lgkmcnt(5)
  v_mfma_f32_32x32x16_bf16 v[64:79], v[112:115], v[136:139], v[64:79]
  ds_read_b64_tr_b16 v[150:151], v168 offset:20096
  ds_read_b64_tr_b16 v[152:153], v168 offset:18688
  v_cndmask_b32 v186, 0, v186, s[62:63]
  v_or_b32 v224, v224, v186
  s_add_u32 m0, s55, 45056
  s_waitcnt lgkmcnt(6)
  v_mfma_f32_32x32x16_bf16 v[16:31], v[128:131], v[116:119], v[16:31]
  buffer_load_dwordx4 v175, s[8:11], s53 offen lds
  ds_read_b64_tr_b16 v[154:155], v168 offset:20224
  ds_read_b128 v[124:127], v163 offset:4096
  v_subrev_u32 v184, 1, v182
  v_cmp_gt_u32 vcc, 8, v184
  v_mfma_f32_32x32x16_bf16 v[48:63], v[132:135], v[116:119], v[48:63]
  v_cmp_ge_i32 s[62:63], -9, v184
  v_cndmask_b32 v217, v185, 0, vcc
  s_nop 0
  v_cndmask_b32 v221, v185, 0, s[62:63]
  v_mov_b32 v186, 0xffff0000
  s_add_u32 m0, s55, 46080
  v_mfma_f32_32x32x16_bf16 v[80:95], v[116:119], v[136:139], v[80:95]
  buffer_load_dwordx4 v176, s[8:11], s53 offen lds
  v_cndmask_b32 v186, 0, v186, s[62:63]
  v_or_b32 v224, v224, v186
  v_subrev_u32 v184, 2, v182
  v_cmp_gt_u32 vcc, 8, v184
  v_add_u32 v163, 0xfffec000, v163
  v_add_u32 v168, 0xfffec000, v168
  s_waitcnt vmcnt(11)
  s_waitcnt lgkmcnt(0)
  s_barrier
  s_mov_b32 s51, 640
  s_mov_b32 s52, 983040
  s_mov_b32 s53, 1007616
  v_mfma_f32_32x32x16_bf16 v[0:15], v[144:147], v[120:123], v[0:15]
  ds_read_b128 v[112:115], v160
  ds_read_b64_tr_b16 v[128:129], v168 offset:0
  v_cmp_ge_i32 s[62:63], -9, v184
  v_cndmask_b32 v218, v185, 0, vcc
  s_add_u32 m0, s54, 81920
  v_mfma_f32_32x32x16_bf16 v[32:47], v[148:151], v[120:123], v[32:47]
  buffer_load_dwordx4 v170, s[4:7], s51 offen lds
  ds_read_b64_tr_b16 v[130:131], v168 offset:1536
  ds_read_b64_tr_b16 v[132:133], v168 offset:128
  v_cndmask_b32 v222, v185, 0, s[62:63]
  s_add_u32 m0, s54, 82944
  v_mfma_f32_32x32x16_bf16 v[64:79], v[120:123], v[152:155], v[64:79]
  buffer_load_dwordx4 v171, s[4:7], s51 offen lds
  ds_read_b64_tr_b16 v[134:135], v168 offset:1664
  ds_read_b64_tr_b16 v[136:137], v168 offset:256
  v_mov_b32 v186, 0xffff
  v_cndmask_b32 v186, 0, v186, s[62:63]
  v_mfma_f32_32x32x16_bf16 v[16:31], v[144:147], v[124:127], v[16:31]
  ds_read_b64_tr_b16 v[138:139], v168 offset:1792
  ds_read_b128 v[116:119], v160 offset:4096
  v_or_b32 v225, v225, v186
  v_subrev_u32 v184, 3, v182
  s_add_u32 m0, s54, 83968
  v_mfma_f32_32x32x16_bf16 v[48:63], v[148:151], v[124:127], v[48:63]
  buffer_load_dwordx4 v172, s[4:7], s51 offen lds
  v_cmp_gt_u32 vcc, 8, v184
  v_cmp_ge_i32 s[62:63], -9, v184
  s_nop 0
  v_cndmask_b32 v219, v185, 0, vcc
  v_cndmask_b32 v223, v185, 0, s[62:63]
  v_mfma_f32_32x32x16_bf16 v[80:95], v[124:127], v[152:155], v[80:95]
  buffer_load_dwordx2 v[254:255], v215, s[12:15], 0 offen sc1
  v_mov_b32 v186, 0xffff0000
  v_cndmask_b32 v186, 0, v186, s[62:63]
  v_or_b32 v225, v225, v186
  v_mov_b32 v226, 0x3f803f80
  s_waitcnt lgkmcnt(5)
  v_mfma_f32_32x32x16_bf16 v[0:15], v[128:131], v[112:115], v[0:15]
  ds_read_b128 v[120:123], v161
  ds_read_b64_tr_b16 v[144:145], v168 offset:6144
  v_mov_b32 v227, 0x3f803f80
  v_mov_b32 v228, 0x3f803f80
  s_add_u32 m0, s54, 84992
  s_waitcnt lgkmcnt(5)
  v_mfma_f32_32x32x16_bf16 v[32:47], v[132:135], v[112:115], v[32:47]
  buffer_load_dwordx4 v173, s[4:7], s51 offen lds
  ds_read_b64_tr_b16 v[146:147], v168 offset:7680
  ds_read_b64_tr_b16 v[148:149], v168 offset:6272
  v_mov_b32 v229, 0x3f803f80
  v_and_b32 v182, 31, v209
  s_waitcnt lgkmcnt(5)
  v_mfma_f32_32x32x16_bf16 v[64:79], v[112:115], v[136:139], v[64:79]
  ds_read_b64_tr_b16 v[150:151], v168 offset:7808
  ds_read_b64_tr_b16 v[152:153], v168 offset:6400
  v_lshrrev_b32 v183, 5, v209
  v_lshlrev_b32 v183, 9, v183
  s_lshl_b32 s61, s43, 2
  s_waitcnt lgkmcnt(6)
  v_mfma_f32_32x32x16_bf16 v[16:31], v[128:131], v[116:119], v[16:31]
  ds_read_b64_tr_b16 v[154:155], v168 offset:7936
  ds_read_b128 v[124:127], v161 offset:4096
  s_lshl_b32 s96, s46, 1
  s_add_u32 s61, s61, s96
  s_add_u32 m0, s55, 81920
  v_mfma_f32_32x32x16_bf16 v[48:63], v[132:135], v[116:119], v[48:63]
  buffer_load_dwordx4 v174, s[8:11], s52 offen lds
  s_mul_i32 s96, s45, 118
  s_add_u32 s61, s61, s96
  s_lshl_b32 s61, s61, 10
  s_add_u32 s61, s61, 3145728
  v_mfma_f32_32x32x16_bf16 v[80:95], v[116:119], v[136:139], v[80:95]
  s_cmp_eq_u32 s42, 0
  s_cselect_b32 s96, 0, 7
  v_mov_b32 v187, 2147483392
  s_movk_i32 s97, 0x400
  v_add_u32 v184, 0, v182
  s_waitcnt lgkmcnt(5)
  v_mfma_f32_32x32x16_bf16 v[0:15], v[144:147], v[120:123], v[0:15]
  ds_read_b128 v[112:115], v162
  ds_read_b64_tr_b16 v[128:129], v168 offset:12288
  v_add_u32 v160, 0xa000, v160
  v_add_u32 v161, 0xa000, v161
  s_add_u32 m0, s55, 82944
  s_waitcnt lgkmcnt(5)
  v_mfma_f32_32x32x16_bf16 v[32:47], v[148:151], v[120:123], v[32:47]
  buffer_load_dwordx4 v175, s[8:11], s52 offen lds
  ds_read_b64_tr_b16 v[130:131], v168 offset:13824
  ds_read_b64_tr_b16 v[132:133], v168 offset:12416
  v_add_u32 v185, s44, v184
  v_cmp_le_u32 vcc, s96, v184
  s_waitcnt lgkmcnt(5)
  v_mfma_f32_32x32x16_bf16 v[64:79], v[120:123], v[152:155], v[64:79]
  ds_read_b64_tr_b16 v[134:135], v168 offset:13952
  ds_read_b64_tr_b16 v[136:137], v168 offset:12544
  v_cmp_gt_u32 s[62:63], s97, v185
  s_nop 0
  s_and_b64 vcc, vcc, s[62:63]
  v_lshrrev_b32 v186, 5, v185
  s_waitcnt lgkmcnt(6)
  v_mfma_f32_32x32x16_bf16 v[16:31], v[144:147], v[124:127], v[16:31]
  ds_read_b64_tr_b16 v[138:139], v168 offset:14080
  ds_read_b128 v[116:119], v162 offset:4096
  v_mul_u32_u24 v186, 241664, v186
  v_and_b32 v185, 31, v185
  s_add_u32 m0, s55, 83968
  v_mfma_f32_32x32x16_bf16 v[48:63], v[148:151], v[124:127], v[48:63]
  buffer_load_dwordx4 v176, s[8:11], s52 offen lds
  v_lshl_add_u32 v185, v185, 4, v183
  v_add3_u32 v185, v185, v186, s61
  v_cndmask_b32 v230, v187, v185, vcc
  v_add_u32 v184, 32, v182
  v_mfma_f32_32x32x16_bf16 v[80:95], v[124:127], v[152:155], v[80:95]
  v_add_u32 v185, s44, v184
  v_cmp_le_u32 vcc, s96, v184
  v_cmp_gt_u32 s[62:63], s97, v185
  s_nop 0
  s_and_b64 vcc, vcc, s[62:63]
  v_lshrrev_b32 v186, 5, v185
  s_waitcnt lgkmcnt(5)
  v_mfma_f32_32x32x16_bf16 v[0:15], v[128:131], v[112:115], v[0:15]
  ds_read_b128 v[120:123], v163
  ds_read_b64_tr_b16 v[144:145], v168 offset:18432
  v_add_u32 v162, 0xa000, v162
  v_mul_u32_u24 v186, 241664, v186
  s_add_u32 m0, s55, 84992
  s_waitcnt lgkmcnt(5)
  v_mfma_f32_32x32x16_bf16 v[32:47], v[132:135], v[112:115], v[32:47]
  buffer_load_dwordx4 v174, s[8:11], s53 offen lds
  ds_read_b64_tr_b16 v[146:147], v168 offset:19968
  ds_read_b64_tr_b16 v[148:149], v168 offset:18560
  v_and_b32 v185, 31, v185
  v_lshl_add_u32 v185, v185, 4, v183
  s_waitcnt lgkmcnt(5)
  v_mfma_f32_32x32x16_bf16 v[64:79], v[112:115], v[136:139], v[64:79]
  ds_read_b64_tr_b16 v[150:151], v168 offset:20096
  ds_read_b64_tr_b16 v[152:153], v168 offset:18688
  v_add3_u32 v185, v185, v186, s61
  v_cndmask_b32 v231, v187, v185, vcc
  s_add_u32 m0, s55, 86016
  s_waitcnt lgkmcnt(6)
  v_mfma_f32_32x32x16_bf16 v[16:31], v[128:131], v[116:119], v[16:31]
  buffer_load_dwordx4 v175, s[8:11], s53 offen lds
  ds_read_b64_tr_b16 v[154:155], v168 offset:20224
  ds_read_b128 v[124:127], v163 offset:4096
  s_lshl_b32 s61, s3, 8
  s_add_u32 s61, s61, 122880
  v_mfma_f32_32x32x16_bf16 v[48:63], v[132:135], v[116:119], v[48:63]
  v_lshl_add_u32 v232, v209, 2, s61
  v_lshrrev_b32 v183, 5, v209
  v_lshl_add_u32 v233, v183, 4, s61
  s_lshl_b32 s61, s42, 3
  s_add_u32 m0, s55, 87040
  v_mfma_f32_32x32x16_bf16 v[80:95], v[116:119], v[136:139], v[80:95]
  buffer_load_dwordx4 v176, s[8:11], s53 offen lds
  s_add_u32 s61, s61, s43
  s_lshl_b32 s61, s61, 2
  s_add_u32 s61, s61, s3
  s_lshl_b32 s61, s61, 3
  v_add_u32 v163, 0xa000, v163
  v_add_u32 v168, 0xa000, v168
  s_waitcnt vmcnt(7)
  s_waitcnt lgkmcnt(0)
  s_barrier
  s_mov_b32 s58, 0
L_fchk_16:
  v_cmp_eq_u32 s[30:31], s56, v254
  v_cmp_eq_u32 s[34:35], s57, v255
  s_nop 0
  s_and_b64 s[30:31], s[30:31], s[34:35]
  s_cmp_eq_u64 s[30:31], exec
  s_cbranch_scc1 L_fok_17
  s_add_u32 s58, s58, 1
  s_cmp_ge_u32 s58, 262144
  s_cbranch_scc1 L_fok_17
  buffer_load_dwordx2 v[254:255], v215, s[12:15], 0 offen sc1
  s_waitcnt vmcnt(0)
  s_branch L_fchk_16
L_fok_17:
  s_mov_b32 s51, 768
  s_mov_b32 s52, 1179648
  s_mov_b32 s53, 1204224
  v_mfma_f32_32x32x16_bf16 v[0:15], v[144:147], v[120:123], v[0:15]
  ds_read_b128 v[112:115], v160
  ds_read_b64_tr_b16 v[128:129], v168 offset:0
  s_add_u32 s61, s61, 4096
  v_mov_b32 v182, s61
  s_add_u32 m0, s54, 0
  v_mfma_f32_32x32x16_bf16 v[32:47], v[148:151], v[120:123], v[32:47]
  buffer_load_dwordx4 v170, s[4:7], s51 offen lds
  ds_read_b64_tr_b16 v[130:131], v168 offset:1536
  ds_read_b64_tr_b16 v[132:133], v168 offset:128
  v_mov_b32 v188, 2147483392
  s_add_u32 m0, s54, 1024
  v_mfma_f32_32x32x16_bf16 v[64:79], v[120:123], v[152:155], v[64:79]
  buffer_load_dwordx4 v171, s[4:7], s51 offen lds
  ds_read_b64_tr_b16 v[134:135], v168 offset:1664
  ds_read_b64_tr_b16 v[136:137], v168 offset:256
  v_cmp_gt_u32 vcc, 1, v209
  s_nop 1
  v_cndmask_b32 v238, v188, v182, vcc
  v_mfma_f32_32x32x16_bf16 v[16:31], v[144:147], v[124:127], v[16:31]
  ds_read_b64_tr_b16 v[138:139], v168 offset:1792
  ds_read_b128 v[116:119], v160 offset:4096
  s_lshl_b32 s61, s59, 5
  s_add_u32 s96, s61, 24
  s_add_u32 m0, s54, 2048
  v_mfma_f32_32x32x16_bf16 v[48:63], v[148:151], v[124:127], v[48:63]
  buffer_load_dwordx4 v172, s[4:7], s51 offen lds
  s_mul_i32 s96, s96, 575
  s_lshr_b32 s96, s96, 15
  s_max_u32 s61, s61, 7
  s_sub_u32 s61, s61, 7
  v_mfma_f32_32x32x16_bf16 v[80:95], v[124:127], v[152:155], v[80:95]
  buffer_load_dwordx4 a[0:3], v208, s[12:15], s88 offen offset:0 sc1
  s_mul_i32 s61, s61, 575
  s_lshr_b32 s61, s61, 15
  s_sub_u32 s96, s96, s61
  v_bfe_u32 v182, v209, 3, 1
  s_waitcnt lgkmcnt(5)
  v_mfma_f32_32x32x16_bf16 v[0:15], v[128:131], v[112:115], v[0:15]
  ds_read_b128 v[120:123], v161
  ds_read_b64_tr_b16 v[144:145], v168 offset:6144
  v_mul_u32_u24 v182, s96, v182
  v_add_u32 v182, s61, v182
  s_add_u32 m0, s54, 3072
  s_waitcnt lgkmcnt(5)
  v_mfma_f32_32x32x16_bf16 v[32:47], v[132:135], v[112:115], v[32:47]
  buffer_load_dwordx4 v173, s[4:7], s51 offen lds
  ds_read_b64_tr_b16 v[146:147], v168 offset:7680
  ds_read_b64_tr_b16 v[148:149], v168 offset:6272
  v_bfe_u32 v183, v209, 2, 1
  v_lshl_add_u32 v182, v182, 3, v183
  s_waitcnt lgkmcnt(5)
  v_mfma_f32_32x32x16_bf16 v[64:79], v[112:115], v[136:139], v[64:79]
  ds_read_b64_tr_b16 v[150:151], v168 offset:7808
  ds_read_b64_tr_b16 v[152:153], v168 offset:6400
  s_lshl_b32 s61, s3, 1
  v_add_u32 v182, s61, v182
  s_add_u32 m0, s55, 0
  s_waitcnt lgkmcnt(6)
  v_mfma_f32_32x32x16_bf16 v[16:31], v[128:131], v[116:119], v[16:31]
  buffer_load_dwordx4 v174, s[8:11], s52 offen lds
  ds_read_b64_tr_b16 v[154:155], v168 offset:7936
  ds_read_b128 v[124:127], v161 offset:4096
  v_and_b32 v183, 3, v209
  v_lshl_add_u32 v182, v182, 2, v183
  v_mfma_f32_32x32x16_bf16 v[48:63], v[132:135], v[116:119], v[48:63]
  v_lshlrev_b32 v182, 3, v182
  v_add_u32 v235, 4096, v182
  v_and_b32 v182, 31, v209
  v_lshrrev_b32 v183, 5, v209
  s_lshl_b32 s61, s59, 6
  v_mfma_f32_32x32x16_bf16 v[80:95], v[116:119], v[136:139], v[80:95]
  buffer_load_dwordx4 a[4:7], v208, s[12:15], s89 offen offset:0 sc1
  s_add_u32 s61, s61, s45
  s_lshl_b32 s61, s61, 10
  s_lshl_b32 s96, s60, 7
  s_add_u32 s61, s61, s96
  s_waitcnt lgkmcnt(5)
  v_mfma_f32_32x32x16_bf16 v[0:15], v[144:147], v[120:123], v[0:15]
  ds_read_b128 v[112:115], v162
  ds_read_b64_tr_b16 v[128:129], v168 offset:12288
  v_add_u32 v160, 0xa000, v160
  v_add_u32 v161, 0xa000, v161
  s_add_u32 m0, s55, 1024
  s_waitcnt lgkmcnt(5)
  v_mfma_f32_32x32x16_bf16 v[32:47], v[148:151], v[120:123], v[32:47]
  buffer_load_dwordx4 v175, s[8:11], s52 offen lds
  ds_read_b64_tr_b16 v[130:131], v168 offset:13824
  ds_read_b64_tr_b16 v[132:133], v168 offset:12416
  s_lshl_b32 s96, s46, 6
  s_add_u32 m0, s55, 2048
  s_waitcnt lgkmcnt(5)
  v_mfma_f32_32x32x16_bf16 v[64:79], v[120:123], v[152:155], v[64:79]
  buffer_load_dwordx4 v176, s[8:11], s52 offen lds
  ds_read_b64_tr_b16 v[134:135], v168 offset:13952
  ds_read_b64_tr_b16 v[136:137], v168 offset:12544
  s_add_u32 s61, s61, s96
  v_lshlrev_b32 v184, 11, v182
  s_waitcnt lgkmcnt(6)
  v_mfma_f32_32x32x16_bf16 v[16:31], v[144:147], v[124:127], v[16:31]
  ds_read_b64_tr_b16 v[138:139], v168 offset:14080
  ds_read_b128 v[116:119], v162 offset:4096
  v_lshl_add_u32 v184, v183, 5, v184
  v_add_u32 v236, s61, v184
  s_lshl_b32 s61, s45, 10
  v_mfma_f32_32x32x16_bf16 v[48:63], v[148:151], v[124:127], v[48:63]
  buffer_load_dwordx4 a[8:11], v208, s[12:15], s88 offen offset:1024 sc1
  s_lshl_b32 s96, s59, 5
  s_add_u32 s61, s61, s96
  v_add_u32 v182, s61, v182
  v_lshlrev_b32 v182, 4, v182
  v_mfma_f32_32x32x16_bf16 v[80:95], v[124:127], v[152:155], v[80:95]
  buffer_load_dwordx4 a[12:15], v208, s[12:15], s89 offen offset:1024 sc1
  v_add_u32 v237, 65536, v182
  s_mul_i32 s61, s45, 120832
  v_add_u32 v181, s61, v208
  s_xor_b32 s61, s45, 1
  s_waitcnt lgkmcnt(5)
  v_mfma_f32_32x32x16_bf16 v[0:15], v[128:131], v[112:115], v[0:15]
  ds_read_b128 v[120:123], v163
  ds_read_b64_tr_b16 v[144:145], v168 offset:18432
  v_add_u32 v162, 0xa000, v162
  s_mul_i32 s61, s61, 120832
  s_add_u32 m0, s55, 3072
  s_waitcnt lgkmcnt(5)
  v_mfma_f32_32x32x16_bf16 v[32:47], v[132:135], v[112:115], v[32:47]
  buffer_load_dwordx4 v174, s[8:11], s53 offen lds
  ds_read_b64_tr_b16 v[146:147], v168 offset:19968
  ds_read_b64_tr_b16 v[148:149], v168 offset:18560
  v_add_u32 v239, s61, v208
  s_add_u32 m0, s55, 4096
  s_waitcnt lgkmcnt(5)
  v_mfma_f32_32x32x16_bf16 v[64:79], v[112:115], v[136:139], v[64:79]
  buffer_load_dwordx4 v175, s[8:11], s53 offen lds
  ds_read_b64_tr_b16 v[150:151], v168 offset:20096
  ds_read_b64_tr_b16 v[152:153], v168 offset:18688
  s_lshl_b32 s61, s59, 1
  s_mul_i32 s61, s61, 120832
  s_waitcnt lgkmcnt(6)
  v_mfma_f32_32x32x16_bf16 v[16:31], v[128:131], v[116:119], v[16:31]
  ds_read_b64_tr_b16 v[154:155], v168 offset:20224
  ds_read_b128 v[124:127], v163 offset:4096
  s_add_u32 s61, s61, 3145728
  s_mul_i32 s96, s3, 18
  s_add_u32 m0, s55, 5120
  v_mfma_f32_32x32x16_bf16 v[48:63], v[132:135], v[116:119], v[48:63]
  buffer_load_dwordx4 v176, s[8:11], s53 offen lds
  s_add_u32 s96, s96, 32
  s_lshl_b32 s97, s96, 10
  s_add_u32 s24, s61, s97
  s_add_u32 s38, s24, 4096
  v_mfma_f32_32x32x16_bf16 v[80:95], v[116:119], v[136:139], v[80:95]
  buffer_load_dwordx4 a[16:19], v208, s[12:15], s88 offen offset:2048 sc1
  s_add_u32 s39, s24, 8192
  s_add_u32 s1, s24, 12288
  s_add_u32 s0, s24, 16384
  s_lshl_b32 s96, s3, 2
  v_add_u32 v163, 0xa000, v163
  v_add_u32 v168, 0xa000, v168
  s_waitcnt vmcnt(15)
  s_waitcnt lgkmcnt(0)
  s_barrier
  s_mov_b32 s51, 896
  s_mov_b32 s52, 1376256
  s_mov_b32 s53, 1400832
  v_mfma_f32_32x32x16_bf16 v[0:15], v[144:147], v[120:123], v[0:15]
  ds_read_b128 v[112:115], v160
  ds_read_b64_tr_b16 v[128:129], v168 offset:0
  s_add_u32 s96, s96, 104
  s_lshl_b32 s97, s96, 10
  s_add_u32 m0, s54, 40960
  v_mfma_f32_32x32x16_bf16 v[32:47], v[148:151], v[120:123], v[32:47]
  buffer_load_dwordx4 v170, s[4:7], s51 offen lds
  ds_read_b64_tr_b16 v[130:131], v168 offset:1536
  ds_read_b64_tr_b16 v[132:133], v168 offset:128
  s_add_u32 s28, s61, s97
  s_add_u32 m0, s54, 41984
  v_mfma_f32_32x32x16_bf16 v[64:79], v[120:123], v[152:155], v[64:79]
  buffer_load_dwordx4 v171, s[4:7], s51 offen lds
  ds_read_b64_tr_b16 v[134:135], v168 offset:1664
  ds_read_b64_tr_b16 v[136:137], v168 offset:256
  s_add_u32 s97, s96, 2
  s_min_u32 s97, s97, 117
  v_mfma_f32_32x32x16_bf16 v[16:31], v[144:147], v[124:127], v[16:31]
  ds_read_b64_tr_b16 v[138:139], v168 offset:1792
  ds_read_b128 v[116:119], v160 offset:4096
  s_lshl_b32 s97, s97, 10
  s_add_u32 s26, s61, s97
  s_add_u32 m0, s54, 43008
  v_mfma_f32_32x32x16_bf16 v[48:63], v[148:151], v[124:127], v[48:63]
  buffer_load_dwordx4 v172, s[4:7], s51 offen lds
  s_add_u32 s97, s96, 3
  s_min_u32 s97, s97, 117
  s_lshl_b32 s97, s97, 10
  s_add_u32 s27, s61, s97
  v_mfma_f32_32x32x16_bf16 v[80:95], v[124:127], v[152:155], v[80:95]
  buffer_load_dwordx4 a[20:23], v208, s[12:15], s89 offen offset:2048 sc1
  s_lshl_b32 s97, s3, 13
  s_add_u32 s25, s61, s97
  s_add_u32 s33, s25, 4096
  s_waitcnt lgkmcnt(5)
  v_mfma_f32_32x32x16_bf16 v[0:15], v[128:131], v[112:115], v[0:15]
  ds_read_b128 v[120:123], v161
  ds_read_b64_tr_b16 v[144:145], v168 offset:6144
  s_add_u32 m0, s54, 44032
  s_waitcnt lgkmcnt(5)
  v_mfma_f32_32x32x16_bf16 v[32:47], v[132:135], v[112:115], v[32:47]
  buffer_load_dwordx4 v173, s[4:7], s51 offen lds
  ds_read_b64_tr_b16 v[146:147], v168 offset:7680
  ds_read_b64_tr_b16 v[148:149], v168 offset:6272
  s_waitcnt lgkmcnt(5)
  v_mfma_f32_32x32x16_bf16 v[64:79], v[112:115], v[136:139], v[64:79]
  ds_read_b64_tr_b16 v[150:151], v168 offset:7808
  ds_read_b64_tr_b16 v[152:153], v168 offset:6400
  s_add_u32 m0, s55, 40960
  s_waitcnt lgkmcnt(6)
  v_mfma_f32_32x32x16_bf16 v[16:31], v[128:131], v[116:119], v[16:31]
  buffer_load_dwordx4 v174, s[8:11], s52 offen lds
  ds_read_b64_tr_b16 v[154:155], v168 offset:7936
  ds_read_b128 v[124:127], v161 offset:4096
  v_mfma_f32_32x32x16_bf16 v[48:63], v[132:135], v[116:119], v[48:63]
  v_mfma_f32_32x32x16_bf16 v[80:95], v[116:119], v[136:139], v[80:95]
  buffer_load_dwordx4 a[24:27], v208, s[12:15], s88 offen offset:3072 sc1
  s_waitcnt lgkmcnt(5)
  v_mfma_f32_32x32x16_bf16 v[0:15], v[144:147], v[120:123], v[0:15]
  ds_read_b128 v[112:115], v162
  ds_read_b64_tr_b16 v[128:129], v168 offset:12288
  v_add_u32 v160, 0xfffec000, v160
  v_add_u32 v161, 0xfffec000, v161
  s_add_u32 m0, s55, 41984
  s_waitcnt lgkmcnt(5)
  v_mfma_f32_32x32x16_bf16 v[32:47], v[148:151], v[120:123], v[32:47]
  buffer_load_dwordx4 v175, s[8:11], s52 offen lds
  ds_read_b64_tr_b16 v[130:131], v168 offset:13824
  ds_read_b64_tr_b16 v[132:133], v168 offset:12416
  s_add_u32 m0, s55, 43008
  s_waitcnt lgkmcnt(5)
  v_mfma_f32_32x32x16_bf16 v[64:79], v[120:123], v[152:155], v[64:79]
  buffer_load_dwordx4 v176, s[8:11], s52 offen lds
  ds_read_b64_tr_b16 v[134:135], v168 offset:13952
  ds_read_b64_tr_b16 v[136:137], v168 offset:12544
  s_waitcnt lgkmcnt(6)
  v_mfma_f32_32x32x16_bf16 v[16:31], v[144:147], v[124:127], v[16:31]
  ds_read_b64_tr_b16 v[138:139], v168 offset:14080
  ds_read_b128 v[116:119], v162 offset:4096
  v_mfma_f32_32x32x16_bf16 v[48:63], v[148:151], v[124:127], v[48:63]
  buffer_load_dwordx4 a[28:31], v208, s[12:15], s89 offen offset:3072 sc1
  s_add_u32 s88, s88, 4096
  v_mfma_f32_32x32x16_bf16 v[80:95], v[124:127], v[152:155], v[80:95]
  buffer_load_dwordx4 a[32:35], v208, s[12:15], s88 offen offset:0 sc1
  s_waitcnt lgkmcnt(5)
  v_mfma_f32_32x32x16_bf16 v[0:15], v[128:131], v[112:115], v[0:15]
  ds_read_b128 v[120:123], v163
  ds_read_b64_tr_b16 v[144:145], v168 offset:18432
  v_add_u32 v162, 0xfffec000, v162
  s_add_u32 m0, s55, 44032
  s_waitcnt lgkmcnt(5)
  v_mfma_f32_32x32x16_bf16 v[32:47], v[132:135], v[112:115], v[32:47]
  buffer_load_dwordx4 v174, s[8:11], s53 offen lds
  ds_read_b64_tr_b16 v[146:147], v168 offset:19968
  ds_read_b64_tr_b16 v[148:149], v168 offset:18560
  s_add_u32 m0, s55, 45056
  s_waitcnt lgkmcnt(5)
  v_mfma_f32_32x32x16_bf16 v[64:79], v[112:115], v[136:139], v[64:79]
  buffer_load_dwordx4 v175, s[8:11], s53 offen lds
  ds_read_b64_tr_b16 v[150:151], v168 offset:20096
  ds_read_b64_tr_b16 v[152:153], v168 offset:18688
  s_waitcnt lgkmcnt(6)
  v_mfma_f32_32x32x16_bf16 v[16:31], v[128:131], v[116:119], v[16:31]
  ds_read_b64_tr_b16 v[154:155], v168 offset:20224
  ds_read_b128 v[124:127], v163 offset:4096
  s_add_u32 m0, s55, 46080
  v_mfma_f32_32x32x16_bf16 v[48:63], v[132:135], v[116:119], v[48:63]
  buffer_load_dwordx4 v176, s[8:11], s53 offen lds
  s_add_u32 s89, s89, 4096
  v_mfma_f32_32x32x16_bf16 v[80:95], v[116:119], v[136:139], v[80:95]
  buffer_load_dwordx4 a[36:39], v208, s[12:15], s89 offen offset:0 sc1
  v_add_u32 v163, 0xfffec000, v163
  v_add_u32 v168, 0xfffec000, v168
  s_waitcnt vmcnt(16)
  s_waitcnt lgkmcnt(0)
  s_barrier
  v_mfma_f32_32x32x16_bf16 v[0:15], v[144:147], v[120:123], v[0:15]
  ds_read_b128 v[112:115], v160
  ds_read_b64_tr_b16 v[128:129], v168 offset:0
  v_mfma_f32_32x32x16_bf16 v[32:47], v[148:151], v[120:123], v[32:47]
  buffer_load_dwordx4 a[40:43], v208, s[12:15], s88 offen offset:1024 sc1
  ds_read_b64_tr_b16 v[130:131], v168 offset:1536
  ds_read_b64_tr_b16 v[132:133], v168 offset:128
  v_mfma_f32_32x32x16_bf16 v[64:79], v[120:123], v[152:155], v[64:79]
  ds_read_b64_tr_b16 v[134:135], v168 offset:1664
  ds_read_b64_tr_b16 v[136:137], v168 offset:256
  v_mfma_f32_32x32x16_bf16 v[16:31], v[144:147], v[124:127], v[16:31]
  buffer_load_dwordx4 a[44:47], v208, s[12:15], s89 offen offset:1024 sc1
  ds_read_b64_tr_b16 v[138:139], v168 offset:1792
  ds_read_b128 v[116:119], v160 offset:4096
  v_mfma_f32_32x32x16_bf16 v[48:63], v[148:151], v[124:127], v[48:63]
  v_mfma_f32_32x32x16_bf16 v[80:95], v[124:127], v[152:155], v[80:95]
  buffer_load_dwordx4 a[48:51], v208, s[12:15], s88 offen offset:2048 sc1
  s_waitcnt lgkmcnt(5)
  v_mfma_f32_32x32x16_bf16 v[0:15], v[128:131], v[112:115], v[0:15]
  ds_read_b128 v[120:123], v161
  ds_read_b64_tr_b16 v[144:145], v168 offset:6144
  s_waitcnt lgkmcnt(5)
  v_mfma_f32_32x32x16_bf16 v[32:47], v[132:135], v[112:115], v[32:47]
  buffer_load_dwordx4 v[182:185], v211, s[12:15], 0 offen sc1
  ds_read_b64_tr_b16 v[146:147], v168 offset:7680
  ds_read_b64_tr_b16 v[148:149], v168 offset:6272
  s_waitcnt lgkmcnt(5)
  v_mfma_f32_32x32x16_bf16 v[64:79], v[112:115], v[136:139], v[64:79]
  ds_read_b64_tr_b16 v[150:151], v168 offset:7808
  ds_read_b64_tr_b16 v[152:153], v168 offset:6400
  s_waitcnt lgkmcnt(6)
  v_mfma_f32_32x32x16_bf16 v[16:31], v[128:131], v[116:119], v[16:31]
  buffer_load_dwordx4 v[186:189], v212, s[12:15], 0 offen sc1
  ds_read_b64_tr_b16 v[154:155], v168 offset:7936
  ds_read_b128 v[124:127], v161 offset:4096
  v_mfma_f32_32x32x16_bf16 v[48:63], v[132:135], v[116:119], v[48:63]
  v_mfma_f32_32x32x16_bf16 v[80:95], v[116:119], v[136:139], v[80:95]
  buffer_load_dwordx4 v[190:193], v213, s[12:15], 0 offen offset:0 sc1
  s_waitcnt lgkmcnt(5)
  v_mfma_f32_32x32x16_bf16 v[0:15], v[144:147], v[120:123], v[0:15]
  ds_read_b128 v[112:115], v162
  ds_read_b64_tr_b16 v[128:129], v168 offset:12288
  v_add_u32 v160, 0xa000, v160
  v_add_u32 v161, 0xa000, v161
  s_mov_b32 s99, 8192
  s_waitcnt lgkmcnt(5)
L_stub_att_1:
  s_cmp_eq_u32 s86, 1
  s_cbranch_scc1 L_tret_att_1
  v_mfma_f32_32x32x16_bf16 v[32:47], v[148:151], v[120:123], v[32:47]
  buffer_load_dwordx4 v[194:197], v213, s[12:15], s99 offen sc1
  ds_read_b64_tr_b16 v[130:131], v168 offset:13824
  ds_read_b64_tr_b16 v[132:133], v168 offset:12416
  s_waitcnt lgkmcnt(5)
  v_mfma_f32_32x32x16_bf16 v[64:79], v[120:123], v[152:155], v[64:79]
  ds_read_b64_tr_b16 v[134:135], v168 offset:13952
  ds_read_b64_tr_b16 v[136:137], v168 offset:12544
  s_waitcnt lgkmcnt(6)
  v_mfma_f32_32x32x16_bf16 v[16:31], v[144:147], v[124:127], v[16:31]
  ds_read_b64_tr_b16 v[138:139], v168 offset:14080
  ds_read_b128 v[116:119], v162 offset:4096
  s_mov_b32 s99, 16384
  v_mfma_f32_32x32x16_bf16 v[48:63], v[148:151], v[124:127], v[48:63]
  buffer_load_dwordx4 v[198:201], v213, s[12:15], s99 offen sc1
  v_mfma_f32_32x32x16_bf16 v[80:95], v[124:127], v[152:155], v[80:95]
  s_waitcnt lgkmcnt(5)
  v_mfma_f32_32x32x16_bf16 v[0:15], v[128:131], v[112:115], v[0:15]
  ds_read_b128 v[120:123], v163
  ds_read_b64_tr_b16 v[144:145], v168 offset:18432
  v_add_u32 v162, 0xa000, v162
  s_waitcnt lgkmcnt(5)
  v_mfma_f32_32x32x16_bf16 v[32:47], v[132:135], v[112:115], v[32:47]
  buffer_load_dwordx4 a[52:55], v208, s[12:15], s89 offen offset:2048 sc1
  ds_read_b64_tr_b16 v[146:147], v168 offset:19968
  ds_read_b64_tr_b16 v[148:149], v168 offset:18560
  s_waitcnt lgkmcnt(5)
  v_mfma_f32_32x32x16_bf16 v[64:79], v[112:115], v[136:139], v[64:79]
  ds_read_b64_tr_b16 v[150:151], v168 offset:20096
  ds_read_b64_tr_b16 v[152:153], v168 offset:18688
  s_waitcnt lgkmcnt(6)
  v_mfma_f32_32x32x16_bf16 v[16:31], v[128:131], v[116:119], v[16:31]
  buffer_load_dwordx4 a[56:59], v208, s[12:15], s88 offen offset:3072 sc1
  ds_read_b64_tr_b16 v[154:155], v168 offset:20224
  ds_read_b128 v[124:127], v163 offset:4096
  v_mfma_f32_32x32x16_bf16 v[48:63], v[132:135], v[116:119], v[48:63]
  v_mfma_f32_32x32x16_bf16 v[80:95], v[116:119], v[136:139], v[80:95]
  buffer_load_dwordx4 a[60:63], v208, s[12:15], s89 offen offset:3072 sc1
  v_add_u32 v163, 0xa000, v163
  v_add_u32 v168, 0xa000, v168
  s_waitcnt vmcnt(12)
  s_waitcnt lgkmcnt(0)
  s_barrier
  v_mfma_f32_32x32x16_bf16 v[0:15], v[144:147], v[120:123], v[0:15]
  ds_read_b128 v[112:115], v160
  ds_read_b64_tr_b16 v[128:129], v168 offset:0
  s_add_u32 s88, s88, 4096
  v_mfma_f32_32x32x16_bf16 v[32:47], v[148:151], v[120:123], v[32:47]
  buffer_load_dwordx4 a[64:67], v208, s[12:15], s88 offen offset:0 sc1
  ds_read_b64_tr_b16 v[130:131], v168 offset:1536
  ds_read_b64_tr_b16 v[132:133], v168 offset:128
  v_mfma_f32_32x32x16_bf16 v[64:79], v[120:123], v[152:155], v[64:79]
  ds_read_b64_tr_b16 v[134:135], v168 offset:1664
  ds_read_b64_tr_b16 v[136:137], v168 offset:256
  s_add_u32 s89, s89, 4096
  v_mfma_f32_32x32x16_bf16 v[16:31], v[144:147], v[124:127], v[16:31]
  buffer_load_dwordx4 a[68:71], v208, s[12:15], s89 offen offset:0 sc1
  ds_read_b64_tr_b16 v[138:139], v168 offset:1792
  ds_read_b128 v[116:119], v160 offset:4096
  v_mfma_f32_32x32x16_bf16 v[48:63], v[148:151], v[124:127], v[48:63]
  v_mfma_f32_32x32x16_bf16 v[80:95], v[124:127], v[152:155], v[80:95]
  buffer_load_dwordx4 a[72:75], v208, s[12:15], s88 offen offset:1024 sc1
  s_waitcnt lgkmcnt(5)
  v_mfma_f32_32x32x16_bf16 v[0:15], v[128:131], v[112:115], v[0:15]
  ds_read_b128 v[120:123], v161
  ds_read_b64_tr_b16 v[144:145], v168 offset:6144
  s_waitcnt lgkmcnt(5)
  v_mfma_f32_32x32x16_bf16 v[32:47], v[132:135], v[112:115], v[32:47]
  buffer_load_dwordx4 a[76:79], v208, s[12:15], s89 offen offset:1024 sc1
  ds_read_b64_tr_b16 v[146:147], v168 offset:7680
  ds_read_b64_tr_b16 v[148:149], v168 offset:6272
  s_waitcnt lgkmcnt(5)
  v_mfma_f32_32x32x16_bf16 v[64:79], v[112:115], v[136:139], v[64:79]
  ds_read_b64_tr_b16 v[150:151], v168 offset:7808
  ds_read_b64_tr_b16 v[152:153], v168 offset:6400
  s_waitcnt vmcnt(7)
  s_mov_b32 s58, 0
L_gchk_18:
  v_cmp_eq_u32 vcc, s56, v185
  v_cmp_eq_u32 s[62:63], s56, v189
  s_nop 0
  s_and_b64 vcc, vcc, s[62:63]
  v_cmp_eq_u32 s[62:63], s56, v193
  s_nop 0
  s_and_b64 vcc, vcc, s[62:63]
  v_cmp_eq_u32 s[62:63], s56, v197
  s_nop 0
  s_and_b64 vcc, vcc, s[62:63]
  v_cmp_eq_u32 s[62:63], s56, v201
  s_nop 0
  s_and_b64 vcc, vcc, s[62:63]
  s_cmp_eq_u64 vcc, exec
  s_cbranch_scc1 L_gok_19
  s_add_u32 s58, s58, 1
  s_cmp_ge_u32 s58, 262144
  s_cbranch_scc1 L_gok_19
  buffer_load_dwordx4 v[182:185], v211, s[12:15], 0 offen sc1
  buffer_load_dwordx4 v[186:189], v212, s[12:15], 0 offen sc1
  buffer_load_dwordx4 v[190:193], v213, s[12:15], 0 offen offset:0 sc1
  s_mov_b32 s99, 8192
  buffer_load_dwordx4 v[194:197], v213, s[12:15], s99 offen sc1
  s_mov_b32 s99, 16384
  buffer_load_dwordx4 v[198:201], v213, s[12:15], s99 offen sc1
  s_waitcnt vmcnt(0)
  s_branch L_gchk_18
L_gok_19:
  s_waitcnt lgkmcnt(6)
  v_mfma_f32_32x32x16_bf16 v[16:31], v[128:131], v[116:119], v[16:31]
  buffer_load_dwordx4 a[80:83], v208, s[12:15], s88 offen offset:2048 sc1
  ds_read_b64_tr_b16 v[154:155], v168 offset:7936
  ds_read_b128 v[124:127], v161 offset:4096
  v_mfma_f32_32x32x16_bf16 v[48:63], v[132:135], v[116:119], v[48:63]
  v_mfma_f32_32x32x16_bf16 v[80:95], v[116:119], v[136:139], v[80:95]
  buffer_load_dwordx4 a[84:87], v208, s[12:15], s89 offen offset:2048 sc1
  s_waitcnt lgkmcnt(5)
  v_mfma_f32_32x32x16_bf16 v[0:15], v[144:147], v[120:123], v[0:15]
  ds_read_b128 v[112:115], v162
  ds_read_b64_tr_b16 v[128:129], v168 offset:12288
  s_waitcnt lgkmcnt(5)
  v_mfma_f32_32x32x16_bf16 v[32:47], v[148:151], v[120:123], v[32:47]
  buffer_load_dwordx4 a[88:91], v208, s[12:15], s88 offen offset:3072 sc1
  ds_read_b64_tr_b16 v[130:131], v168 offset:13824
  ds_read_b64_tr_b16 v[132:133], v168 offset:12416
  s_waitcnt lgkmcnt(5)
  v_mfma_f32_32x32x16_bf16 v[64:79], v[120:123], v[152:155], v[64:79]
  ds_read_b64_tr_b16 v[134:135], v168 offset:13952
  ds_read_b64_tr_b16 v[136:137], v168 offset:12544
  s_waitcnt lgkmcnt(6)
  v_mfma_f32_32x32x16_bf16 v[16:31], v[144:147], v[124:127], v[16:31]
  buffer_load_dwordx4 a[92:95], v208, s[12:15], s89 offen offset:3072 sc1
  ds_read_b64_tr_b16 v[138:139], v168 offset:14080
  ds_read_b128 v[116:119], v162 offset:4096
  v_mfma_f32_32x32x16_bf16 v[48:63], v[148:151], v[124:127], v[48:63]
  s_add_u32 s88, s88, 4096
  v_mfma_f32_32x32x16_bf16 v[80:95], v[124:127], v[152:155], v[80:95]
  buffer_load_dwordx4 a[96:99], v208, s[12:15], s88 offen offset:0 sc1
  s_waitcnt lgkmcnt(5)
  v_mfma_f32_32x32x16_bf16 v[0:15], v[128:131], v[112:115], v[0:15]
  ds_read_b128 v[120:123], v163
  ds_read_b64_tr_b16 v[144:145], v168 offset:18432
  s_add_u32 s89, s89, 4096
  s_waitcnt lgkmcnt(5)
  v_mfma_f32_32x32x16_bf16 v[32:47], v[132:135], v[112:115], v[32:47]
  buffer_load_dwordx4 a[100:103], v208, s[12:15], s89 offen offset:0 sc1
  ds_read_b64_tr_b16 v[146:147], v168 offset:19968
  ds_read_b64_tr_b16 v[148:149], v168 offset:18560
  s_waitcnt lgkmcnt(5)
  v_mfma_f32_32x32x16_bf16 v[64:79], v[112:115], v[136:139], v[64:79]
  ds_read_b64_tr_b16 v[150:151], v168 offset:20096
  ds_read_b64_tr_b16 v[152:153], v168 offset:18688
  s_waitcnt lgkmcnt(6)
  v_mfma_f32_32x32x16_bf16 v[16:31], v[128:131], v[116:119], v[16:31]
  buffer_load_dwordx4 a[104:107], v208, s[12:15], s88 offen offset:1024 sc1
  ds_read_b64_tr_b16 v[154:155], v168 offset:20224
  ds_read_b128 v[124:127], v163 offset:4096
  v_mfma_f32_32x32x16_bf16 v[48:63], v[132:135], v[116:119], v[48:63]
  v_mfma_f32_32x32x16_bf16 v[80:95], v[116:119], v[136:139], v[80:95]
  buffer_load_dwordx4 a[108:111], v208, s[12:15], s89 offen offset:1024 sc1
  s_waitcnt lgkmcnt(5)
  v_mfma_f32_32x32x16_bf16 v[0:15], v[144:147], v[120:123], v[0:15]
  s_waitcnt lgkmcnt(3)
  v_mfma_f32_32x32x16_bf16 v[32:47], v[148:151], v[120:123], v[32:47]
  buffer_load_dwordx4 a[112:115], v208, s[12:15], s88 offen offset:2048 sc1
  s_waitcnt lgkmcnt(1)
  v_mfma_f32_32x32x16_bf16 v[64:79], v[120:123], v[152:155], v[64:79]
  s_waitcnt lgkmcnt(0)
  v_mfma_f32_32x32x16_bf16 v[16:31], v[144:147], v[124:127], v[16:31]
  buffer_load_dwordx4 a[116:119], v208, s[12:15], s89 offen offset:2048 sc1
  v_mfma_f32_32x32x16_bf16 v[48:63], v[148:151], v[124:127], v[48:63]
  v_mfma_f32_32x32x16_bf16 v[80:95], v[124:127], v[152:155], v[80:95]
  buffer_load_dwordx4 a[120:123], v208, s[12:15], s88 offen offset:3072 sc1
  s_mov_b32 s62, 0
  s_mov_b32 s63, -1
  v_cndmask_b32 v206, v184, v188, s[62:63]
  v_mfma_f32_32x32x8_bf16 v[0:15], v[190:191], v[182:183], v[0:15]
  ds_write_b32 v232, v206
  v_mfma_f32_32x32x8_bf16 v[16:31], v[190:191], v[186:187], v[16:31]
  ds_read_b128 v[144:147], v233 offset:0
  ds_read_b128 v[148:151], v233 offset:32
  ds_read_b128 v[152:155], v233 offset:64
  ds_read_b128 v[156:159], v233 offset:96
  v_mfma_f32_32x32x8_bf16 v[32:47], v[194:195], v[182:183], v[32:47]
  buffer_load_dwordx4 a[124:127], v208, s[12:15], s89 offen offset:3072 sc1
  ds_read_b128 v[160:163], v233 offset:128
  ds_read_b128 v[164:167], v233 offset:160
  ds_read_b128 v[168:171], v233 offset:192
  ds_read_b128 v[172:175], v233 offset:224
  v_mfma_f32_32x32x8_bf16 v[48:63], v[194:195], v[186:187], v[48:63]
  v_mul_f32 v180, 0x3eb8aa3b, v206
  v_mov_b32 v252, v184
  v_mov_b32 v253, v184
  v_mov_b32 v254, v188
  v_mov_b32 v255, v188
  v_mfma_f32_32x32x8_bf16 v[64:79], v[182:183], v[198:199], v[64:79]
  v_mfma_f32_32x32x8_bf16 v[80:95], v[186:187], v[198:199], v[80:95]
  s_add_u32 s88, s88, 4096
  buffer_load_dwordx4 a[128:131], v208, s[12:15], s88 offen offset:0 sc1
  v_permlane16_swap_b32 v252, v253
  v_permlane16_swap_b32 v254, v255
  v_mul_f32 v176, 0x3eb8aa3b, v252
  v_mul_f32 v177, 0x3eb8aa3b, v253
  v_mul_f32 v178, 0x3eb8aa3b, v254
  v_mul_f32 v179, 0x3eb8aa3b, v255
  v_cvt_pk_bf16_f32 v96, v0, v1
  v_cvt_pk_bf16_f32 v97, v2, v3
  v_cvt_pk_bf16_f32 v98, v4, v5
  v_cvt_pk_bf16_f32 v99, v6, v7
  v_cvt_pk_bf16_f32 v100, v8, v9
  v_cvt_pk_bf16_f32 v101, v10, v11
  v_cvt_pk_bf16_f32 v102, v12, v13
  v_cvt_pk_bf16_f32 v103, v14, v15
  s_add_u32 s89, s89, 4096
  buffer_load_dwordx4 a[132:135], v208, s[12:15], s89 offen offset:0 sc1
  v_cvt_pk_bf16_f32 v104, v16, v17
  v_cvt_pk_bf16_f32 v105, v18, v19
  v_cvt_pk_bf16_f32 v106, v20, v21
  v_cvt_pk_bf16_f32 v107, v22, v23
  v_cvt_pk_bf16_f32 v108, v24, v25
  v_cvt_pk_bf16_f32 v109, v26, v27
  v_cvt_pk_bf16_f32 v110, v28, v29
  v_cvt_pk_bf16_f32 v111, v30, v31
  v_permlane16_swap_b32 v96, v98
  v_permlane16_swap_b32 v97, v99
  v_permlane16_swap_b32 v100, v102
  v_permlane16_swap_b32 v101, v103
  v_permlane16_swap_b32 v104, v106
  v_permlane16_swap_b32 v105, v107
  buffer_load_dwordx4 a[136:139], v208, s[12:15], s88 offen offset:1024 sc1
  v_permlane16_swap_b32 v108, v110
  v_permlane16_swap_b32 v109, v111
  v_pk_mul_f32 v[32:33], v[32:33], v[184:185] op_sel_hi:[1,0]
  v_pk_mul_f32 v[34:35], v[34:35], v[184:185] op_sel_hi:[1,0]
  v_pk_mul_f32 v[36:37], v[36:37], v[184:185] op_sel_hi:[1,0]
  v_pk_mul_f32 v[38:39], v[38:39], v[184:185] op_sel_hi:[1,0]
  v_pk_mul_f32 v[40:41], v[40:41], v[184:185] op_sel_hi:[1,0]
  v_pk_mul_f32 v[42:43], v[42:43], v[184:185] op_sel_hi:[1,0]
  v_pk_mul_f32 v[44:45], v[44:45], v[184:185] op_sel_hi:[1,0]
  v_pk_mul_f32 v[46:47], v[46:47], v[184:185] op_sel_hi:[1,0]
  buffer_load_dwordx4 a[140:143], v208, s[12:15], s89 offen offset:1024 sc1
  v_pk_mul_f32 v[48:49], v[48:49], v[188:189] op_sel_hi:[1,0]
  v_pk_mul_f32 v[50:51], v[50:51], v[188:189] op_sel_hi:[1,0]
  v_pk_mul_f32 v[52:53], v[52:53], v[188:189] op_sel_hi:[1,0]
  v_pk_mul_f32 v[54:55], v[54:55], v[188:189] op_sel_hi:[1,0]
  v_pk_mul_f32 v[56:57], v[56:57], v[188:189] op_sel_hi:[1,0]
  v_pk_mul_f32 v[58:59], v[58:59], v[188:189] op_sel_hi:[1,0]
  v_pk_mul_f32 v[60:61], v[60:61], v[188:189] op_sel_hi:[1,0]
  v_pk_mul_f32 v[62:63], v[62:63], v[188:189] op_sel_hi:[1,0]
  v_cvt_pk_bf16_f32 v112, v32, v33
  v_cvt_pk_bf16_f32 v113, v34, v35
  s_add_u32 s88, s88, s29
  buffer_load_dwordx4 a[144:147], v208, s[12:15], s88 offen offset:0 sc1
  v_cvt_pk_bf16_f32 v114, v36, v37
  v_cvt_pk_bf16_f32 v115, v38, v39
  v_cvt_pk_bf16_f32 v116, v40, v41
  v_cvt_pk_bf16_f32 v117, v42, v43
  v_cvt_pk_bf16_f32 v118, v44, v45
  v_cvt_pk_bf16_f32 v119, v46, v47
  v_cvt_pk_bf16_f32 v120, v48, v49
  v_cvt_pk_bf16_f32 v121, v50, v51
  v_cvt_pk_bf16_f32 v122, v52, v53
  v_cvt_pk_bf16_f32 v123, v54, v55
  v_cvt_pk_bf16_f32 v124, v56, v57
  v_cvt_pk_bf16_f32 v125, v58, v59
  v_cvt_pk_bf16_f32 v126, v60, v61
  v_cvt_pk_bf16_f32 v127, v62, v63
  s_add_u32 s89, s89, s29
  buffer_load_dwordx4 a[148:151], v208, s[12:15], s89 offen offset:0 sc1
  v_permlane16_swap_b32 v112, v114
  v_permlane16_swap_b32 v113, v115
  v_permlane16_swap_b32 v116, v118
  v_permlane16_swap_b32 v117, v119
  v_permlane16_swap_b32 v120, v122
  v_permlane16_swap_b32 v121, v123
  v_permlane16_swap_b32 v124, v126
  v_permlane16_swap_b32 v125, v127
  v_mfma_f32_16x16x16_bf16 v[0:3], v[112:113], v[96:97], v[216:219]
  s_waitcnt lgkmcnt(4)
  v_pk_mul_f32 v[64:65], v[64:65], v[144:145]
  v_pk_mul_f32 v[66:67], v[66:67], v[146:147]
  v_mfma_f32_16x16x16_bf16 v[4:7], v[114:115], v[98:99], v[216:219]
  buffer_load_dwordx4 a[152:155], v208, s[12:15], s88 offen offset:1024 sc1
  v_pk_mul_f32 v[68:69], v[68:69], v[148:149]
  v_pk_mul_f32 v[70:71], v[70:71], v[150:151]
  v_mfma_f32_16x16x16_bf16 v[16:19], v[112:113], v[98:99], v[220:223]
  v_pk_mul_f32 v[72:73], v[72:73], v[152:153]
  v_pk_mul_f32 v[74:75], v[74:75], v[154:155]
  v_mfma_f32_16x16x16_bf16 v[8:11], v[120:121], v[104:105], v[216:219]
  v_pk_mul_f32 v[76:77], v[76:77], v[156:157]
  v_pk_mul_f32 v[78:79], v[78:79], v[158:159]
  buffer_load_dwordx4 a[156:159], v208, s[12:15], s89 offen offset:1024 sc1
  v_mfma_f32_16x16x16_bf16 v[20:23], v[114:115], v[104:105], v[220:223]
  s_waitcnt lgkmcnt(0)
  v_pk_mul_f32 v[80:81], v[80:81], v[160:161]
  v_pk_mul_f32 v[82:83], v[82:83], v[162:163]
  v_mfma_f32_16x16x16_bf16 v[12:15], v[122:123], v[106:107], v[216:219]
  v_pk_mul_f32 v[84:85], v[84:85], v[164:165]
  v_pk_mul_f32 v[86:87], v[86:87], v[166:167]
  v_mfma_f32_16x16x16_bf16 v[24:27], v[120:121], v[106:107], v[220:223]
  v_pk_mul_f32 v[88:89], v[88:89], v[168:169]
  buffer_load_dwordx4 a[160:163], v208, s[12:15], s88 offen offset:2048 sc1
  v_pk_mul_f32 v[90:91], v[90:91], v[170:171]
  v_mfma_f32_16x16x16_bf16 v[28:31], v[116:117], v[100:101], v[216:219]
  v_pk_mul_f32 v[92:93], v[92:93], v[172:173]
  v_pk_mul_f32 v[94:95], v[94:95], v[174:175]
  v_mfma_f32_16x16x16_bf16 v[32:35], v[118:119], v[102:103], v[216:219]
  v_cvt_pk_bf16_f32 v128, v64, v65
  v_cvt_pk_bf16_f32 v129, v66, v67
  v_mfma_f32_16x16x16_bf16 v[44:47], v[116:117], v[102:103], v[220:223]
  buffer_load_dwordx4 a[164:167], v208, s[12:15], s89 offen offset:2048 sc1
  v_cvt_pk_bf16_f32 v136, v68, v69
  v_cvt_pk_bf16_f32 v137, v70, v71
  v_mfma_f32_16x16x16_bf16 v[36:39], v[124:125], v[108:109], v[216:219]
  v_cvt_pk_bf16_f32 v130, v72, v73
  v_cvt_pk_bf16_f32 v131, v74, v75
  v_mfma_f32_16x16x16_bf16 v[48:51], v[118:119], v[108:109], v[220:223]
  v_cvt_pk_bf16_f32 v138, v76, v77
  v_cvt_pk_bf16_f32 v139, v78, v79
  v_mfma_f32_16x16x16_bf16 v[40:43], v[126:127], v[110:111], v[216:219]
  v_cvt_pk_bf16_f32 v132, v80, v81
  buffer_load_dwordx4 a[168:171], v208, s[12:15], s88 offen offset:3072 sc1
  v_cvt_pk_bf16_f32 v133, v82, v83
  v_mfma_f32_16x16x16_bf16 v[52:55], v[124:125], v[110:111], v[220:223]
  v_cvt_pk_bf16_f32 v140, v84, v85
  v_cvt_pk_bf16_f32 v141, v86, v87
  v_cvt_pk_bf16_f32 v134, v88, v89
  v_cvt_pk_bf16_f32 v135, v90, v91
  v_cvt_pk_bf16_f32 v142, v92, v93
  v_cvt_pk_bf16_f32 v143, v94, v95
  v_permlane32_swap_b32 v128, v136
  v_permlane32_swap_b32 v129, v137
  v_permlane32_swap_b32 v130, v138
  v_permlane32_swap_b32 v131, v139
  v_permlane32_swap_b32 v132, v140
  buffer_load_dwordx4 a[172:175], v208, s[12:15], s89 offen offset:3072 sc1
  v_permlane32_swap_b32 v133, v141
  v_permlane32_swap_b32 v134, v142
  v_permlane32_swap_b32 v135, v143
  v_permlane16_swap_b32 v128, v136
  v_permlane16_swap_b32 v129, v137
  v_permlane16_swap_b32 v130, v138
  v_permlane16_swap_b32 v131, v139
  v_permlane16_swap_b32 v132, v140
  v_permlane16_swap_b32 v133, v141
  v_permlane16_swap_b32 v134, v142
  v_permlane16_swap_b32 v135, v143
  v_max_f32 v4, v4, v16
  v_max_f32 v5, v5, v17
  v_max_f32 v6, v6, v18
  s_add_u32 s88, s88, s32
  buffer_load_dwordx4 a[176:179], v208, s[12:15], s88 offen offset:0 sc1
  v_max_f32 v7, v7, v19
  v_max_f32 v8, v8, v20
  v_max_f32 v9, v9, v21
  v_max_f32 v10, v10, v22
  v_max_f32 v11, v11, v23
  v_max_f32 v12, v12, v24
  v_max_f32 v13, v13, v25
  v_max_f32 v14, v14, v26
  v_max_f32 v15, v15, v27
  v_max_f32 v32, v32, v44
  v_max_f32 v33, v33, v45
  v_max_f32 v34, v34, v46
  v_max_f32 v35, v35, v47
  v_max_f32 v36, v36, v48
  s_add_u32 s89, s89, s32
  buffer_load_dwordx4 a[180:183], v208, s[12:15], s89 offen offset:0 sc1
  v_max_f32 v37, v37, v49
  v_max_f32 v38, v38, v50
  v_max_f32 v39, v39, v51
  v_max_f32 v40, v40, v52
  v_max_f32 v41, v41, v53
  v_max_f32 v42, v42, v54
  v_max_f32 v43, v43, v55
  v_max3_f32 v64, v0, v1, v2
  v_max3_f32 v65, v4, v5, v6
  v_max3_f32 v66, v8, v9, v10
  v_max3_f32 v67, v12, v13, v14
  v_max3_f32 v68, v28, v29, v30
  v_max3_f32 v69, v32, v33, v34
  v_max3_f32 v70, v36, v37, v38
  buffer_load_dwordx4 a[184:187], v208, s[12:15], s88 offen offset:1024 sc1
  v_max3_f32 v71, v40, v41, v42
  v_max_f32 v64, v64, v3
  v_max_f32 v65, v65, v7
  v_max_f32 v66, v66, v11
  v_max_f32 v67, v67, v15
  v_max_f32 v68, v68, v31
  v_max_f32 v69, v69, v35
  v_max_f32 v70, v70, v39
  v_max_f32 v71, v71, v43
  v_permlane16_swap_b32 v64, v65
  v_permlane16_swap_b32 v66, v67
  v_permlane16_swap_b32 v68, v69
  v_permlane16_swap_b32 v70, v71
  v_max_f32 v64, v64, v65
  buffer_load_dwordx4 a[188:191], v208, s[12:15], s89 offen offset:1024 sc1
  v_max_f32 v66, v66, v67
  v_max_f32 v68, v68, v69
  v_max_f32 v70, v70, v71
  v_permlane32_swap_b32 v64, v66
  s_nop 0
  v_permlane32_swap_b32 v68, v70
  v_max_f32 v64, v64, v66
  v_max_f32 v68, v68, v70
  v_mul_f32 v64, -v64, v180
  v_mul_f32 v68, -v68, v180
  v_mov_b32 v66, v64
  v_mov_b32 v70, v68
  s_nop 0
  v_permlane32_swap_b32 v64, v66
  v_permlane32_swap_b32 v68, v70
  v_mov_b32 v65, v64
  buffer_load_dwordx4 a[192:195], v208, s[12:15], s88 offen offset:2048 sc1
  v_mov_b32 v67, v66
  v_mov_b32 v69, v68
  v_mov_b32 v71, v70
  v_permlane16_swap_b32 v64, v65
  v_permlane16_swap_b32 v66, v67
  v_permlane16_swap_b32 v68, v69
  v_permlane16_swap_b32 v70, v71
  v_fma_f32 v0, v0, v176, v64
  v_fma_f32 v1, v1, v176, v64
  v_fma_f32 v2, v2, v176, v64
  v_fma_f32 v3, v3, v176, v64
  v_fma_f32 v4, v4, v177, v65
  v_fma_f32 v5, v5, v177, v65
  v_fma_f32 v6, v6, v177, v65
  buffer_load_dwordx4 a[196:199], v208, s[12:15], s89 offen offset:2048 sc1
  v_fma_f32 v7, v7, v177, v65
  v_fma_f32 v8, v8, v178, v66
  v_fma_f32 v9, v9, v178, v66
  v_fma_f32 v10, v10, v178, v66
  v_fma_f32 v11, v11, v178, v66
  v_fma_f32 v12, v12, v179, v67
  v_fma_f32 v13, v13, v179, v67
  v_fma_f32 v14, v14, v179, v67
  v_fma_f32 v15, v15, v179, v67
  v_fma_f32 v28, v28, v176, v68
  v_fma_f32 v29, v29, v176, v68
  v_fma_f32 v30, v30, v176, v68
  v_fma_f32 v31, v31, v176, v68
  v_fma_f32 v32, v32, v177, v69
  buffer_load_dwordx4 a[200:203], v208, s[12:15], s88 offen offset:3072 sc1
  v_fma_f32 v33, v33, v177, v69
  v_fma_f32 v34, v34, v177, v69
  v_fma_f32 v35, v35, v177, v69
  v_fma_f32 v36, v36, v178, v70
  v_fma_f32 v37, v37, v178, v70
  v_fma_f32 v38, v38, v178, v70
  v_fma_f32 v39, v39, v178, v70
  v_fma_f32 v40, v40, v179, v71
  v_fma_f32 v41, v41, v179, v71
  v_fma_f32 v42, v42, v179, v71
  v_fma_f32 v43, v43, v179, v71
  v_exp_f32 v0, v0
  v_exp_f32 v1, v1
  buffer_load_dwordx4 a[204:207], v208, s[12:15], s89 offen offset:3072 sc1
  v_exp_f32 v2, v2
  v_exp_f32 v3, v3
  v_exp_f32 v4, v4
  v_exp_f32 v5, v5
  v_exp_f32 v6, v6
  v_exp_f32 v7, v7
  v_exp_f32 v8, v8
  v_exp_f32 v9, v9
  v_exp_f32 v10, v10
  s_add_u32 s88, s88, 4096
  buffer_load_dwordx4 a[208:211], v208, s[12:15], s88 offen offset:0 sc1
  v_exp_f32 v11, v11
  v_exp_f32 v12, v12
  v_exp_f32 v13, v13
  v_exp_f32 v14, v14
  v_exp_f32 v15, v15
  v_exp_f32 v28, v28
  v_exp_f32 v29, v29
  v_exp_f32 v30, v30
  v_exp_f32 v31, v31
  s_add_u32 s89, s89, 4096
  buffer_load_dwordx4 a[212:215], v208, s[12:15], s89 offen offset:0 sc1
  v_exp_f32 v32, v32
  v_exp_f32 v33, v33
  v_exp_f32 v34, v34
  v_exp_f32 v35, v35
  v_exp_f32 v36, v36
  v_exp_f32 v37, v37
  v_exp_f32 v38, v38
  v_exp_f32 v39, v39
  v_exp_f32 v40, v40
  buffer_load_dwordx4 a[216:219], v208, s[12:15], s88 offen offset:1024 sc1
  v_exp_f32 v41, v41
  v_exp_f32 v42, v42
  v_exp_f32 v43, v43
  v_cvt_pk_bf16_f32 v98, v0, v1
  v_cvt_pk_bf16_f32 v99, v2, v3
  v_cvt_pk_bf16_f32 v102, v4, v5
  v_cvt_pk_bf16_f32 v103, v6, v7
  v_cvt_pk_bf16_f32 v106, v8, v9
  v_cvt_pk_bf16_f32 v107, v10, v11
  v_cvt_pk_bf16_f32 v110, v12, v13
  v_cvt_pk_bf16_f32 v111, v14, v15
  v_cvt_pk_bf16_f32 v114, v28, v29
  v_cvt_pk_bf16_f32 v115, v30, v31
  buffer_load_dwordx4 a[220:223], v208, s[12:15], s89 offen offset:1024 sc1
  v_cvt_pk_bf16_f32 v118, v32, v33
  v_cvt_pk_bf16_f32 v119, v34, v35
  v_cvt_pk_bf16_f32 v122, v36, v37
  v_cvt_pk_bf16_f32 v123, v38, v39
  v_cvt_pk_bf16_f32 v126, v40, v41
  v_cvt_pk_bf16_f32 v127, v42, v43
  v_and_b32 v100, v102, v224
  v_and_b32 v101, v103, v225
  v_and_b32 v104, v106, v224
  v_and_b32 v105, v107, v225
  v_and_b32 v108, v110, v224
  v_and_b32 v109, v111, v225
  v_xor_b32 v102, v102, v100
  v_xor_b32 v103, v103, v101
  buffer_load_dwordx4 a[224:227], v208, s[12:15], s88 offen offset:2048 sc1
  v_xor_b32 v106, v106, v104
  v_xor_b32 v107, v107, v105
  v_xor_b32 v110, v110, v108
  v_xor_b32 v111, v111, v109
  v_and_b32 v116, v118, v224
  v_and_b32 v117, v119, v225
  v_and_b32 v120, v122, v224
  v_and_b32 v121, v123, v225
  v_and_b32 v124, v126, v224
  v_and_b32 v125, v127, v225
  v_xor_b32 v118, v118, v116
  v_xor_b32 v119, v119, v117
  v_xor_b32 v122, v122, v120
  v_xor_b32 v123, v123, v121
  buffer_load_dwordx4 a[228:231], v208, s[12:15], s89 offen offset:2048 sc1
  v_xor_b32 v126, v126, v124
  v_xor_b32 v127, v127, v125
  v_mfma_f32_16x16x16_bf16 v[0:3], v[226:227], v[98:99], 0
  v_mfma_f32_16x16x16_bf16 v[144:147], v[128:129], v[98:99], 0
  v_mfma_f32_16x16x32_bf16 v[4:7], v[226:229], v[100:103], 0
  v_mfma_f32_16x16x32_bf16 v[148:151], v[128:131], v[100:103], 0
  v_mfma_f32_16x16x32_bf16 v[8:11], v[226:229], v[104:107], 0
  buffer_load_dwordx4 a[232:235], v208, s[12:15], s88 offen offset:3072 sc1
  v_mfma_f32_16x16x32_bf16 v[152:155], v[130:133], v[104:107], 0
  v_mfma_f32_16x16x32_bf16 v[12:15], v[226:229], v[108:111], 0
  v_mfma_f32_16x16x32_bf16 v[156:159], v[132:135], v[108:111], 0
  v_mfma_f32_16x16x16_bf16 v[16:19], v[226:227], v[114:115], 0
  v_mfma_f32_16x16x16_bf16 v[160:163], v[136:137], v[114:115], 0
  v_mfma_f32_16x16x32_bf16 v[20:23], v[226:229], v[116:119], 0
  buffer_load_dwordx4 a[236:239], v208, s[12:15], s89 offen offset:3072 sc1
  v_mfma_f32_16x16x32_bf16 v[164:167], v[136:139], v[116:119], 0
  v_mfma_f32_16x16x32_bf16 v[24:27], v[226:229], v[120:123], 0
  v_mfma_f32_16x16x32_bf16 v[168:171], v[138:141], v[120:123], 0
  v_mfma_f32_16x16x32_bf16 v[28:31], v[226:229], v[124:127], 0
  v_mfma_f32_16x16x32_bf16 v[172:175], v[140:143], v[124:127], 0
  v_mul_f32 v0, v0, v252
  v_mul_f32 v4, v4, v253
  v_mul_f32 v8, v8, v254
  v_mul_f32 v12, v12, v255
  v_mul_f32 v16, v16, v252
  v_mul_f32 v20, v20, v253
  v_mul_f32 v24, v24, v254
  v_mul_f32 v28, v28, v255
  v_rcp_f32 v0, v0
  v_rcp_f32 v4, v4
  v_rcp_f32 v8, v8
  v_rcp_f32 v12, v12
  v_rcp_f32 v16, v16
  v_rcp_f32 v20, v20
  v_rcp_f32 v24, v24
  v_rcp_f32 v28, v28
  v_pk_mul_f32 v[144:145], v[144:145], v[0:1] op_sel_hi:[1,0]
  v_pk_mul_f32 v[146:147], v[146:147], v[0:1] op_sel_hi:[1,0]
  v_pk_mul_f32 v[148:149], v[148:149], v[4:5] op_sel_hi:[1,0]
  v_pk_mul_f32 v[150:151], v[150:151], v[4:5] op_sel_hi:[1,0]
  v_pk_mul_f32 v[152:153], v[152:153], v[8:9] op_sel_hi:[1,0]
  v_pk_mul_f32 v[154:155], v[154:155], v[8:9] op_sel_hi:[1,0]
  v_pk_mul_f32 v[156:157], v[156:157], v[12:13] op_sel_hi:[1,0]
  v_pk_mul_f32 v[158:159], v[158:159], v[12:13] op_sel_hi:[1,0]
  v_pk_mul_f32 v[160:161], v[160:161], v[16:17] op_sel_hi:[1,0]
  v_pk_mul_f32 v[162:163], v[162:163], v[16:17] op_sel_hi:[1,0]
  v_pk_mul_f32 v[164:165], v[164:165], v[20:21] op_sel_hi:[1,0]
  v_pk_mul_f32 v[166:167], v[166:167], v[20:21] op_sel_hi:[1,0]
  v_pk_mul_f32 v[168:169], v[168:169], v[24:25] op_sel_hi:[1,0]
  v_pk_mul_f32 v[170:171], v[170:171], v[24:25] op_sel_hi:[1,0]
  v_pk_mul_f32 v[172:173], v[172:173], v[28:29] op_sel_hi:[1,0]
  v_pk_mul_f32 v[174:175], v[174:175], v[28:29] op_sel_hi:[1,0]
  v_cvt_pk_bf16_f32 v64, v144, v145
  v_cvt_pk_bf16_f32 v65, v146, v147
  v_cvt_pk_bf16_f32 v66, v148, v149
  v_cvt_pk_bf16_f32 v67, v150, v151
  v_cvt_pk_bf16_f32 v68, v152, v153
  v_cvt_pk_bf16_f32 v69, v154, v155
  v_cvt_pk_bf16_f32 v70, v156, v157
  v_cvt_pk_bf16_f32 v71, v158, v159
  v_cvt_pk_bf16_f32 v72, v160, v161
  v_cvt_pk_bf16_f32 v73, v162, v163
  v_cvt_pk_bf16_f32 v74, v164, v165
  v_cvt_pk_bf16_f32 v75, v166, v167
  v_cvt_pk_bf16_f32 v76, v168, v169
  v_cvt_pk_bf16_f32 v77, v170, v171
  v_cvt_pk_bf16_f32 v78, v172, v173
  v_cvt_pk_bf16_f32 v79, v174, v175
  v_permlane16_swap_b32 v64, v66
  v_permlane16_swap_b32 v65, v67
  v_permlane16_swap_b32 v68, v70
  v_permlane16_swap_b32 v69, v71
  v_permlane16_swap_b32 v72, v74
  v_permlane16_swap_b32 v73, v75
  v_permlane16_swap_b32 v76, v78
  v_permlane16_swap_b32 v77, v79
  buffer_store_dwordx4 v[64:67], v230, s[12:15], 0 offen offset:0 sc1
  buffer_store_dwordx4 v[68:71], v231, s[12:15], 0 offen offset:0 sc1
  buffer_store_dwordx4 v[72:75], v230, s[12:15], 0 offen offset:1024 sc1
  buffer_store_dwordx4 v[76:79], v231, s[12:15], 0 offen offset:1024 sc1
  s_and_b32 s61, s56, 63
  s_lshr_b32 s96, s56, 6
  s_and_b32 s96, s96, 62
  s_and_b32 s97, s56, 1
  s_or_b32 s96, s96, s97
  s_lshl_b32 s96, s96, 8
  s_or_b32 s61, s61, s96
  v_lshrrev_b32 v168, 5, v209
  v_lshlrev_b32 v168, 3, v168
  v_lshrrev_b32 v168, v168, s61
  v_lshlrev_b32 v169, 15, v168
  v_lshl_or_b32 v169, v168, 30, v169
  v_and_b32 v216, 0x80008000, v169
  v_lshrrev_b32 v168, 2, v168
  v_lshlrev_b32 v169, 15, v168
  v_lshl_or_b32 v169, v168, 30, v169
  v_and_b32 v218, 0x80008000, v169
  v_lshrrev_b32 v168, 2, v168
  v_lshlrev_b32 v169, 15, v168
  v_lshl_or_b32 v169, v168, 30, v169
L_stub_att_2:
  s_cmp_eq_u32 s86, 1
  s_cbranch_scc1 L_tret_att_2
  v_and_b32 v219, 0x80008000, v169
  v_xor_b32 v217, 0x80008000, v216
  v_mov_b32 v252, s56
  v_mov_b32 v253, s57
  s_waitcnt vmcnt(0)
  buffer_store_dwordx2 v[252:253], v238, s[12:15], 0 offen sc1
  s_mov_b32 s37, 0x80008000
  s_mov_b32 s58, 0
L_pp_20:
  s_add_u32 s58, s58, 1
  s_cmp_ge_u32 s58, 262144
  s_cbranch_scc1 L_ppok_21
  buffer_load_dwordx4 v[72:75], v181, s[12:15], s39 offen offset:1024 sc1
  buffer_load_dwordx4 v[76:79], v239, s[12:15], s39 offen offset:1024 sc1
  s_waitcnt vmcnt(0)
  v_bitop3_b32 v168, v72, v76, v216 bitop3:0x7e
  v_bitop3_b32 v169, v73, v77, v217 bitop3:0x7e
  v_bitop3_b32 v170, v74, v78, v218 bitop3:0x7e
  v_bitop3_b32 v171, v75, v79, v219 bitop3:0x7e
  v_or3_b32 v168, v168, v169, v170
  v_bitop3_b32 v168, v168, v171, s37 bitop3:0xa8
  v_cmp_ne_u32 s[30:31], 0, v168
  s_nop 0
  s_cmp_lg_u64 s[30:31], 0
  s_cbranch_scc1 L_pp_20
L_ppok_21:
  buffer_load_dwordx4 v[64:67], v181, s[12:15], s24 offen offset:0 sc1
  buffer_load_dwordx4 v[68:71], v239, s[12:15], s24 offen offset:0 sc1
  buffer_load_dwordx4 v[72:75], v181, s[12:15], s24 offen offset:1024 sc1
  buffer_load_dwordx4 v[76:79], v239, s[12:15], s24 offen offset:1024 sc1
  buffer_load_dwordx4 v[80:83], v181, s[12:15], s24 offen offset:2048 sc1
  buffer_load_dwordx4 v[84:87], v239, s[12:15], s24 offen offset:2048 sc1
  buffer_load_dwordx4 v[88:91], v181, s[12:15], s24 offen offset:3072 sc1
  buffer_load_dwordx4 v[92:95], v239, s[12:15], s24 offen offset:3072 sc1
  buffer_load_dwordx4 v[96:99], v181, s[12:15], s38 offen offset:0 sc1
  buffer_load_dwordx4 v[100:103], v239, s[12:15], s38 offen offset:0 sc1
  buffer_load_dwordx4 v[104:107], v181, s[12:15], s38 offen offset:1024 sc1
  buffer_load_dwordx4 v[108:111], v239, s[12:15], s38 offen offset:1024 sc1
  buffer_load_dwordx4 v[112:115], v181, s[12:15], s38 offen offset:2048 sc1
  buffer_load_dwordx4 v[116:119], v239, s[12:15], s38 offen offset:2048 sc1
  buffer_load_dwordx4 v[120:123], v181, s[12:15], s38 offen offset:3072 sc1
  buffer_load_dwordx4 v[124:127], v239, s[12:15], s38 offen offset:3072 sc1
  s_mov_b32 s37, 0x80008000
  s_mov_b32 s58, 0
  s_branch L_p2
.p2align 12
L_wide:
  s_add_u32 s101, s42, 240
  s_lshl_b32 s61, s44, 1
  s_add_u32 s61, s61, s46
  s_lshl_b32 s96, s45, 6
  s_add_u32 s61, s61, s96
  s_lshl_b32 s61, s61, 10
  v_lshrrev_b32 v1, 3, v209
  v_lshrrev_b32 v2, 4, v209
  v_and_b32 v3, 7, v209
  v_xor_b32 v3, v3, v2
  v_lshlrev_b32 v1, 11, v1
  v_add_u32 v1, s61, v1
  v_lshl_add_u32 v170, v3, 4, v1
  v_xor_b32 v3, 4, v3
  v_lshl_add_u32 v171, v3, 4, v1
  v_add_u32 v171, 0x4000, v171
  v_add_u32 v172, 0x8000, v170
  v_add_u32 v173, 0x8000, v171
  s_lshl_b32 s54, s3, 12
  s_mul_i32 s55, s3, 7168
  s_add_u32 s55, s55, 0x4000
  s_mul_i32 s96, s3, 44032
  s_add_u32 s96, s96, 2304
  v_add_u32 v1, 0, v209
  v_mul_u32_u24 v2, 293, v1
  v_lshrrev_b32 v2, 13, v2
  v_mul_u32_u24 v3, 28, v2
  v_sub_u32 v1, v1, v3
  v_mul_u32_u24 v2, 2752, v2
  v_lshl_add_u32 v1, v1, 4, v2
  v_add_u32 v174, s96, v1
  v_add_u32 v1, 64, v209
  v_mul_u32_u24 v2, 293, v1
  v_lshrrev_b32 v2, 13, v2
  v_mul_u32_u24 v3, 28, v2
  v_sub_u32 v1, v1, v3
  v_mul_u32_u24 v2, 2752, v2
  v_lshl_add_u32 v1, v1, 4, v2
  v_add_u32 v175, s96, v1
  v_add_u32 v1, 128, v209
  v_mul_u32_u24 v2, 293, v1
  v_lshrrev_b32 v2, 13, v2
  v_mul_u32_u24 v3, 28, v2
  v_sub_u32 v1, v1, v3
  v_mul_u32_u24 v2, 2752, v2
  v_lshl_add_u32 v1, v1, 4, v2
  v_add_u32 v176, s96, v1
  v_add_u32 v1, 192, v209
  v_mul_u32_u24 v2, 293, v1
  v_lshrrev_b32 v2, 13, v2
  v_mul_u32_u24 v3, 28, v2
  v_sub_u32 v1, v1, v3
  v_mul_u32_u24 v2, 2752, v2
  v_lshl_add_u32 v1, v1, 4, v2
  v_add_u32 v177, s96, v1
  v_add_u32 v1, 256, v209
  v_mul_u32_u24 v2, 293, v1
  v_lshrrev_b32 v2, 13, v2
  v_mul_u32_u24 v3, 28, v2
  v_sub_u32 v1, v1, v3
  v_mul_u32_u24 v2, 2752, v2
  v_lshl_add_u32 v1, v1, 4, v2
  v_add_u32 v178, s96, v1
  v_add_u32 v1, 320, v209
  v_mul_u32_u24 v2, 293, v1
  v_lshrrev_b32 v2, 13, v2
  v_mul_u32_u24 v3, 28, v2
  v_sub_u32 v1, v1, v3
  v_mul_u32_u24 v2, 2752, v2
  v_lshl_add_u32 v1, v1, 4, v2
  v_add_u32 v179, s96, v1
  v_add_u32 v1, 384, v209
  v_mul_u32_u24 v2, 293, v1
  v_lshrrev_b32 v2, 13, v2
  v_mul_u32_u24 v3, 28, v2
  v_sub_u32 v1, v1, v3
  v_mul_u32_u24 v2, 2752, v2
  v_lshl_add_u32 v1, v1, 4, v2
  v_add_u32 v180, s96, v1
  s_waitcnt lgkmcnt(0)
  s_mov_b32 s4, s24
  s_and_b32 s5, s25, 0xffff
  s_mov_b32 s6, 2097152
  s_mov_b32 s7, 0x00020000
  s_mov_b32 s8, s32
  s_and_b32 s9, s33, 0xffff
  s_mov_b32 s10, 1409024
  s_mov_b32 s11, 0x00020000
  s_mov_b32 s12, s38
  s_and_b32 s13, s39, 0xffff
  s_mov_b32 s14, 0x10000000
  s_mov_b32 s15, 0x00020000
  s_mov_b32 s16, s36
  s_and_b32 s17, s37, 0xffff
  s_mov_b32 s18, 2097152
  s_mov_b32 s19, 0x00020000
  s_mov_b32 s51, 0
  s_mov_b32 s52, 0
  s_add_u32 m0, s54, 0
  s_nop 0
  buffer_load_dwordx4 v170, s[4:7], s51 offen lds
  s_and_b32 s61, s40, 1
  s_lshl_b32 s61, s61, 9
  s_lshr_b32 s96, s40, 1
  s_lshl_b32 s96, s96, 7
  s_add_u32 s61, s61, s96
  s_lshl_b32 s96, s41, 2
  s_add_u32 s61, s61, s96
  s_add_u32 s61, s61, s3
  s_lshl_b32 s90, s61, 11
  v_and_b32 v1, 31, v209
  s_add_u32 m0, s54, 1024
  s_nop 0
  buffer_load_dwordx4 v171, s[4:7], s51 offen lds
  s_lshl_b32 s61, s45, 6
  v_add_u32 v1, s61, v1
  v_lshlrev_b32 v1, 7, v1
  v_bfe_u32 v2, v209, 1, 3
  v_lshrrev_b32 v3, 5, v209
  v_xor_b32 v2, v2, v3
  s_lshl_b32 s61, s46, 12
  v_add_u32 v5, s61, v1
  s_xor_b32 s61, s61, 0x1000
  v_add_u32 v6, s61, v1
  s_add_u32 m0, s54, 2048
  s_nop 0
  buffer_load_dwordx4 v172, s[4:7], s51 offen lds
  v_xor_b32 v4, 0, v2
  v_lshl_add_u32 v160, v4, 4, v5
  v_lshl_add_u32 v164, v4, 4, v6
  v_xor_b32 v4, 2, v2
  v_lshl_add_u32 v161, v4, 4, v5
  v_lshl_add_u32 v165, v4, 4, v6
  v_xor_b32 v4, 4, v2
  v_lshl_add_u32 v162, v4, 4, v5
  v_lshl_add_u32 v166, v4, 4, v6
  v_xor_b32 v4, 6, v2
  s_add_u32 m0, s54, 3072
  s_nop 0
  buffer_load_dwordx4 v173, s[4:7], s51 offen lds
  v_lshl_add_u32 v163, v4, 4, v5
  v_lshl_add_u32 v167, v4, 4, v6
  v_bfe_u32 v1, v209, 2, 2
  v_lshrrev_b32 v2, 5, v209
  v_lshl_add_u32 v1, v2, 3, v1
  v_mul_u32_u24 v1, 448, v1
  v_bfe_u32 v2, v209, 4, 1
  v_lshl_add_u32 v1, v2, 5, v1
  v_and_b32 v2, 3, v209
  v_lshl_add_u32 v1, v2, 3, v1
  s_add_u32 m0, s55, 0
  s_nop 0
  buffer_load_dwordx4 v174, s[8:11], s52 offen lds
  v_add_u32 v1, 0x4000, v1
  s_lshl_b32 s61, s46, 6
  v_add_u32 v168, s61, v1
  v_add_u32 v169, 384, v1
  s_add_u32 m0, s55, 1024
  s_nop 0
  buffer_load_dwordx4 v175, s[8:11], s52 offen lds
  s_add_u32 m0, s55, 2048
  s_nop 0
  buffer_load_dwordx4 v176, s[8:11], s52 offen lds
  s_add_u32 m0, s55, 3072
  s_nop 0
  buffer_load_dwordx4 v177, s[8:11], s52 offen lds
  s_add_u32 m0, s55, 4096
  s_nop 0
  buffer_load_dwordx4 v178, s[8:11], s52 offen lds
  s_add_u32 m0, s55, 5120
  s_nop 0
  buffer_load_dwordx4 v179, s[8:11], s52 offen lds
  s_add_u32 m0, s55, 6144
  s_nop 0
  buffer_load_dwordx4 v180, s[8:11], s52 offen lds
  v_mov_b32 v210, 0
  buffer_load_dword v210, v210, s[12:15], 0 offen sc1
  s_mov_b32 s51, 128
  s_mov_b32 s52, 176128
  s_add_u32 m0, s54, 45056
  s_nop 0
  buffer_load_dwordx4 v170, s[4:7], s51 offen lds
  s_add_u32 m0, s54, 46080
  s_nop 0
  buffer_load_dwordx4 v171, s[4:7], s51 offen lds
  s_add_u32 m0, s54, 47104
  s_nop 0
  buffer_load_dwordx4 v172, s[4:7], s51 offen lds
  s_add_u32 m0, s54, 48128
  s_nop 0
  buffer_load_dwordx4 v173, s[4:7], s51 offen lds
  s_add_u32 m0, s55, 45056
  s_nop 0
  buffer_load_dwordx4 v174, s[8:11], s52 offen lds
  s_add_u32 m0, s55, 46080
  s_nop 0
  buffer_load_dwordx4 v175, s[8:11], s52 offen lds
  s_add_u32 m0, s55, 47104
  s_nop 0
  buffer_load_dwordx4 v176, s[8:11], s52 offen lds
  s_add_u32 m0, s55, 48128
  s_nop 0
  buffer_load_dwordx4 v177, s[8:11], s52 offen lds
  s_add_u32 m0, s55, 49152
  s_nop 0
  buffer_load_dwordx4 v178, s[8:11], s52 offen lds
  s_add_u32 m0, s55, 50176
  s_nop 0
  buffer_load_dwordx4 v179, s[8:11], s52 offen lds
  s_add_u32 m0, s55, 51200
  s_nop 0
  buffer_load_dwordx4 v180, s[8:11], s52 offen lds
  s_cmp_lg_u32 s3, 1
  s_cbranch_scc1 L_tskip_wide_0
  s_mov_b32 s86, 1
  s_branch L_stub_wide_0
L_tret_wide_0:
  s_mov_b32 s86, 0
L_tskip_wide_0:
  s_cmp_lg_u32 s3, 2
  s_cbranch_scc1 L_tskip_wide_1
  s_mov_b32 s86, 1
  s_branch L_stub_wide_1
L_tret_wide_1:
  s_mov_b32 s86, 0
L_tskip_wide_1:
  s_mov_b32 s51, 256
  s_mov_b32 s52, 352256
  s_add_u32 m0, s54, 90112
  s_nop 0
  buffer_load_dwordx4 v170, s[4:7], s51 offen lds
  s_add_u32 m0, s54, 91136
  s_nop 0
  buffer_load_dwordx4 v171, s[4:7], s51 offen lds
  s_add_u32 m0, s54, 92160
  s_nop 0
  buffer_load_dwordx4 v172, s[4:7], s51 offen lds
  s_add_u32 m0, s54, 93184
  s_nop 0
  buffer_load_dwordx4 v173, s[4:7], s51 offen lds
  s_add_u32 m0, s55, 90112
  s_nop 0
  buffer_load_dwordx4 v174, s[8:11], s52 offen lds
  s_add_u32 m0, s55, 91136
  s_nop 0
  buffer_load_dwordx4 v175, s[8:11], s52 offen lds
  s_add_u32 m0, s55, 92160
  s_nop 0
  buffer_load_dwordx4 v176, s[8:11], s52 offen lds
  s_waitcnt vmcnt(19)
  s_barrier
  ds_read_b128 v[112:115], v160
  ds_read_b64_tr_b16 v[128:129], v168 offset:0
  ds_read_b64_tr_b16 v[130:131], v168 offset:1792
  ds_read_b64_tr_b16 v[132:133], v168 offset:128
  ds_read_b64_tr_b16 v[134:135], v168 offset:1920
  ds_read_b64_tr_b16 v[136:137], v168 offset:256
  ds_read_b64_tr_b16 v[138:139], v168 offset:2048
  ds_read_b64_tr_b16 v[140:141], v169 offset:0
  ds_read_b64_tr_b16 v[142:143], v169 offset:1792
  ds_read_b128 v[116:119], v164
  s_waitcnt lgkmcnt(7)
  v_mfma_f32_32x32x16_bf16 v[0:15], v[128:131], v[112:115], 0
  ds_read_b128 v[120:123], v161
  ds_read_b64_tr_b16 v[144:145], v168 offset:7168
  s_waitcnt vmcnt(18)
  v_readfirstlane_b32 s56, v210
  s_nop 0
  s_mul_i32 s56, s56, 0x9E3779B1
  s_waitcnt lgkmcnt(7)
  v_mfma_f32_32x32x16_bf16 v[32:47], v[132:135], v[112:115], 0
  ds_read_b64_tr_b16 v[146:147], v168 offset:8960
  ds_read_b64_tr_b16 v[148:149], v168 offset:7296
  s_add_u32 s56, s56, 0x7F4A7C15
  s_not_b32 s57, s56
  s_add_u32 m0, s55, 93184
  s_waitcnt lgkmcnt(7)
  v_mfma_f32_32x32x16_bf16 v[64:79], v[136:139], v[112:115], 0
  buffer_load_dwordx4 v177, s[8:11], s52 offen lds
  ds_read_b64_tr_b16 v[150:151], v168 offset:9088
  ds_read_b64_tr_b16 v[152:153], v168 offset:7424
  v_min_u32 v183, 29, v209
  s_mul_i32 s61, s60, 30
  s_waitcnt lgkmcnt(7)
  v_mfma_f32_32x32x16_bf16 v[96:111], v[140:143], v[112:115], 0
  ds_read_b64_tr_b16 v[154:155], v168 offset:9216
  ds_read_b64_tr_b16 v[156:157], v169 offset:7168
  v_add_u32 v183, s61, v183
  v_lshlrev_b32 v183, 3, v183
  v_add_u32 v215, 12288, v183
  s_waitcnt lgkmcnt(8)
  v_mfma_f32_32x32x16_bf16 v[16:31], v[128:131], v[116:119], 0
  ds_read_b64_tr_b16 v[158:159], v169 offset:8960
  ds_read_b128 v[124:127], v165
  v_and_b32 v182, 31, v209
  s_lshl_b32 s61, s45, 10
  s_add_u32 m0, s55, 94208
  v_mfma_f32_32x32x16_bf16 v[48:63], v[132:135], v[116:119], 0
  buffer_load_dwordx4 v178, s[8:11], s52 offen lds
  s_xor_b32 s96, s46, 0
  s_lshl_b32 s96, s96, 5
  s_add_u32 s96, s96, s44
  v_add_u32 v183, s96, v182
  v_mfma_f32_32x32x16_bf16 v[80:95], v[136:139], v[116:119], 0
  v_min_u32 v183, 0x3ff, v183
  v_add_u32 v183, s61, v183
  v_lshlrev_b32 v183, 4, v183
  v_add_u32 v211, 65536, v183
  s_xor_b32 s96, s46, 1
  s_waitcnt lgkmcnt(7)
  v_mfma_f32_32x32x16_bf16 v[0:15], v[144:147], v[120:123], v[0:15]
  ds_read_b128 v[112:115], v162
  ds_read_b64_tr_b16 v[128:129], v168 offset:14336
  v_add_u32 v160, 0xb000, v160
  v_add_u32 v164, 0xb000, v164
  s_add_u32 m0, s55, 95232
  s_waitcnt lgkmcnt(7)
  v_mfma_f32_32x32x16_bf16 v[32:47], v[148:151], v[120:123], v[32:47]
  buffer_load_dwordx4 v179, s[8:11], s52 offen lds
  ds_read_b64_tr_b16 v[130:131], v168 offset:16128
  ds_read_b64_tr_b16 v[132:133], v168 offset:14464
  v_add_u32 v161, 0xb000, v161
  v_add_u32 v165, 0xb000, v165
  s_waitcnt lgkmcnt(7)
  v_mfma_f32_32x32x16_bf16 v[64:79], v[152:155], v[120:123], v[64:79]
  ds_read_b64_tr_b16 v[134:135], v168 offset:16256
  ds_read_b64_tr_b16 v[136:137], v168 offset:14592
  s_lshl_b32 s96, s96, 5
  s_add_u32 s96, s96, s44
  s_add_u32 m0, s55, 96256
  s_waitcnt lgkmcnt(7)
  v_mfma_f32_32x32x16_bf16 v[96:111], v[156:159], v[120:123], v[96:111]
  buffer_load_dwordx4 v180, s[8:11], s52 offen lds
  ds_read_b64_tr_b16 v[138:139], v168 offset:16384
  ds_read_b64_tr_b16 v[140:141], v169 offset:14336
  v_add_u32 v183, s96, v182
  v_min_u32 v183, 0x3ff, v183
  s_waitcnt lgkmcnt(8)
  v_mfma_f32_32x32x16_bf16 v[16:31], v[144:147], v[124:127], v[16:31]
  buffer_load_dwordx4 v[190:193], v208, s[4:7], s90 offen
  ds_read_b64_tr_b16 v[142:143], v169 offset:16128
  ds_read_b128 v[116:119], v166
  v_add_u32 v183, s61, v183
  v_lshlrev_b32 v183, 4, v183
  v_mfma_f32_32x32x16_bf16 v[48:63], v[148:151], v[124:127], v[48:63]
  v_add_u32 v212, 65536, v183
  v_lshrrev_b32 v183, 5, v209
  v_mul_u32_u24 v183, 2944, v183
  v_add_u32 v183, v183, v182
  s_mul_i32 s61, s43, 192
  v_mfma_f32_32x32x16_bf16 v[80:95], v[152:155], v[124:127], v[80:95]
  buffer_load_dwordx4 v[194:197], v208, s[4:7], s90 offen offset:1024
  s_lshl_b32 s96, s46, 5
  s_add_u32 s61, s61, s96
  s_add_u32 s61, s61, 1536
  v_add_u32 v184, s61, v183
  s_waitcnt lgkmcnt(7)
  v_mfma_f32_32x32x16_bf16 v[0:15], v[128:131], v[112:115], v[0:15]
  ds_read_b128 v[120:123], v163
  ds_read_b64_tr_b16 v[144:145], v168 offset:21504
  v_add_u32 v162, 0xb000, v162
  v_add_u32 v166, 0xb000, v166
  v_lshlrev_b32 v184, 4, v184
  s_waitcnt lgkmcnt(7)
  v_mfma_f32_32x32x16_bf16 v[32:47], v[132:135], v[112:115], v[32:47]
  ds_read_b64_tr_b16 v[146:147], v168 offset:23296
  ds_read_b64_tr_b16 v[148:149], v168 offset:21632
  v_add_u32 v213, 131072, v184
  v_add_u32 v184, 2880, v183
  v_lshlrev_b32 v184, 4, v184
  s_waitcnt lgkmcnt(7)
  v_mfma_f32_32x32x16_bf16 v[64:79], v[136:139], v[112:115], v[64:79]
  ds_read_b64_tr_b16 v[150:151], v168 offset:23424
  ds_read_b64_tr_b16 v[152:153], v168 offset:21760
  v_add_u32 v214, 131072, v184
  s_lshl_b32 s61, s60, 1
  s_add_u32 s61, s61, s46
  s_waitcnt lgkmcnt(7)
  v_mfma_f32_32x32x16_bf16 v[96:111], v[140:143], v[112:115], v[96:111]
  ds_read_b64_tr_b16 v[154:155], v168 offset:23552
  ds_read_b64_tr_b16 v[156:157], v169 offset:21504
  s_mul_i32 s97, s61, 122880
  s_xor_b32 s61, s61, 1
  s_mul_i32 s98, s61, 122880
  s_waitcnt lgkmcnt(8)
  v_mfma_f32_32x32x16_bf16 v[16:31], v[128:131], v[116:119], v[16:31]
  ds_read_b64_tr_b16 v[158:159], v169 offset:23296
  ds_read_b128 v[124:127], v167
  s_mul_i32 s96, s3, 18432
  s_add_u32 s96, s96, 294912
  s_add_u32 s88, s97, s96
  v_mfma_f32_32x32x16_bf16 v[48:63], v[132:135], v[116:119], v[48:63]
  s_add_u32 s89, s98, s96
  s_mul_i32 s29, s3, -14336
  s_add_u32 s29, s29, 57344
  s_lshl_b32 s32, s3, 12
  s_sub_u32 s32, s32, 106496
  v_mfma_f32_32x32x16_bf16 v[80:95], v[136:139], v[116:119], v[80:95]
  v_add_u32 v163, 0xb000, v163
  v_add_u32 v167, 0xb000, v167
  v_add_u32 v168, 0xb000, v168
  v_add_u32 v169, 0xb000, v169
  s_waitcnt vmcnt(13)
  s_waitcnt lgkmcnt(0)
  s_barrier
  s_cmp_eq_u32 s3, 0
  s_cbranch_scc0 L_nob2pub_22
  s_lshl_b32 s36, s101, 3
  s_add_u32 s36, s36, 12288
  v_mov_b32 v253, s36
  v_mov_b32 v252, 2147483392
  v_cmp_gt_u32 s[30:31], 1, v209
  s_nop 1
  v_cndmask_b32 v253, v252, v253, s[30:31]
  v_mov_b32 v254, s56
  v_mov_b32 v255, s57
  buffer_store_dwordx2 v[254:255], v253, s[12:15], 0 offen sc1
L_nob2pub_22:
  s_mov_b32 s51, 384
  s_mov_b32 s52, 528384
  v_mfma_f32_32x32x16_bf16 v[0:15], v[144:147], v[120:123], v[0:15]
  ds_read_b128 v[112:115], v160
  ds_read_b64_tr_b16 v[128:129], v168 offset:0
  s_add_u32 m0, s54, 0
  v_mfma_f32_32x32x16_bf16 v[32:47], v[148:151], v[120:123], v[32:47]
  buffer_load_dwordx4 v170, s[4:7], s51 offen lds
  ds_read_b64_tr_b16 v[130:131], v168 offset:1792
  ds_read_b64_tr_b16 v[132:133], v168 offset:128
  v_mfma_f32_32x32x16_bf16 v[64:79], v[152:155], v[120:123], v[64:79]
  ds_read_b64_tr_b16 v[134:135], v168 offset:1920
  ds_read_b64_tr_b16 v[136:137], v168 offset:256
  s_add_u32 m0, s54, 1024
  v_mfma_f32_32x32x16_bf16 v[96:111], v[156:159], v[120:123], v[96:111]
  buffer_load_dwordx4 v171, s[4:7], s51 offen lds
  ds_read_b64_tr_b16 v[138:139], v168 offset:2048
  ds_read_b64_tr_b16 v[140:141], v169 offset:0
  v_mfma_f32_32x32x16_bf16 v[16:31], v[144:147], v[124:127], v[16:31]
  ds_read_b64_tr_b16 v[142:143], v169 offset:1792
  ds_read_b128 v[116:119], v164
  s_add_u32 m0, s54, 2048
  v_mfma_f32_32x32x16_bf16 v[48:63], v[148:151], v[124:127], v[48:63]
  buffer_load_dwordx4 v172, s[4:7], s51 offen lds
  v_mfma_f32_32x32x16_bf16 v[80:95], v[152:155], v[124:127], v[80:95]
  s_waitcnt lgkmcnt(7)
  v_mfma_f32_32x32x16_bf16 v[0:15], v[128:131], v[112:115], v[0:15]
  ds_read_b128 v[120:123], v161
  ds_read_b64_tr_b16 v[144:145], v168 offset:7168
  s_waitcnt lgkmcnt(7)
  v_mfma_f32_32x32x16_bf16 v[32:47], v[132:135], v[112:115], v[32:47]
  ds_read_b64_tr_b16 v[146:147], v168 offset:8960
  ds_read_b64_tr_b16 v[148:149], v168 offset:7296
  s_add_u32 m0, s54, 3072
  s_waitcnt lgkmcnt(7)
  v_mfma_f32_32x32x16_bf16 v[64:79], v[136:139], v[112:115], v[64:79]
  buffer_load_dwordx4 v173, s[4:7], s51 offen lds
  ds_read_b64_tr_b16 v[150:151], v168 offset:9088
  ds_read_b64_tr_b16 v[152:153], v168 offset:7424
  s_waitcnt lgkmcnt(7)
  v_mfma_f32_32x32x16_bf16 v[96:111], v[140:143], v[112:115], v[96:111]
  ds_read_b64_tr_b16 v[154:155], v168 offset:9216
  ds_read_b64_tr_b16 v[156:157], v169 offset:7168
  s_waitcnt lgkmcnt(8)
  v_mfma_f32_32x32x16_bf16 v[16:31], v[128:131], v[116:119], v[16:31]
  ds_read_b64_tr_b16 v[158:159], v169 offset:8960
  ds_read_b128 v[124:127], v165
  s_add_u32 m0, s55, 0
  v_mfma_f32_32x32x16_bf16 v[48:63], v[132:135], v[116:119], v[48:63]
  buffer_load_dwordx4 v174, s[8:11], s52 offen lds
  v_mfma_f32_32x32x16_bf16 v[80:95], v[136:139], v[116:119], v[80:95]
  s_waitcnt lgkmcnt(7)
  v_mfma_f32_32x32x16_bf16 v[0:15], v[144:147], v[120:123], v[0:15]
  ds_read_b128 v[112:115], v162
  ds_read_b64_tr_b16 v[128:129], v168 offset:14336
  v_add_u32 v160, 0xb000, v160
  v_add_u32 v164, 0xb000, v164
  v_add_u32 v161, 0xb000, v161
  s_waitcnt lgkmcnt(7)
  v_mfma_f32_32x32x16_bf16 v[32:47], v[148:151], v[120:123], v[32:47]
  ds_read_b64_tr_b16 v[130:131], v168 offset:16128
  ds_read_b64_tr_b16 v[132:133], v168 offset:14464
  v_add_u32 v165, 0xb000, v165
  s_add_u32 m0, s55, 1024
  s_waitcnt lgkmcnt(7)
  v_mfma_f32_32x32x16_bf16 v[64:79], v[152:155], v[120:123], v[64:79]
  buffer_load_dwordx4 v175, s[8:11], s52 offen lds
  ds_read_b64_tr_b16 v[134:135], v168 offset:16256
  ds_read_b64_tr_b16 v[136:137], v168 offset:14592
  s_waitcnt lgkmcnt(7)
  v_mfma_f32_32x32x16_bf16 v[96:111], v[156:159], v[120:123], v[96:111]
  ds_read_b64_tr_b16 v[138:139], v168 offset:16384
  ds_read_b64_tr_b16 v[140:141], v169 offset:14336
  s_waitcnt lgkmcnt(8)
  v_mfma_f32_32x32x16_bf16 v[16:31], v[144:147], v[124:127], v[16:31]
  ds_read_b64_tr_b16 v[142:143], v169 offset:16128
  ds_read_b128 v[116:119], v166
  s_add_u32 m0, s55, 2048
  v_mfma_f32_32x32x16_bf16 v[48:63], v[148:151], v[124:127], v[48:63]
  buffer_load_dwordx4 v176, s[8:11], s52 offen lds
  v_mfma_f32_32x32x16_bf16 v[80:95], v[152:155], v[124:127], v[80:95]
  s_waitcnt lgkmcnt(7)
  v_mfma_f32_32x32x16_bf16 v[0:15], v[128:131], v[112:115], v[0:15]
  ds_read_b128 v[120:123], v163
  ds_read_b64_tr_b16 v[144:145], v168 offset:21504
  v_add_u32 v162, 0xb000, v162
  v_add_u32 v166, 0xb000, v166
  s_add_u32 m0, s55, 3072
  s_waitcnt lgkmcnt(7)
  v_mfma_f32_32x32x16_bf16 v[32:47], v[132:135], v[112:115], v[32:47]
  buffer_load_dwordx4 v177, s[8:11], s52 offen lds
  ds_read_b64_tr_b16 v[146:147], v168 offset:23296
  ds_read_b64_tr_b16 v[148:149], v168 offset:21632
  s_waitcnt vmcnt(8)
  v_mov_b32 v182, 0x3f803f80
  s_waitcnt lgkmcnt(7)
  v_mfma_f32_32x32x16_bf16 v[64:79], v[136:139], v[112:115], v[64:79]
  ds_read_b64_tr_b16 v[150:151], v168 offset:23424
  ds_read_b64_tr_b16 v[152:153], v168 offset:21760
  v_mov_b32 v198, 0
  v_mov_b32 v199, 0
  s_add_u32 m0, s55, 4096
  s_waitcnt lgkmcnt(7)
  v_mfma_f32_32x32x16_bf16 v[96:111], v[140:143], v[112:115], v[96:111]
  buffer_load_dwordx4 v178, s[8:11], s52 offen lds
  ds_read_b64_tr_b16 v[154:155], v168 offset:23552
  ds_read_b64_tr_b16 v[156:157], v169 offset:21504
  v_mov_b32 v200, 0
  s_add_u32 m0, s55, 5120
  s_waitcnt lgkmcnt(8)
  v_mfma_f32_32x32x16_bf16 v[16:31], v[128:131], v[116:119], v[16:31]
  buffer_load_dwordx4 v179, s[8:11], s52 offen lds
  ds_read_b64_tr_b16 v[158:159], v169 offset:23296
  ds_read_b128 v[124:127], v167
  v_mov_b32 v201, 0
  v_dot2c_f32_bf16 v198, v190, v182
  v_mfma_f32_32x32x16_bf16 v[48:63], v[132:135], v[116:119], v[48:63]
  v_dot2c_f32_bf16 v199, v190, v190
  v_dot2c_f32_bf16 v200, v194, v182
  v_dot2c_f32_bf16 v201, v194, v194
  v_dot2c_f32_bf16 v198, v191, v182
  s_add_u32 m0, s55, 6144
  v_mfma_f32_32x32x16_bf16 v[80:95], v[136:139], v[116:119], v[80:95]
  buffer_load_dwordx4 v180, s[8:11], s52 offen lds
  v_dot2c_f32_bf16 v199, v191, v191
  v_dot2c_f32_bf16 v200, v195, v182
  v_dot2c_f32_bf16 v201, v195, v195
  v_dot2c_f32_bf16 v198, v192, v182
  v_add_u32 v163, 0xb000, v163
  v_add_u32 v167, 0xb000, v167
  v_add_u32 v168, 0xb000, v168
  v_add_u32 v169, 0xb000, v169
  s_waitcnt lgkmcnt(0)
  s_barrier
  s_mov_b32 s51, 512
  s_mov_b32 s52, 704512
  v_mfma_f32_32x32x16_bf16 v[0:15], v[144:147], v[120:123], v[0:15]
  ds_read_b128 v[112:115], v160
  ds_read_b64_tr_b16 v[128:129], v168 offset:0
  v_dot2c_f32_bf16 v199, v192, v192
  v_dot2c_f32_bf16 v200, v196, v182
  s_add_u32 m0, s54, 45056
  v_mfma_f32_32x32x16_bf16 v[32:47], v[148:151], v[120:123], v[32:47]
  buffer_load_dwordx4 v170, s[4:7], s51 offen lds
  ds_read_b64_tr_b16 v[130:131], v168 offset:1792
  ds_read_b64_tr_b16 v[132:133], v168 offset:128
  v_dot2c_f32_bf16 v201, v196, v196
  v_dot2c_f32_bf16 v198, v193, v182
  v_mfma_f32_32x32x16_bf16 v[64:79], v[152:155], v[120:123], v[64:79]
  ds_read_b64_tr_b16 v[134:135], v168 offset:1920
  ds_read_b64_tr_b16 v[136:137], v168 offset:256
  v_dot2c_f32_bf16 v199, v193, v193
  v_dot2c_f32_bf16 v200, v197, v182
  s_add_u32 m0, s54, 46080
  v_mfma_f32_32x32x16_bf16 v[96:111], v[156:159], v[120:123], v[96:111]
  buffer_load_dwordx4 v171, s[4:7], s51 offen lds
  ds_read_b64_tr_b16 v[138:139], v168 offset:2048
  ds_read_b64_tr_b16 v[140:141], v169 offset:0
  v_dot2c_f32_bf16 v201, v197, v197
  s_lshr_b32 s61, s90, 11
  v_mfma_f32_32x32x16_bf16 v[16:31], v[144:147], v[124:127], v[16:31]
  ds_read_b64_tr_b16 v[142:143], v169 offset:1792
  ds_read_b128 v[116:119], v164
  v_lshrrev_b32 v202, 5, v209
  v_lshl_add_u32 v202, v202, 10, s61
  s_add_u32 m0, s54, 47104
  v_mfma_f32_32x32x16_bf16 v[48:63], v[148:151], v[124:127], v[48:63]
  buffer_load_dwordx4 v172, s[4:7], s51 offen lds
  v_lshlrev_b32 v202, 4, v202
  v_permlane32_swap_b32 v198, v200
  v_permlane32_swap_b32 v199, v201
  v_add_u32 v202, 65536, v202
  v_mfma_f32_32x32x16_bf16 v[80:95], v[152:155], v[124:127], v[80:95]
  v_and_b32 v203, 31, v209
  v_add_f32 v198, v198, v200
  v_add_f32 v199, v199, v201
  v_mov_b32 v186, 2147483392
  v_cmp_eq_u32 vcc, 0, v203
  s_waitcnt lgkmcnt(7)
  v_mfma_f32_32x32x16_bf16 v[0:15], v[128:131], v[112:115], v[0:15]
  ds_read_b128 v[120:123], v161
  ds_read_b64_tr_b16 v[144:145], v168 offset:7168
  v_permlane16_swap_b32 v198, v199
  v_cndmask_b32 v202, v186, v202, vcc
  v_mov_b32 v185, s56
  s_waitcnt lgkmcnt(7)
  v_mfma_f32_32x32x16_bf16 v[32:47], v[132:135], v[112:115], v[32:47]
  ds_read_b64_tr_b16 v[146:147], v168 offset:8960
  ds_read_b64_tr_b16 v[148:149], v168 offset:7296
  v_add_f32 v198, v198, v199
  s_nop 1
  v_add_f32_dpp v198, v198, v198 row_ror:8 row_mask:0xf bank_mask:0xf
  s_add_u32 m0, s54, 48128
  s_waitcnt lgkmcnt(7)
  v_mfma_f32_32x32x16_bf16 v[64:79], v[136:139], v[112:115], v[64:79]
  buffer_load_dwordx4 v173, s[4:7], s51 offen lds
  ds_read_b64_tr_b16 v[150:151], v168 offset:9088
  ds_read_b64_tr_b16 v[152:153], v168 offset:7424
  v_add_f32_dpp v198, v198, v198 row_ror:4 row_mask:0xf bank_mask:0xf
  s_nop 1
  v_add_f32_dpp v198, v198, v198 row_ror:2 row_mask:0xf bank_mask:0xf
  s_waitcnt lgkmcnt(7)
  v_mfma_f32_32x32x16_bf16 v[96:111], v[140:143], v[112:115], v[96:111]
  ds_read_b64_tr_b16 v[154:155], v168 offset:9216
  ds_read_b64_tr_b16 v[156:157], v169 offset:7168
  v_add_f32_dpp v198, v198, v198 row_ror:1 row_mask:0xf bank_mask:0xf
  v_mov_b32 v199, v198
  s_nop 1
  v_permlane16_swap_b32 v198, v199
  s_waitcnt lgkmcnt(8)
  v_mfma_f32_32x32x16_bf16 v[16:31], v[128:131], v[116:119], v[16:31]
  ds_read_b64_tr_b16 v[158:159], v169 offset:8960
  ds_read_b128 v[124:127], v165
  v_mul_f32 v198, 0xbb000000, v198
  v_mul_f32 v199, 0x3b000000, v199
  s_add_u32 m0, s55, 45056
  v_mfma_f32_32x32x16_bf16 v[48:63], v[132:135], v[116:119], v[48:63]
  buffer_load_dwordx4 v174, s[8:11], s52 offen lds
  v_fma_f32 v199, -v198, v198, v199
  v_cvt_pk_bf16_f32 v182, v198, v198
  v_max_f32 v199, 0, v199
L_stub_wide_0:
  s_cmp_eq_u32 s86, 1
  s_cbranch_scc1 L_tret_wide_0
  v_and_b32 v203, 0xffff0000, v182
  v_mfma_f32_32x32x16_bf16 v[80:95], v[136:139], v[116:119], v[80:95]
  v_add_f32 v199, 0x3727c5ac, v199
  v_sub_f32 v203, v198, v203
  v_rsq_f32 v184, v199
  v_cvt_pk_bf16_f32 v183, v203, 0
  buffer_store_dwordx4 v[182:185], v202, s[12:15], 0 offen sc1
  s_waitcnt lgkmcnt(7)
  v_mfma_f32_32x32x16_bf16 v[0:15], v[144:147], v[120:123], v[0:15]
  ds_read_b128 v[112:115], v162
  ds_read_b64_tr_b16 v[128:129], v168 offset:14336
  v_add_u32 v160, 0xfffea000, v160
  v_add_u32 v164, 0xfffea000, v164
  v_add_u32 v161, 0xfffea000, v161
  s_waitcnt lgkmcnt(7)
  v_mfma_f32_32x32x16_bf16 v[32:47], v[148:151], v[120:123], v[32:47]
  ds_read_b64_tr_b16 v[130:131], v168 offset:16128
  ds_read_b64_tr_b16 v[132:133], v168 offset:14464
  v_add_u32 v165, 0xfffea000, v165
  s_and_b32 s61, s56, 63
  s_add_u32 m0, s55, 46080
  s_waitcnt lgkmcnt(7)
  v_mfma_f32_32x32x16_bf16 v[64:79], v[152:155], v[120:123], v[64:79]
  buffer_load_dwordx4 v175, s[8:11], s52 offen lds
  ds_read_b64_tr_b16 v[134:135], v168 offset:16256
  ds_read_b64_tr_b16 v[136:137], v168 offset:14592
  s_lshr_b32 s96, s56, 6
  s_and_b32 s96, s96, 62
  s_waitcnt lgkmcnt(7)
  v_mfma_f32_32x32x16_bf16 v[96:111], v[156:159], v[120:123], v[96:111]
  ds_read_b64_tr_b16 v[138:139], v168 offset:16384
  ds_read_b64_tr_b16 v[140:141], v169 offset:14336
  s_and_b32 s97, s56, 1
  s_or_b32 s96, s96, s97
  s_lshl_b32 s96, s96, 8
  s_waitcnt lgkmcnt(8)
  v_mfma_f32_32x32x16_bf16 v[16:31], v[144:147], v[124:127], v[16:31]
  ds_read_b64_tr_b16 v[142:143], v169 offset:16128
  ds_read_b128 v[116:119], v166
  s_or_b32 s61, s61, s96
  v_lshrrev_b32 v182, 5, v209
  s_add_u32 m0, s55, 47104
  v_mfma_f32_32x32x16_bf16 v[48:63], v[148:151], v[124:127], v[48:63]
  buffer_load_dwordx4 v176, s[8:11], s52 offen lds
  v_lshlrev_b32 v182, 3, v182
  v_lshrrev_b32 v182, v182, s61
  v_lshlrev_b32 v183, 15, v182
  v_lshl_or_b32 v183, v182, 30, v183
  v_mfma_f32_32x32x16_bf16 v[80:95], v[152:155], v[124:127], v[80:95]
  v_and_b32 v216, 0x80008000, v183
  v_lshrrev_b32 v182, 2, v182
  v_lshlrev_b32 v183, 15, v182
  v_lshl_or_b32 v183, v182, 30, v183
  v_and_b32 v218, 0x80008000, v183
  s_waitcnt lgkmcnt(7)
  v_mfma_f32_32x32x16_bf16 v[0:15], v[128:131], v[112:115], v[0:15]
  ds_read_b128 v[120:123], v163
  ds_read_b64_tr_b16 v[144:145], v168 offset:21504
  v_add_u32 v162, 0xfffea000, v162
  v_add_u32 v166, 0xfffea000, v166
  s_add_u32 m0, s55, 48128
  s_waitcnt lgkmcnt(7)
  v_mfma_f32_32x32x16_bf16 v[32:47], v[132:135], v[112:115], v[32:47]
  buffer_load_dwordx4 v177, s[8:11], s52 offen lds
  ds_read_b64_tr_b16 v[146:147], v168 offset:23296
  ds_read_b64_tr_b16 v[148:149], v168 offset:21632
  v_lshrrev_b32 v182, 2, v182
  v_lshlrev_b32 v183, 15, v182
  s_waitcnt lgkmcnt(7)
  v_mfma_f32_32x32x16_bf16 v[64:79], v[136:139], v[112:115], v[64:79]
  ds_read_b64_tr_b16 v[150:151], v168 offset:23424
  ds_read_b64_tr_b16 v[152:153], v168 offset:21760
  v_lshl_or_b32 v183, v182, 30, v183
  v_and_b32 v219, 0x80008000, v183
  s_add_u32 m0, s55, 49152
  s_waitcnt lgkmcnt(7)
  v_mfma_f32_32x32x16_bf16 v[96:111], v[140:143], v[112:115], v[96:111]
  buffer_load_dwordx4 v178, s[8:11], s52 offen lds
  ds_read_b64_tr_b16 v[154:155], v168 offset:23552
  ds_read_b64_tr_b16 v[156:157], v169 offset:21504
  v_xor_b32 v217, 0x80008000, v216
  s_add_u32 m0, s55, 50176
  s_waitcnt lgkmcnt(8)
  v_mfma_f32_32x32x16_bf16 v[16:31], v[128:131], v[116:119], v[16:31]
  buffer_load_dwordx4 v179, s[8:11], s52 offen lds
  ds_read_b64_tr_b16 v[158:159], v169 offset:23296
  ds_read_b128 v[124:127], v167
  v_mov_b32 v238, 2147483392
  s_lshl_b32 s61, s59, 5
  v_mfma_f32_32x32x16_bf16 v[48:63], v[132:135], v[116:119], v[48:63]
  s_add_u32 s96, s61, 24
  s_mul_i32 s96, s96, 575
  s_lshr_b32 s96, s96, 15
  s_max_u32 s61, s61, 7
  s_add_u32 m0, s55, 51200
  v_mfma_f32_32x32x16_bf16 v[80:95], v[136:139], v[116:119], v[80:95]
  buffer_load_dwordx4 v180, s[8:11], s52 offen lds
  s_sub_u32 s61, s61, 7
  s_mul_i32 s61, s61, 575
  s_lshr_b32 s61, s61, 15
  s_sub_u32 s96, s96, s61
  v_add_u32 v163, 0xfffea000, v163
  v_add_u32 v167, 0xfffea000, v167
  v_add_u32 v168, 0xfffea000, v168
  v_add_u32 v169, 0xfffea000, v169
  s_waitcnt vmcnt(12)
  s_waitcnt lgkmcnt(0)
  s_barrier
  s_mov_b32 s51, 640
  s_mov_b32 s52, 880640
  v_mfma_f32_32x32x16_bf16 v[0:15], v[144:147], v[120:123], v[0:15]
  ds_read_b128 v[112:115], v160
  ds_read_b64_tr_b16 v[128:129], v168 offset:0
  v_bfe_u32 v182, v209, 3, 1
  v_mul_u32_u24 v182, s96, v182
  s_add_u32 m0, s54, 90112
  v_mfma_f32_32x32x16_bf16 v[32:47], v[148:151], v[120:123], v[32:47]
  buffer_load_dwordx4 v170, s[4:7], s51 offen lds
  ds_read_b64_tr_b16 v[130:131], v168 offset:1792
  ds_read_b64_tr_b16 v[132:133], v168 offset:128
  v_add_u32 v182, s61, v182
  v_bfe_u32 v183, v209, 2, 1
  v_mfma_f32_32x32x16_bf16 v[64:79], v[152:155], v[120:123], v[64:79]
  ds_read_b64_tr_b16 v[134:135], v168 offset:1920
  ds_read_b64_tr_b16 v[136:137], v168 offset:256
  v_lshl_add_u32 v182, v182, 3, v183
  s_lshl_b32 s61, s3, 1
  s_add_u32 m0, s54, 91136
  v_mfma_f32_32x32x16_bf16 v[96:111], v[156:159], v[120:123], v[96:111]
  buffer_load_dwordx4 v171, s[4:7], s51 offen lds
  ds_read_b64_tr_b16 v[138:139], v168 offset:2048
  ds_read_b64_tr_b16 v[140:141], v169 offset:0
  v_add_u32 v182, s61, v182
  s_add_u32 m0, s54, 92160
  v_mfma_f32_32x32x16_bf16 v[16:31], v[144:147], v[124:127], v[16:31]
  buffer_load_dwordx4 v172, s[4:7], s51 offen lds
  ds_read_b64_tr_b16 v[142:143], v169 offset:1792
  ds_read_b128 v[116:119], v164
  v_and_b32 v183, 3, v209
  v_lshl_add_u32 v182, v182, 2, v183
  v_mfma_f32_32x32x16_bf16 v[48:63], v[148:151], v[124:127], v[48:63]
  v_lshlrev_b32 v182, 3, v182
  v_add_u32 v235, 4096, v182
  v_and_b32 v182, 31, v209
  v_lshrrev_b32 v183, 5, v209
  s_lshl_b32 s61, s59, 6
  v_mfma_f32_32x32x16_bf16 v[80:95], v[152:155], v[124:127], v[80:95]
  buffer_load_dwordx2 v[254:255], v215, s[12:15], 0 offen sc1
  s_add_u32 s61, s61, s45
  s_lshl_b32 s61, s61, 10
  s_lshl_b32 s96, s60, 7
  s_add_u32 s61, s61, s96
  s_waitcnt lgkmcnt(7)
  v_mfma_f32_32x32x16_bf16 v[0:15], v[128:131], v[112:115], v[0:15]
  ds_read_b128 v[120:123], v161
  ds_read_b64_tr_b16 v[144:145], v168 offset:7168
  s_lshl_b32 s96, s46, 6
  s_add_u32 s61, s61, s96
  v_lshlrev_b32 v184, 11, v182
  s_waitcnt lgkmcnt(7)
  v_mfma_f32_32x32x16_bf16 v[32:47], v[132:135], v[112:115], v[32:47]
  ds_read_b64_tr_b16 v[146:147], v168 offset:8960
  ds_read_b64_tr_b16 v[148:149], v168 offset:7296
  v_lshl_add_u32 v184, v183, 5, v184
  v_add_u32 v236, s61, v184
  s_add_u32 m0, s54, 93184
  s_waitcnt lgkmcnt(7)
  v_mfma_f32_32x32x16_bf16 v[64:79], v[136:139], v[112:115], v[64:79]
  buffer_load_dwordx4 v173, s[4:7], s51 offen lds
  ds_read_b64_tr_b16 v[150:151], v168 offset:9088
  ds_read_b64_tr_b16 v[152:153], v168 offset:7424
  s_lshl_b32 s61, s45, 10
  s_lshl_b32 s96, s59, 5
  s_waitcnt lgkmcnt(7)
  v_mfma_f32_32x32x16_bf16 v[96:111], v[140:143], v[112:115], v[96:111]
  ds_read_b64_tr_b16 v[154:155], v168 offset:9216
  ds_read_b64_tr_b16 v[156:157], v169 offset:7168
  s_add_u32 s61, s61, s96
  v_add_u32 v182, s61, v182
  v_lshlrev_b32 v182, 4, v182
  s_waitcnt lgkmcnt(8)
  v_mfma_f32_32x32x16_bf16 v[16:31], v[128:131], v[116:119], v[16:31]
  ds_read_b64_tr_b16 v[158:159], v169 offset:8960
  ds_read_b128 v[124:127], v165
  v_add_u32 v237, 65536, v182
  s_mul_i32 s61, s45, 120832
  s_add_u32 m0, s55, 90112
  v_mfma_f32_32x32x16_bf16 v[48:63], v[132:135], v[116:119], v[48:63]
  buffer_load_dwordx4 v174, s[8:11], s52 offen lds
  v_add_u32 v181, s61, v208
  s_xor_b32 s61, s45, 1
  s_mul_i32 s61, s61, 120832
  v_add_u32 v239, s61, v208
  v_mfma_f32_32x32x16_bf16 v[80:95], v[136:139], v[116:119], v[80:95]
  s_lshl_b32 s61, s59, 1
  s_mul_i32 s61, s61, 120832
  s_add_u32 s61, s61, 3145728
  s_mul_i32 s96, s3, 18
  s_add_u32 s96, s96, 32
  s_waitcnt lgkmcnt(7)
  v_mfma_f32_32x32x16_bf16 v[0:15], v[144:147], v[120:123], v[0:15]
  ds_read_b128 v[112:115], v162
  ds_read_b64_tr_b16 v[128:129], v168 offset:14336
  v_add_u32 v160, 0xb000, v160
  v_add_u32 v164, 0xb000, v164
  v_add_u32 v161, 0xb000, v161
  s_waitcnt lgkmcnt(7)
  v_mfma_f32_32x32x16_bf16 v[32:47], v[148:151], v[120:123], v[32:47]
  ds_read_b64_tr_b16 v[130:131], v168 offset:16128
  ds_read_b64_tr_b16 v[132:133], v168 offset:14464
  v_add_u32 v165, 0xb000, v165
  s_lshl_b32 s97, s96, 10
  s_add_u32 m0, s55, 91136
  s_waitcnt lgkmcnt(7)
  v_mfma_f32_32x32x16_bf16 v[64:79], v[152:155], v[120:123], v[64:79]
  buffer_load_dwordx4 v175, s[8:11], s52 offen lds
  ds_read_b64_tr_b16 v[134:135], v168 offset:16256
  ds_read_b64_tr_b16 v[136:137], v168 offset:14592
  s_add_u32 s24, s61, s97
  s_add_u32 s38, s24, 4096
  s_waitcnt lgkmcnt(7)
  v_mfma_f32_32x32x16_bf16 v[96:111], v[156:159], v[120:123], v[96:111]
  ds_read_b64_tr_b16 v[138:139], v168 offset:16384
  ds_read_b64_tr_b16 v[140:141], v169 offset:14336
  s_add_u32 s39, s24, 8192
  s_add_u32 s1, s24, 12288
  s_add_u32 s0, s24, 16384
  s_waitcnt lgkmcnt(8)
  v_mfma_f32_32x32x16_bf16 v[16:31], v[144:147], v[124:127], v[16:31]
  ds_read_b64_tr_b16 v[142:143], v169 offset:16128
  ds_read_b128 v[116:119], v166
  s_lshl_b32 s96, s3, 2
  s_add_u32 s96, s96, 104
  s_add_u32 m0, s55, 92160
  v_mfma_f32_32x32x16_bf16 v[48:63], v[148:151], v[124:127], v[48:63]
  buffer_load_dwordx4 v176, s[8:11], s52 offen lds
  s_lshl_b32 s97, s96, 10
  s_add_u32 s28, s61, s97
  s_add_u32 s97, s96, 2
  s_min_u32 s97, s97, 117
  v_mfma_f32_32x32x16_bf16 v[80:95], v[152:155], v[124:127], v[80:95]
  s_lshl_b32 s97, s97, 10
  s_add_u32 s26, s61, s97
  s_add_u32 s97, s96, 3
  s_min_u32 s97, s97, 117
  s_lshl_b32 s97, s97, 10
  s_waitcnt lgkmcnt(7)
  v_mfma_f32_32x32x16_bf16 v[0:15], v[128:131], v[112:115], v[0:15]
  ds_read_b128 v[120:123], v163
  ds_read_b64_tr_b16 v[144:145], v168 offset:21504
  v_add_u32 v162, 0xb000, v162
  v_add_u32 v166, 0xb000, v166
  s_add_u32 m0, s55, 93184
  s_waitcnt lgkmcnt(7)
  v_mfma_f32_32x32x16_bf16 v[32:47], v[132:135], v[112:115], v[32:47]
  buffer_load_dwordx4 v177, s[8:11], s52 offen lds
  ds_read_b64_tr_b16 v[146:147], v168 offset:23296
  ds_read_b64_tr_b16 v[148:149], v168 offset:21632
  s_add_u32 s27, s61, s97
  s_lshl_b32 s97, s3, 13
  s_waitcnt lgkmcnt(7)
  v_mfma_f32_32x32x16_bf16 v[64:79], v[136:139], v[112:115], v[64:79]
  ds_read_b64_tr_b16 v[150:151], v168 offset:23424
  ds_read_b64_tr_b16 v[152:153], v168 offset:21760
  s_add_u32 s25, s61, s97
  s_add_u32 s33, s25, 4096
  s_add_u32 m0, s55, 94208
  s_waitcnt lgkmcnt(7)
  v_mfma_f32_32x32x16_bf16 v[96:111], v[140:143], v[112:115], v[96:111]
  buffer_load_dwordx4 v178, s[8:11], s52 offen lds
  ds_read_b64_tr_b16 v[154:155], v168 offset:23552
  ds_read_b64_tr_b16 v[156:157], v169 offset:21504
  s_add_u32 m0, s55, 95232
  s_waitcnt lgkmcnt(8)
  v_mfma_f32_32x32x16_bf16 v[16:31], v[128:131], v[116:119], v[16:31]
  buffer_load_dwordx4 v179, s[8:11], s52 offen lds
  ds_read_b64_tr_b16 v[158:159], v169 offset:23296
  ds_read_b128 v[124:127], v167
  v_mfma_f32_32x32x16_bf16 v[48:63], v[132:135], v[116:119], v[48:63]
  s_add_u32 m0, s55, 96256
  v_mfma_f32_32x32x16_bf16 v[80:95], v[136:139], v[116:119], v[80:95]
  buffer_load_dwordx4 v180, s[8:11], s52 offen lds
  v_add_u32 v163, 0xb000, v163
  v_add_u32 v167, 0xb000, v167
  v_add_u32 v168, 0xb000, v168
  v_add_u32 v169, 0xb000, v169
  s_waitcnt vmcnt(8)
  s_waitcnt lgkmcnt(0)
  s_barrier
  s_mov_b32 s58, 0
L_fchk_23:
  v_cmp_eq_u32 s[30:31], s56, v254
  v_cmp_eq_u32 s[34:35], s57, v255
  s_nop 0
  s_and_b64 s[30:31], s[30:31], s[34:35]
  s_cmp_eq_u64 s[30:31], exec
  s_cbranch_scc1 L_fok_24
  s_add_u32 s58, s58, 1
  s_cmp_ge_u32 s58, 262144
  s_cbranch_scc1 L_fok_24
  buffer_load_dwordx2 v[254:255], v215, s[12:15], 0 offen sc1
  s_waitcnt vmcnt(0)
  s_branch L_fchk_23
L_fok_24:
  s_mov_b32 s51, 768
  s_mov_b32 s52, 1056768
  v_mfma_f32_32x32x16_bf16 v[0:15], v[144:147], v[120:123], v[0:15]
  ds_read_b128 v[112:115], v160
  ds_read_b64_tr_b16 v[128:129], v168 offset:0
  s_add_u32 m0, s54, 0
  v_mfma_f32_32x32x16_bf16 v[32:47], v[148:151], v[120:123], v[32:47]
  buffer_load_dwordx4 v170, s[4:7], s51 offen lds
  ds_read_b64_tr_b16 v[130:131], v168 offset:1792
  ds_read_b64_tr_b16 v[132:133], v168 offset:128
  v_mfma_f32_32x32x16_bf16 v[64:79], v[152:155], v[120:123], v[64:79]
  ds_read_b64_tr_b16 v[134:135], v168 offset:1920
  ds_read_b64_tr_b16 v[136:137], v168 offset:256
  s_add_u32 m0, s54, 1024
  v_mfma_f32_32x32x16_bf16 v[96:111], v[156:159], v[120:123], v[96:111]
  buffer_load_dwordx4 v171, s[4:7], s51 offen lds
  ds_read_b64_tr_b16 v[138:139], v168 offset:2048
  ds_read_b64_tr_b16 v[140:141], v169 offset:0
  s_add_u32 m0, s54, 2048
  v_mfma_f32_32x32x16_bf16 v[16:31], v[144:147], v[124:127], v[16:31]
  buffer_load_dwordx4 v172, s[4:7], s51 offen lds
  ds_read_b64_tr_b16 v[142:143], v169 offset:1792
  ds_read_b128 v[116:119], v164
  v_mfma_f32_32x32x16_bf16 v[48:63], v[148:151], v[124:127], v[48:63]
  v_mfma_f32_32x32x16_bf16 v[80:95], v[152:155], v[124:127], v[80:95]
  buffer_load_dwordx4 a[0:3], v208, s[12:15], s88 offen offset:0 sc1
  s_waitcnt lgkmcnt(7)
  v_mfma_f32_32x32x16_bf16 v[0:15], v[128:131], v[112:115], v[0:15]
  ds_read_b128 v[120:123], v161
  ds_read_b64_tr_b16 v[144:145], v168 offset:7168
  s_add_u32 m0, s54, 3072
  s_waitcnt lgkmcnt(7)
  v_mfma_f32_32x32x16_bf16 v[32:47], v[132:135], v[112:115], v[32:47]
  buffer_load_dwordx4 v173, s[4:7], s51 offen lds
  ds_read_b64_tr_b16 v[146:147], v168 offset:8960
  ds_read_b64_tr_b16 v[148:149], v168 offset:7296
  s_waitcnt lgkmcnt(7)
  v_mfma_f32_32x32x16_bf16 v[64:79], v[136:139], v[112:115], v[64:79]
  ds_read_b64_tr_b16 v[150:151], v168 offset:9088
  ds_read_b64_tr_b16 v[152:153], v168 offset:7424
  s_add_u32 m0, s55, 0
  s_waitcnt lgkmcnt(7)
  v_mfma_f32_32x32x16_bf16 v[96:111], v[140:143], v[112:115], v[96:111]
  buffer_load_dwordx4 v174, s[8:11], s52 offen lds
  ds_read_b64_tr_b16 v[154:155], v168 offset:9216
  ds_read_b64_tr_b16 v[156:157], v169 offset:7168
  s_waitcnt lgkmcnt(8)
  v_mfma_f32_32x32x16_bf16 v[16:31], v[128:131], v[116:119], v[16:31]
  buffer_load_dwordx4 a[4:7], v208, s[12:15], s89 offen offset:0 sc1
  ds_read_b64_tr_b16 v[158:159], v169 offset:8960
  ds_read_b128 v[124:127], v165
  v_mfma_f32_32x32x16_bf16 v[48:63], v[132:135], v[116:119], v[48:63]
  v_mfma_f32_32x32x16_bf16 v[80:95], v[136:139], v[116:119], v[80:95]
  buffer_load_dwordx4 a[8:11], v208, s[12:15], s88 offen offset:1024 sc1
  s_waitcnt lgkmcnt(7)
  v_mfma_f32_32x32x16_bf16 v[0:15], v[144:147], v[120:123], v[0:15]
  ds_read_b128 v[112:115], v162
  ds_read_b64_tr_b16 v[128:129], v168 offset:14336
  v_add_u32 v160, 0xb000, v160
  v_add_u32 v164, 0xb000, v164
  s_add_u32 m0, s55, 1024
  s_waitcnt lgkmcnt(7)
  v_mfma_f32_32x32x16_bf16 v[32:47], v[148:151], v[120:123], v[32:47]
  buffer_load_dwordx4 v175, s[8:11], s52 offen lds
  ds_read_b64_tr_b16 v[130:131], v168 offset:16128
  ds_read_b64_tr_b16 v[132:133], v168 offset:14464
  v_add_u32 v161, 0xb000, v161
  v_add_u32 v165, 0xb000, v165
  s_waitcnt lgkmcnt(7)
  v_mfma_f32_32x32x16_bf16 v[64:79], v[152:155], v[120:123], v[64:79]
  ds_read_b64_tr_b16 v[134:135], v168 offset:16256
  ds_read_b64_tr_b16 v[136:137], v168 offset:14592
  s_add_u32 m0, s55, 2048
  s_waitcnt lgkmcnt(7)
  v_mfma_f32_32x32x16_bf16 v[96:111], v[156:159], v[120:123], v[96:111]
  buffer_load_dwordx4 v176, s[8:11], s52 offen lds
  ds_read_b64_tr_b16 v[138:139], v168 offset:16384
  ds_read_b64_tr_b16 v[140:141], v169 offset:14336
  s_waitcnt lgkmcnt(8)
  v_mfma_f32_32x32x16_bf16 v[16:31], v[144:147], v[124:127], v[16:31]
  buffer_load_dwordx4 a[12:15], v208, s[12:15], s89 offen offset:1024 sc1
  ds_read_b64_tr_b16 v[142:143], v169 offset:16128
  ds_read_b128 v[116:119], v166
  v_mfma_f32_32x32x16_bf16 v[48:63], v[148:151], v[124:127], v[48:63]
  v_mfma_f32_32x32x16_bf16 v[80:95], v[152:155], v[124:127], v[80:95]
  buffer_load_dwordx4 a[16:19], v208, s[12:15], s88 offen offset:2048 sc1
  s_waitcnt lgkmcnt(7)
  v_mfma_f32_32x32x16_bf16 v[0:15], v[128:131], v[112:115], v[0:15]
  ds_read_b128 v[120:123], v163
  ds_read_b64_tr_b16 v[144:145], v168 offset:21504
  v_add_u32 v162, 0xb000, v162
  v_add_u32 v166, 0xb000, v166
  s_add_u32 m0, s55, 3072
  s_waitcnt lgkmcnt(7)
  v_mfma_f32_32x32x16_bf16 v[32:47], v[132:135], v[112:115], v[32:47]
  buffer_load_dwordx4 v177, s[8:11], s52 offen lds
  ds_read_b64_tr_b16 v[146:147], v168 offset:23296
  ds_read_b64_tr_b16 v[148:149], v168 offset:21632
  s_add_u32 m0, s55, 4096
  s_waitcnt lgkmcnt(7)
  v_mfma_f32_32x32x16_bf16 v[64:79], v[136:139], v[112:115], v[64:79]
  buffer_load_dwordx4 v178, s[8:11], s52 offen lds
  ds_read_b64_tr_b16 v[150:151], v168 offset:23424
  ds_read_b64_tr_b16 v[152:153], v168 offset:21760
  s_waitcnt lgkmcnt(7)
  v_mfma_f32_32x32x16_bf16 v[96:111], v[140:143], v[112:115], v[96:111]
  ds_read_b64_tr_b16 v[154:155], v168 offset:23552
  ds_read_b64_tr_b16 v[156:157], v169 offset:21504
  s_add_u32 m0, s55, 5120
  s_waitcnt lgkmcnt(8)
  v_mfma_f32_32x32x16_bf16 v[16:31], v[128:131], v[116:119], v[16:31]
  buffer_load_dwordx4 v179, s[8:11], s52 offen lds
  ds_read_b64_tr_b16 v[158:159], v169 offset:23296
  ds_read_b128 v[124:127], v167
  s_add_u32 m0, s55, 6144
  v_mfma_f32_32x32x16_bf16 v[48:63], v[132:135], v[116:119], v[48:63]
  buffer_load_dwordx4 v180, s[8:11], s52 offen lds
  v_mfma_f32_32x32x16_bf16 v[80:95], v[136:139], v[116:119], v[80:95]
  buffer_load_dwordx4 a[20:23], v208, s[12:15], s89 offen offset:2048 sc1
  v_add_u32 v163, 0xb000, v163
  v_add_u32 v167, 0xb000, v167
  v_add_u32 v168, 0xb000, v168
  v_add_u32 v169, 0xb000, v169
  s_waitcnt vmcnt(17)
  s_waitcnt lgkmcnt(0)
  s_barrier
  s_mov_b32 s51, 896
  s_mov_b32 s52, 1232896
  v_mfma_f32_32x32x16_bf16 v[0:15], v[144:147], v[120:123], v[0:15]
  ds_read_b128 v[112:115], v160
  ds_read_b64_tr_b16 v[128:129], v168 offset:0
  s_add_u32 m0, s54, 45056
  v_mfma_f32_32x32x16_bf16 v[32:47], v[148:151], v[120:123], v[32:47]
  buffer_load_dwordx4 v170, s[4:7], s51 offen lds
  ds_read_b64_tr_b16 v[130:131], v168 offset:1792
  ds_read_b64_tr_b16 v[132:133], v168 offset:128
  v_mfma_f32_32x32x16_bf16 v[64:79], v[152:155], v[120:123], v[64:79]
  ds_read_b64_tr_b16 v[134:135], v168 offset:1920
  ds_read_b64_tr_b16 v[136:137], v168 offset:256
  s_add_u32 m0, s54, 46080
  v_mfma_f32_32x32x16_bf16 v[96:111], v[156:159], v[120:123], v[96:111]
  buffer_load_dwordx4 v171, s[4:7], s51 offen lds
  ds_read_b64_tr_b16 v[138:139], v168 offset:2048
  ds_read_b64_tr_b16 v[140:141], v169 offset:0
  s_add_u32 m0, s54, 47104
  v_mfma_f32_32x32x16_bf16 v[16:31], v[144:147], v[124:127], v[16:31]
  buffer_load_dwordx4 v172, s[4:7], s51 offen lds
  ds_read_b64_tr_b16 v[142:143], v169 offset:1792
  ds_read_b128 v[116:119], v164
  v_mfma_f32_32x32x16_bf16 v[48:63], v[148:151], v[124:127], v[48:63]
  v_mfma_f32_32x32x16_bf16 v[80:95], v[152:155], v[124:127], v[80:95]
  buffer_load_dwordx4 a[24:27], v208, s[12:15], s88 offen offset:3072 sc1
  s_waitcnt lgkmcnt(7)
  v_mfma_f32_32x32x16_bf16 v[0:15], v[128:131], v[112:115], v[0:15]
  ds_read_b128 v[120:123], v161
  ds_read_b64_tr_b16 v[144:145], v168 offset:7168
  s_add_u32 m0, s54, 48128
  s_waitcnt lgkmcnt(7)
  v_mfma_f32_32x32x16_bf16 v[32:47], v[132:135], v[112:115], v[32:47]
  buffer_load_dwordx4 v173, s[4:7], s51 offen lds
  ds_read_b64_tr_b16 v[146:147], v168 offset:8960
  ds_read_b64_tr_b16 v[148:149], v168 offset:7296
  s_waitcnt lgkmcnt(7)
  v_mfma_f32_32x32x16_bf16 v[64:79], v[136:139], v[112:115], v[64:79]
  ds_read_b64_tr_b16 v[150:151], v168 offset:9088
  ds_read_b64_tr_b16 v[152:153], v168 offset:7424
  s_add_u32 m0, s55, 45056
  s_waitcnt lgkmcnt(7)
  v_mfma_f32_32x32x16_bf16 v[96:111], v[140:143], v[112:115], v[96:111]
  buffer_load_dwordx4 v174, s[8:11], s52 offen lds
  ds_read_b64_tr_b16 v[154:155], v168 offset:9216
  ds_read_b64_tr_b16 v[156:157], v169 offset:7168
  s_waitcnt lgkmcnt(8)
  v_mfma_f32_32x32x16_bf16 v[16:31], v[128:131], v[116:119], v[16:31]
  buffer_load_dwordx4 a[28:31], v208, s[12:15], s89 offen offset:3072 sc1
  ds_read_b64_tr_b16 v[158:159], v169 offset:8960
  ds_read_b128 v[124:127], v165
  v_mfma_f32_32x32x16_bf16 v[48:63], v[132:135], v[116:119], v[48:63]
  s_add_u32 s88, s88, 4096
  v_mfma_f32_32x32x16_bf16 v[80:95], v[136:139], v[116:119], v[80:95]
  buffer_load_dwordx4 a[32:35], v208, s[12:15], s88 offen offset:0 sc1
  s_waitcnt lgkmcnt(7)
  v_mfma_f32_32x32x16_bf16 v[0:15], v[144:147], v[120:123], v[0:15]
  ds_read_b128 v[112:115], v162
  ds_read_b64_tr_b16 v[128:129], v168 offset:14336
  v_add_u32 v160, 0xfffea000, v160
  v_add_u32 v164, 0xfffea000, v164
  s_add_u32 m0, s55, 46080
  s_waitcnt lgkmcnt(7)
  v_mfma_f32_32x32x16_bf16 v[32:47], v[148:151], v[120:123], v[32:47]
  buffer_load_dwordx4 v175, s[8:11], s52 offen lds
  ds_read_b64_tr_b16 v[130:131], v168 offset:16128
  ds_read_b64_tr_b16 v[132:133], v168 offset:14464
  v_add_u32 v161, 0xfffea000, v161
  v_add_u32 v165, 0xfffea000, v165
  s_waitcnt lgkmcnt(7)
  v_mfma_f32_32x32x16_bf16 v[64:79], v[152:155], v[120:123], v[64:79]
  ds_read_b64_tr_b16 v[134:135], v168 offset:16256
  ds_read_b64_tr_b16 v[136:137], v168 offset:14592
  s_add_u32 m0, s55, 47104
  s_waitcnt lgkmcnt(7)
  v_mfma_f32_32x32x16_bf16 v[96:111], v[156:159], v[120:123], v[96:111]
  buffer_load_dwordx4 v176, s[8:11], s52 offen lds
  ds_read_b64_tr_b16 v[138:139], v168 offset:16384
  ds_read_b64_tr_b16 v[140:141], v169 offset:14336
  s_add_u32 s89, s89, 4096
  s_waitcnt lgkmcnt(8)
  v_mfma_f32_32x32x16_bf16 v[16:31], v[144:147], v[124:127], v[16:31]
  buffer_load_dwordx4 a[36:39], v208, s[12:15], s89 offen offset:0 sc1
  ds_read_b64_tr_b16 v[142:143], v169 offset:16128
  ds_read_b128 v[116:119], v166
  v_mfma_f32_32x32x16_bf16 v[48:63], v[148:151], v[124:127], v[48:63]
  v_mfma_f32_32x32x16_bf16 v[80:95], v[152:155], v[124:127], v[80:95]
  buffer_load_dwordx4 a[40:43], v208, s[12:15], s88 offen offset:1024 sc1
  s_waitcnt lgkmcnt(7)
  v_mfma_f32_32x32x16_bf16 v[0:15], v[128:131], v[112:115], v[0:15]
  ds_read_b128 v[120:123], v163
  ds_read_b64_tr_b16 v[144:145], v168 offset:21504
  v_add_u32 v162, 0xfffea000, v162
  v_add_u32 v166, 0xfffea000, v166
  s_add_u32 m0, s55, 48128
  s_waitcnt lgkmcnt(7)
  v_mfma_f32_32x32x16_bf16 v[32:47], v[132:135], v[112:115], v[32:47]
  buffer_load_dwordx4 v177, s[8:11], s52 offen lds
  ds_read_b64_tr_b16 v[146:147], v168 offset:23296
  ds_read_b64_tr_b16 v[148:149], v168 offset:21632
  s_add_u32 m0, s55, 49152
  s_waitcnt lgkmcnt(7)
  v_mfma_f32_32x32x16_bf16 v[64:79], v[136:139], v[112:115], v[64:79]
  buffer_load_dwordx4 v178, s[8:11], s52 offen lds
  ds_read_b64_tr_b16 v[150:151], v168 offset:23424
  ds_read_b64_tr_b16 v[152:153], v168 offset:21760
  s_add_u32 m0, s55, 50176
  s_waitcnt lgkmcnt(7)
  v_mfma_f32_32x32x16_bf16 v[96:111], v[140:143], v[112:115], v[96:111]
  buffer_load_dwordx4 v179, s[8:11], s52 offen lds
  ds_read_b64_tr_b16 v[154:155], v168 offset:23552
  ds_read_b64_tr_b16 v[156:157], v169 offset:21504
  s_add_u32 m0, s55, 51200
  s_waitcnt lgkmcnt(8)
  v_mfma_f32_32x32x16_bf16 v[16:31], v[128:131], v[116:119], v[16:31]
  buffer_load_dwordx4 v180, s[8:11], s52 offen lds
  ds_read_b64_tr_b16 v[158:159], v169 offset:23296
  ds_read_b128 v[124:127], v167
  v_mfma_f32_32x32x16_bf16 v[48:63], v[132:135], v[116:119], v[48:63]
  buffer_load_dwordx4 a[44:47], v208, s[12:15], s89 offen offset:1024 sc1
  v_mfma_f32_32x32x16_bf16 v[80:95], v[136:139], v[116:119], v[80:95]
  buffer_load_dwordx4 a[48:51], v208, s[12:15], s88 offen offset:2048 sc1
  v_add_u32 v163, 0xfffea000, v163
  v_add_u32 v167, 0xfffea000, v167
  v_add_u32 v168, 0xfffea000, v168
  v_add_u32 v169, 0xfffea000, v169
  s_waitcnt vmcnt(19)
  s_waitcnt lgkmcnt(0)
  s_barrier
  v_mfma_f32_32x32x16_bf16 v[0:15], v[144:147], v[120:123], v[0:15]
  ds_read_b128 v[112:115], v160
  ds_read_b64_tr_b16 v[128:129], v168 offset:0
  v_mfma_f32_32x32x16_bf16 v[32:47], v[148:151], v[120:123], v[32:47]
  buffer_load_dwordx4 a[52:55], v208, s[12:15], s89 offen offset:2048 sc1
  ds_read_b64_tr_b16 v[130:131], v168 offset:1792
  ds_read_b64_tr_b16 v[132:133], v168 offset:128
  v_mfma_f32_32x32x16_bf16 v[64:79], v[152:155], v[120:123], v[64:79]
  ds_read_b64_tr_b16 v[134:135], v168 offset:1920
  ds_read_b64_tr_b16 v[136:137], v168 offset:256
  v_mfma_f32_32x32x16_bf16 v[96:111], v[156:159], v[120:123], v[96:111]
  buffer_load_dwordx4 a[56:59], v208, s[12:15], s88 offen offset:3072 sc1
  ds_read_b64_tr_b16 v[138:139], v168 offset:2048
  ds_read_b64_tr_b16 v[140:141], v169 offset:0
  v_mfma_f32_32x32x16_bf16 v[16:31], v[144:147], v[124:127], v[16:31]
  ds_read_b64_tr_b16 v[142:143], v169 offset:1792
  ds_read_b128 v[116:119], v164
  v_mfma_f32_32x32x16_bf16 v[48:63], v[148:151], v[124:127], v[48:63]
  buffer_load_dwordx4 a[60:63], v208, s[12:15], s89 offen offset:3072 sc1
  v_mfma_f32_32x32x16_bf16 v[80:95], v[152:155], v[124:127], v[80:95]
  s_waitcnt lgkmcnt(7)
  v_mfma_f32_32x32x16_bf16 v[0:15], v[128:131], v[112:115], v[0:15]
  ds_read_b128 v[120:123], v161
  ds_read_b64_tr_b16 v[144:145], v168 offset:7168
  s_waitcnt lgkmcnt(7)
  v_mfma_f32_32x32x16_bf16 v[32:47], v[132:135], v[112:115], v[32:47]
L_stub_wide_1:
  s_cmp_eq_u32 s86, 1
  s_cbranch_scc1 L_tret_wide_1
  buffer_load_dwordx4 v[182:185], v211, s[12:15], 0 offen sc1
  ds_read_b64_tr_b16 v[146:147], v168 offset:8960
  ds_read_b64_tr_b16 v[148:149], v168 offset:7296
  s_waitcnt lgkmcnt(7)
  v_mfma_f32_32x32x16_bf16 v[64:79], v[136:139], v[112:115], v[64:79]
  ds_read_b64_tr_b16 v[150:151], v168 offset:9088
  ds_read_b64_tr_b16 v[152:153], v168 offset:7424
  s_waitcnt lgkmcnt(7)
  v_mfma_f32_32x32x16_bf16 v[96:111], v[140:143], v[112:115], v[96:111]
  buffer_load_dwordx4 v[186:189], v212, s[12:15], 0 offen sc1
  ds_read_b64_tr_b16 v[154:155], v168 offset:9216
  ds_read_b64_tr_b16 v[156:157], v169 offset:7168
  s_waitcnt lgkmcnt(8)
  v_mfma_f32_32x32x16_bf16 v[16:31], v[128:131], v[116:119], v[16:31]
  ds_read_b64_tr_b16 v[158:159], v169 offset:8960
  ds_read_b128 v[124:127], v165
  v_mfma_f32_32x32x16_bf16 v[48:63], v[132:135], v[116:119], v[48:63]
  buffer_load_dwordx4 v[190:193], v213, s[12:15], 0 offen offset:0 sc1
  v_mfma_f32_32x32x16_bf16 v[80:95], v[136:139], v[116:119], v[80:95]
  s_waitcnt lgkmcnt(7)
  v_mfma_f32_32x32x16_bf16 v[0:15], v[144:147], v[120:123], v[0:15]
  ds_read_b128 v[112:115], v162
  ds_read_b64_tr_b16 v[128:129], v168 offset:14336
  v_add_u32 v160, 0xb000, v160
  v_add_u32 v164, 0xb000, v164
  v_add_u32 v161, 0xb000, v161
  s_waitcnt lgkmcnt(7)
  v_mfma_f32_32x32x16_bf16 v[32:47], v[148:151], v[120:123], v[32:47]
  buffer_load_dwordx4 v[194:197], v213, s[12:15], 0 offen offset:1024 sc1
  ds_read_b64_tr_b16 v[130:131], v168 offset:16128
  ds_read_b64_tr_b16 v[132:133], v168 offset:14464
  v_add_u32 v165, 0xb000, v165
  s_waitcnt lgkmcnt(7)
  v_mfma_f32_32x32x16_bf16 v[64:79], v[152:155], v[120:123], v[64:79]
  ds_read_b64_tr_b16 v[134:135], v168 offset:16256
  ds_read_b64_tr_b16 v[136:137], v168 offset:14592
  s_waitcnt lgkmcnt(7)
  v_mfma_f32_32x32x16_bf16 v[96:111], v[156:159], v[120:123], v[96:111]
  buffer_load_dwordx4 v[198:201], v213, s[12:15], 0 offen offset:2048 sc1
  ds_read_b64_tr_b16 v[138:139], v168 offset:16384
  ds_read_b64_tr_b16 v[140:141], v169 offset:14336
  s_waitcnt lgkmcnt(8)
  v_mfma_f32_32x32x16_bf16 v[16:31], v[144:147], v[124:127], v[16:31]
  ds_read_b64_tr_b16 v[142:143], v169 offset:16128
  ds_read_b128 v[116:119], v166
  v_mfma_f32_32x32x16_bf16 v[48:63], v[148:151], v[124:127], v[48:63]
  buffer_load_dwordx4 v[202:205], v214, s[12:15], 0 offen sc1
  v_mfma_f32_32x32x16_bf16 v[80:95], v[152:155], v[124:127], v[80:95]
  s_waitcnt lgkmcnt(7)
  v_mfma_f32_32x32x16_bf16 v[0:15], v[128:131], v[112:115], v[0:15]
  ds_read_b128 v[120:123], v163
  ds_read_b64_tr_b16 v[144:145], v168 offset:21504
  v_add_u32 v162, 0xb000, v162
  v_add_u32 v166, 0xb000, v166
  s_add_u32 s88, s88, 4096
  s_waitcnt lgkmcnt(7)
  v_mfma_f32_32x32x16_bf16 v[32:47], v[132:135], v[112:115], v[32:47]
  buffer_load_dwordx4 a[64:67], v208, s[12:15], s88 offen offset:0 sc1
  ds_read_b64_tr_b16 v[146:147], v168 offset:23296
  ds_read_b64_tr_b16 v[148:149], v168 offset:21632
  s_waitcnt lgkmcnt(7)
  v_mfma_f32_32x32x16_bf16 v[64:79], v[136:139], v[112:115], v[64:79]
  ds_read_b64_tr_b16 v[150:151], v168 offset:23424
  ds_read_b64_tr_b16 v[152:153], v168 offset:21760
  s_add_u32 s89, s89, 4096
  s_waitcnt lgkmcnt(7)
  v_mfma_f32_32x32x16_bf16 v[96:111], v[140:143], v[112:115], v[96:111]
  buffer_load_dwordx4 a[68:71], v208, s[12:15], s89 offen offset:0 sc1
  ds_read_b64_tr_b16 v[154:155], v168 offset:23552
  ds_read_b64_tr_b16 v[156:157], v169 offset:21504
  s_waitcnt lgkmcnt(8)
  v_mfma_f32_32x32x16_bf16 v[16:31], v[128:131], v[116:119], v[16:31]
  buffer_load_dwordx4 a[72:75], v208, s[12:15], s88 offen offset:1024 sc1
  ds_read_b64_tr_b16 v[158:159], v169 offset:23296
  ds_read_b128 v[124:127], v167
  v_mfma_f32_32x32x16_bf16 v[48:63], v[132:135], v[116:119], v[48:63]
  v_mfma_f32_32x32x16_bf16 v[80:95], v[136:139], v[116:119], v[80:95]
  buffer_load_dwordx4 a[76:79], v208, s[12:15], s89 offen offset:1024 sc1
  v_add_u32 v163, 0xb000, v163
  v_add_u32 v167, 0xb000, v167
  v_add_u32 v168, 0xb000, v168
  v_add_u32 v169, 0xb000, v169
  s_waitcnt vmcnt(15)
  s_waitcnt lgkmcnt(0)
  s_barrier
  v_mfma_f32_32x32x16_bf16 v[0:15], v[144:147], v[120:123], v[0:15]
  ds_read_b128 v[112:115], v160
  ds_read_b64_tr_b16 v[128:129], v168 offset:0
  v_mfma_f32_32x32x16_bf16 v[32:47], v[148:151], v[120:123], v[32:47]
  buffer_load_dwordx4 a[80:83], v208, s[12:15], s88 offen offset:2048 sc1
  ds_read_b64_tr_b16 v[130:131], v168 offset:1792
  ds_read_b64_tr_b16 v[132:133], v168 offset:128
  v_mfma_f32_32x32x16_bf16 v[64:79], v[152:155], v[120:123], v[64:79]
  ds_read_b64_tr_b16 v[134:135], v168 offset:1920
  ds_read_b64_tr_b16 v[136:137], v168 offset:256
  v_mfma_f32_32x32x16_bf16 v[96:111], v[156:159], v[120:123], v[96:111]
  buffer_load_dwordx4 a[84:87], v208, s[12:15], s89 offen offset:2048 sc1
  ds_read_b64_tr_b16 v[138:139], v168 offset:2048
  ds_read_b64_tr_b16 v[140:141], v169 offset:0
  v_mfma_f32_32x32x16_bf16 v[16:31], v[144:147], v[124:127], v[16:31]
  buffer_load_dwordx4 a[88:91], v208, s[12:15], s88 offen offset:3072 sc1
  ds_read_b64_tr_b16 v[142:143], v169 offset:1792
  ds_read_b128 v[116:119], v164
  v_mfma_f32_32x32x16_bf16 v[48:63], v[148:151], v[124:127], v[48:63]
  v_mfma_f32_32x32x16_bf16 v[80:95], v[152:155], v[124:127], v[80:95]
  buffer_load_dwordx4 a[92:95], v208, s[12:15], s89 offen offset:3072 sc1
  s_waitcnt lgkmcnt(7)
  v_mfma_f32_32x32x16_bf16 v[0:15], v[128:131], v[112:115], v[0:15]
  ds_read_b128 v[120:123], v161
  ds_read_b64_tr_b16 v[144:145], v168 offset:7168
  s_add_u32 s88, s88, 4096
  s_waitcnt lgkmcnt(7)
  v_mfma_f32_32x32x16_bf16 v[32:47], v[132:135], v[112:115], v[32:47]
  buffer_load_dwordx4 a[96:99], v208, s[12:15], s88 offen offset:0 sc1
  ds_read_b64_tr_b16 v[146:147], v168 offset:8960
  ds_read_b64_tr_b16 v[148:149], v168 offset:7296
  s_waitcnt lgkmcnt(7)
  v_mfma_f32_32x32x16_bf16 v[64:79], v[136:139], v[112:115], v[64:79]
  ds_read_b64_tr_b16 v[150:151], v168 offset:9088
  ds_read_b64_tr_b16 v[152:153], v168 offset:7424
  s_waitcnt vmcnt(9)
  s_mov_b32 s58, 0
L_gchk_25:
  v_cmp_eq_u32 vcc, s56, v185
  v_cmp_eq_u32 s[62:63], s56, v189
  s_nop 0
  s_and_b64 vcc, vcc, s[62:63]
  v_cmp_eq_u32 s[62:63], s56, v193
  s_nop 0
  s_and_b64 vcc, vcc, s[62:63]
  v_cmp_eq_u32 s[62:63], s56, v197
  s_nop 0
  s_and_b64 vcc, vcc, s[62:63]
  v_cmp_eq_u32 s[62:63], s56, v201
  s_nop 0
  s_and_b64 vcc, vcc, s[62:63]
  v_cmp_eq_u32 s[62:63], s56, v205
  s_nop 0
  s_and_b64 vcc, vcc, s[62:63]
  s_cmp_eq_u64 vcc, exec
  s_cbranch_scc1 L_gok_26
  s_add_u32 s58, s58, 1
  s_cmp_ge_u32 s58, 262144
  s_cbranch_scc1 L_gok_26
  buffer_load_dwordx4 v[182:185], v211, s[12:15], 0 offen sc1
  buffer_load_dwordx4 v[186:189], v212, s[12:15], 0 offen sc1
  buffer_load_dwordx4 v[190:193], v213, s[12:15], 0 offen offset:0 sc1
  buffer_load_dwordx4 v[194:197], v213, s[12:15], 0 offen offset:1024 sc1
  buffer_load_dwordx4 v[198:201], v213, s[12:15], 0 offen offset:2048 sc1
  buffer_load_dwordx4 v[202:205], v214, s[12:15], 0 offen sc1
  s_waitcnt vmcnt(0)
  s_branch L_gchk_25
L_gok_26:
  s_add_u32 s89, s89, 4096
  s_waitcnt lgkmcnt(7)
  v_mfma_f32_32x32x16_bf16 v[96:111], v[140:143], v[112:115], v[96:111]
  buffer_load_dwordx4 a[100:103], v208, s[12:15], s89 offen offset:0 sc1
  ds_read_b64_tr_b16 v[154:155], v168 offset:9216
  ds_read_b64_tr_b16 v[156:157], v169 offset:7168
  s_waitcnt lgkmcnt(8)
  v_mfma_f32_32x32x16_bf16 v[16:31], v[128:131], v[116:119], v[16:31]
  buffer_load_dwordx4 a[104:107], v208, s[12:15], s88 offen offset:1024 sc1
  ds_read_b64_tr_b16 v[158:159], v169 offset:8960
  ds_read_b128 v[124:127], v165
  v_mfma_f32_32x32x16_bf16 v[48:63], v[132:135], v[116:119], v[48:63]
  v_mfma_f32_32x32x16_bf16 v[80:95], v[136:139], v[116:119], v[80:95]
  buffer_load_dwordx4 a[108:111], v208, s[12:15], s89 offen offset:1024 sc1
  s_waitcnt lgkmcnt(7)
  v_mfma_f32_32x32x16_bf16 v[0:15], v[144:147], v[120:123], v[0:15]
  ds_read_b128 v[112:115], v162
  ds_read_b64_tr_b16 v[128:129], v168 offset:14336
  s_waitcnt lgkmcnt(7)
  v_mfma_f32_32x32x16_bf16 v[32:47], v[148:151], v[120:123], v[32:47]
  buffer_load_dwordx4 a[112:115], v208, s[12:15], s88 offen offset:2048 sc1
  ds_read_b64_tr_b16 v[130:131], v168 offset:16128
  ds_read_b64_tr_b16 v[132:133], v168 offset:14464
  s_waitcnt lgkmcnt(7)
  v_mfma_f32_32x32x16_bf16 v[64:79], v[152:155], v[120:123], v[64:79]
  ds_read_b64_tr_b16 v[134:135], v168 offset:16256
  ds_read_b64_tr_b16 v[136:137], v168 offset:14592
  s_waitcnt lgkmcnt(7)
  v_mfma_f32_32x32x16_bf16 v[96:111], v[156:159], v[120:123], v[96:111]
  buffer_load_dwordx4 a[116:119], v208, s[12:15], s89 offen offset:2048 sc1
  ds_read_b64_tr_b16 v[138:139], v168 offset:16384
  ds_read_b64_tr_b16 v[140:141], v169 offset:14336
  s_waitcnt lgkmcnt(8)
  v_mfma_f32_32x32x16_bf16 v[16:31], v[144:147], v[124:127], v[16:31]
  buffer_load_dwordx4 a[120:123], v208, s[12:15], s88 offen offset:3072 sc1
  ds_read_b64_tr_b16 v[142:143], v169 offset:16128
  ds_read_b128 v[116:119], v166
  v_mfma_f32_32x32x16_bf16 v[48:63], v[148:151], v[124:127], v[48:63]
  v_mfma_f32_32x32x16_bf16 v[80:95], v[152:155], v[124:127], v[80:95]
  buffer_load_dwordx4 a[124:127], v208, s[12:15], s89 offen offset:3072 sc1
  s_waitcnt lgkmcnt(7)
  v_mfma_f32_32x32x16_bf16 v[0:15], v[128:131], v[112:115], v[0:15]
  ds_read_b128 v[120:123], v163
  ds_read_b64_tr_b16 v[144:145], v168 offset:21504
  s_add_u32 s88, s88, 4096
  s_waitcnt lgkmcnt(7)
  v_mfma_f32_32x32x16_bf16 v[32:47], v[132:135], v[112:115], v[32:47]
  buffer_load_dwordx4 a[128:131], v208, s[12:15], s88 offen offset:0 sc1
  ds_read_b64_tr_b16 v[146:147], v168 offset:23296
  ds_read_b64_tr_b16 v[148:149], v168 offset:21632
  s_waitcnt lgkmcnt(7)
  v_mfma_f32_32x32x16_bf16 v[64:79], v[136:139], v[112:115], v[64:79]
  ds_read_b64_tr_b16 v[150:151], v168 offset:23424
  ds_read_b64_tr_b16 v[152:153], v168 offset:21760
  s_add_u32 s89, s89, 4096
  s_waitcnt lgkmcnt(7)
  v_mfma_f32_32x32x16_bf16 v[96:111], v[140:143], v[112:115], v[96:111]
  buffer_load_dwordx4 a[132:135], v208, s[12:15], s89 offen offset:0 sc1
  ds_read_b64_tr_b16 v[154:155], v168 offset:23552
  ds_read_b64_tr_b16 v[156:157], v169 offset:21504
  s_waitcnt lgkmcnt(8)
  v_mfma_f32_32x32x16_bf16 v[16:31], v[128:131], v[116:119], v[16:31]
  ds_read_b64_tr_b16 v[158:159], v169 offset:23296
  ds_read_b128 v[124:127], v167
  v_mfma_f32_32x32x16_bf16 v[48:63], v[132:135], v[116:119], v[48:63]
  buffer_load_dwordx4 a[136:139], v208, s[12:15], s88 offen offset:1024 sc1
  v_mfma_f32_32x32x16_bf16 v[80:95], v[136:139], v[116:119], v[80:95]
  s_waitcnt lgkmcnt(7)
  v_mfma_f32_32x32x16_bf16 v[0:15], v[144:147], v[120:123], v[0:15]
  s_waitcnt lgkmcnt(5)
  v_mfma_f32_32x32x16_bf16 v[32:47], v[148:151], v[120:123], v[32:47]
  buffer_load_dwordx4 a[140:143], v208, s[12:15], s89 offen offset:1024 sc1
  s_waitcnt lgkmcnt(3)
  v_mfma_f32_32x32x16_bf16 v[64:79], v[152:155], v[120:123], v[64:79]
  s_add_u32 s88, s88, s29
  s_waitcnt lgkmcnt(1)
  v_mfma_f32_32x32x16_bf16 v[96:111], v[156:159], v[120:123], v[96:111]
  buffer_load_dwordx4 a[144:147], v208, s[12:15], s88 offen offset:0 sc1
  s_waitcnt lgkmcnt(0)
  v_mfma_f32_32x32x16_bf16 v[16:31], v[144:147], v[124:127], v[16:31]
  s_add_u32 s89, s89, s29
  v_mfma_f32_32x32x16_bf16 v[48:63], v[148:151], v[124:127], v[48:63]
  buffer_load_dwordx4 a[148:151], v208, s[12:15], s89 offen offset:0 sc1
  v_mfma_f32_32x32x16_bf16 v[80:95], v[152:155], v[124:127], v[80:95]
  v_mfma_f32_32x32x8_bf16 v[0:15], v[190:191], v[182:183], v[0:15]
  v_mfma_f32_32x32x8_bf16 v[16:31], v[190:191], v[186:187], v[16:31]
  v_mfma_f32_32x32x8_bf16 v[32:47], v[194:195], v[182:183], v[32:47]
  v_mfma_f32_32x32x8_bf16 v[48:63], v[194:195], v[186:187], v[48:63]
  v_mfma_f32_32x32x8_bf16 v[64:79], v[198:199], v[182:183], v[64:79]
  v_mfma_f32_32x32x8_bf16 v[80:95], v[198:199], v[186:187], v[80:95]
  v_mfma_f32_32x32x8_bf16 v[96:111], v[202:203], v[182:183], v[96:111]
  s_xor_b32 s61, s46, 0
  s_lshl_b32 s96, s42, 1
  s_add_u32 s61, s61, s96
  s_lshl_b32 s61, s61, 1
  s_add_u32 s61, s61, s45
  s_mul_i32 s61, s61, 118
  s_mul_i32 s96, s43, 12
  s_add_u32 s61, s61, s96
  s_add_u32 s61, s61, 32
  s_add_u32 s98, s61, 12
  s_lshl_b32 s98, s98, 10
  s_add_u32 s98, s98, 3145728
  s_lshl_b32 s96, s46, 1
  s_add_u32 s61, s61, s96
  s_lshl_b32 s61, s61, 10
  s_add_u32 s99, s61, 3145728
  s_xor_b32 s61, s46, 1
  s_lshl_b32 s96, s42, 1
  s_add_u32 s61, s61, s96
  s_lshl_b32 s61, s61, 1
  s_add_u32 s61, s61, s45
  s_mul_i32 s61, s61, 118
  s_mul_i32 s96, s43, 12
  s_add_u32 s61, s61, s96
  s_add_u32 s61, s61, 32
  s_lshl_b32 s96, s46, 1
  s_add_u32 s61, s61, s96
  s_lshl_b32 s61, s61, 10
  s_add_u32 s100, s61, 3145728
  v_cvt_pk_bf16_f32 v112, v0, v1
  v_cvt_pk_bf16_f32 v113, v2, v3
  v_cvt_pk_bf16_f32 v114, v4, v5
  v_cvt_pk_bf16_f32 v115, v6, v7
  v_pk_max_i16 v112, v112, 0
  v_pk_max_i16 v113, v113, 0
  v_pk_max_i16 v114, v114, 0
  v_pk_max_i16 v115, v115, 0
  v_or_b32 v112, v216, v112
  v_or_b32 v113, v217, v113
  v_or_b32 v114, v218, v114
  v_or_b32 v115, v219, v115
  buffer_store_dwordx4 v[112:115], v208, s[12:15], s99 offen offset:0 sc1
  v_cvt_pk_bf16_f32 v116, v8, v9
  v_cvt_pk_bf16_f32 v117, v10, v11
  v_cvt_pk_bf16_f32 v118, v12, v13
  v_cvt_pk_bf16_f32 v119, v14, v15
  v_pk_max_i16 v116, v116, 0
  v_pk_max_i16 v117, v117, 0
  v_pk_max_i16 v118, v118, 0
  v_pk_max_i16 v119, v119, 0
  v_or_b32 v116, v216, v116
  v_or_b32 v117, v217, v117
  v_or_b32 v118, v218, v118
  v_or_b32 v119, v219, v119
  buffer_store_dwordx4 v[116:119], v208, s[12:15], s99 offen offset:1024 sc1
  s_add_u32 s99, s99, 4096
  v_cvt_pk_bf16_f32 v120, v16, v17
  v_cvt_pk_bf16_f32 v121, v18, v19
  v_cvt_pk_bf16_f32 v122, v20, v21
  v_cvt_pk_bf16_f32 v123, v22, v23
  v_pk_max_i16 v120, v120, 0
  v_pk_max_i16 v121, v121, 0
  v_pk_max_i16 v122, v122, 0
  v_pk_max_i16 v123, v123, 0
  v_or_b32 v120, v216, v120
  v_or_b32 v121, v217, v121
  v_or_b32 v122, v218, v122
  v_or_b32 v123, v219, v123
  buffer_store_dwordx4 v[120:123], v208, s[12:15], s100 offen offset:0 sc1
  v_cvt_pk_bf16_f32 v124, v24, v25
  v_cvt_pk_bf16_f32 v125, v26, v27
  v_cvt_pk_bf16_f32 v126, v28, v29
  v_cvt_pk_bf16_f32 v127, v30, v31
  v_pk_max_i16 v124, v124, 0
  v_pk_max_i16 v125, v125, 0
  v_pk_max_i16 v126, v126, 0
  v_pk_max_i16 v127, v127, 0
  v_or_b32 v124, v216, v124
  v_or_b32 v125, v217, v125
  v_or_b32 v126, v218, v126
  v_or_b32 v127, v219, v127
  buffer_store_dwordx4 v[124:127], v208, s[12:15], s100 offen offset:1024 sc1
  s_add_u32 s100, s100, 4096
  v_cvt_pk_bf16_f32 v128, v32, v33
  v_cvt_pk_bf16_f32 v129, v34, v35
  v_cvt_pk_bf16_f32 v130, v36, v37
  v_cvt_pk_bf16_f32 v131, v38, v39
  v_pk_max_i16 v128, v128, 0
  v_pk_max_i16 v129, v129, 0
  v_pk_max_i16 v130, v130, 0
  v_pk_max_i16 v131, v131, 0
  v_or_b32 v128, v216, v128
  v_or_b32 v129, v217, v129
  v_or_b32 v130, v218, v130
  v_or_b32 v131, v219, v131
  buffer_store_dwordx4 v[128:131], v208, s[12:15], s99 offen offset:0 sc1
  v_cvt_pk_bf16_f32 v132, v40, v41
  v_cvt_pk_bf16_f32 v133, v42, v43
  v_cvt_pk_bf16_f32 v134, v44, v45
  v_cvt_pk_bf16_f32 v135, v46, v47
  v_pk_max_i16 v132, v132, 0
  v_pk_max_i16 v133, v133, 0
  v_pk_max_i16 v134, v134, 0
  v_pk_max_i16 v135, v135, 0
  v_or_b32 v132, v216, v132
  v_or_b32 v133, v217, v133
  v_or_b32 v134, v218, v134
  v_or_b32 v135, v219, v135
  buffer_store_dwordx4 v[132:135], v208, s[12:15], s99 offen offset:1024 sc1
  s_add_u32 s99, s99, 4096
  v_cvt_pk_bf16_f32 v136, v48, v49
  v_cvt_pk_bf16_f32 v137, v50, v51
  v_cvt_pk_bf16_f32 v138, v52, v53
  v_cvt_pk_bf16_f32 v139, v54, v55
  v_pk_max_i16 v136, v136, 0
  v_pk_max_i16 v137, v137, 0
  v_pk_max_i16 v138, v138, 0
  v_pk_max_i16 v139, v139, 0
  v_or_b32 v136, v216, v136
  v_or_b32 v137, v217, v137
  v_or_b32 v138, v218, v138
  v_or_b32 v139, v219, v139
  buffer_store_dwordx4 v[136:139], v208, s[12:15], s100 offen offset:0 sc1
  v_cvt_pk_bf16_f32 v140, v56, v57
  v_cvt_pk_bf16_f32 v141, v58, v59
  v_cvt_pk_bf16_f32 v142, v60, v61
  v_cvt_pk_bf16_f32 v143, v62, v63
  v_pk_max_i16 v140, v140, 0
  v_pk_max_i16 v141, v141, 0
  v_pk_max_i16 v142, v142, 0
  v_pk_max_i16 v143, v143, 0
  v_or_b32 v140, v216, v140
  v_or_b32 v141, v217, v141
  v_or_b32 v142, v218, v142
  v_or_b32 v143, v219, v143
  buffer_store_dwordx4 v[140:143], v208, s[12:15], s100 offen offset:1024 sc1
  s_add_u32 s100, s100, 4096
  v_cvt_pk_bf16_f32 v112, v64, v65
  v_cvt_pk_bf16_f32 v113, v66, v67
  v_cvt_pk_bf16_f32 v114, v68, v69
  v_cvt_pk_bf16_f32 v115, v70, v71
  v_pk_max_i16 v112, v112, 0
  v_pk_max_i16 v113, v113, 0
  v_pk_max_i16 v114, v114, 0
  v_pk_max_i16 v115, v115, 0
  v_or_b32 v112, v216, v112
  v_or_b32 v113, v217, v113
  v_or_b32 v114, v218, v114
  v_or_b32 v115, v219, v115
  buffer_store_dwordx4 v[112:115], v208, s[12:15], s99 offen offset:0 sc1
  v_cvt_pk_bf16_f32 v116, v72, v73
  v_cvt_pk_bf16_f32 v117, v74, v75
  v_cvt_pk_bf16_f32 v118, v76, v77
  v_cvt_pk_bf16_f32 v119, v78, v79
  v_pk_max_i16 v116, v116, 0
  v_pk_max_i16 v117, v117, 0
  v_pk_max_i16 v118, v118, 0
  v_pk_max_i16 v119, v119, 0
  v_or_b32 v116, v216, v116
  v_or_b32 v117, v217, v117
  v_or_b32 v118, v218, v118
  v_or_b32 v119, v219, v119
  buffer_store_dwordx4 v[116:119], v208, s[12:15], s99 offen offset:1024 sc1
  v_cvt_pk_bf16_f32 v120, v80, v81
  v_cvt_pk_bf16_f32 v121, v82, v83
  v_cvt_pk_bf16_f32 v122, v84, v85
  v_cvt_pk_bf16_f32 v123, v86, v87
  v_pk_max_i16 v120, v120, 0
  v_pk_max_i16 v121, v121, 0
  v_pk_max_i16 v122, v122, 0
  v_pk_max_i16 v123, v123, 0
  v_or_b32 v120, v216, v120
  v_or_b32 v121, v217, v121
  v_or_b32 v122, v218, v122
  v_or_b32 v123, v219, v123
  buffer_store_dwordx4 v[120:123], v208, s[12:15], s100 offen offset:0 sc1
  v_cvt_pk_bf16_f32 v124, v88, v89
  v_cvt_pk_bf16_f32 v125, v90, v91
  v_cvt_pk_bf16_f32 v126, v92, v93
  v_cvt_pk_bf16_f32 v127, v94, v95
  v_pk_max_i16 v124, v124, 0
  v_pk_max_i16 v125, v125, 0
  v_pk_max_i16 v126, v126, 0
  v_pk_max_i16 v127, v127, 0
  v_or_b32 v124, v216, v124
  v_or_b32 v125, v217, v125
  v_or_b32 v126, v218, v126
  v_or_b32 v127, v219, v127
  buffer_store_dwordx4 v[124:127], v208, s[12:15], s100 offen offset:1024 sc1
  v_cvt_pk_bf16_f32 v128, v96, v97
  v_cvt_pk_bf16_f32 v129, v98, v99
  v_cvt_pk_bf16_f32 v130, v100, v101
  v_cvt_pk_bf16_f32 v131, v102, v103
  v_pk_max_i16 v128, v128, 0
  v_pk_max_i16 v129, v129, 0
  v_pk_max_i16 v130, v130, 0
  v_pk_max_i16 v131, v131, 0
  v_or_b32 v128, v216, v128
  v_or_b32 v129, v217, v129
  v_or_b32 v130, v218, v130
  v_or_b32 v131, v219, v131
  buffer_store_dwordx4 v[128:131], v208, s[12:15], s98 offen offset:0 sc1
  v_cvt_pk_bf16_f32 v132, v104, v105
  v_cvt_pk_bf16_f32 v133, v106, v107
  v_cvt_pk_bf16_f32 v134, v108, v109
  v_cvt_pk_bf16_f32 v135, v110, v111
  v_pk_max_i16 v132, v132, 0
  v_pk_max_i16 v133, v133, 0
  v_pk_max_i16 v134, v134, 0
  v_pk_max_i16 v135, v135, 0
  v_or_b32 v132, v216, v132
  v_or_b32 v133, v217, v133
  v_or_b32 v134, v218, v134
  v_or_b32 v135, v219, v135
  buffer_store_dwordx4 v[132:135], v208, s[12:15], s98 offen offset:1024 sc1
  buffer_load_dwordx4 a[152:155], v208, s[12:15], s88 offen offset:1024 sc1
  buffer_load_dwordx4 a[156:159], v208, s[12:15], s89 offen offset:1024 sc1
  buffer_load_dwordx4 a[160:163], v208, s[12:15], s88 offen offset:2048 sc1
  buffer_load_dwordx4 a[164:167], v208, s[12:15], s89 offen offset:2048 sc1
  buffer_load_dwordx4 a[168:171], v208, s[12:15], s88 offen offset:3072 sc1
  buffer_load_dwordx4 a[172:175], v208, s[12:15], s89 offen offset:3072 sc1
  s_add_u32 s88, s88, s32
  buffer_load_dwordx4 a[176:179], v208, s[12:15], s88 offen offset:0 sc1
  s_add_u32 s89, s89, s32
  buffer_load_dwordx4 a[180:183], v208, s[12:15], s89 offen offset:0 sc1
  buffer_load_dwordx4 a[184:187], v208, s[12:15], s88 offen offset:1024 sc1
  buffer_load_dwordx4 a[188:191], v208, s[12:15], s89 offen offset:1024 sc1
  buffer_load_dwordx4 a[192:195], v208, s[12:15], s88 offen offset:2048 sc1
  buffer_load_dwordx4 a[196:199], v208, s[12:15], s89 offen offset:2048 sc1
  buffer_load_dwordx4 a[200:203], v208, s[12:15], s88 offen offset:3072 sc1
  buffer_load_dwordx4 a[204:207], v208, s[12:15], s89 offen offset:3072 sc1
  s_add_u32 s88, s88, 4096
  buffer_load_dwordx4 a[208:211], v208, s[12:15], s88 offen offset:0 sc1
  s_add_u32 s89, s89, 4096
  buffer_load_dwordx4 a[212:215], v208, s[12:15], s89 offen offset:0 sc1
  buffer_load_dwordx4 a[216:219], v208, s[12:15], s88 offen offset:1024 sc1
  buffer_load_dwordx4 a[220:223], v208, s[12:15], s89 offen offset:1024 sc1
  buffer_load_dwordx4 a[224:227], v208, s[12:15], s88 offen offset:2048 sc1
  buffer_load_dwordx4 a[228:231], v208, s[12:15], s89 offen offset:2048 sc1
  buffer_load_dwordx4 a[232:235], v208, s[12:15], s88 offen offset:3072 sc1
  buffer_load_dwordx4 a[236:239], v208, s[12:15], s89 offen offset:3072 sc1
  buffer_load_dwordx4 v[64:67], v181, s[12:15], s24 offen offset:0 sc1
  buffer_load_dwordx4 v[68:71], v239, s[12:15], s24 offen offset:0 sc1
  buffer_load_dwordx4 v[72:75], v181, s[12:15], s24 offen offset:1024 sc1
  buffer_load_dwordx4 v[76:79], v239, s[12:15], s24 offen offset:1024 sc1
  buffer_load_dwordx4 v[80:83], v181, s[12:15], s24 offen offset:2048 sc1
  buffer_load_dwordx4 v[84:87], v239, s[12:15], s24 offen offset:2048 sc1
  buffer_load_dwordx4 v[88:91], v181, s[12:15], s24 offen offset:3072 sc1
  buffer_load_dwordx4 v[92:95], v239, s[12:15], s24 offen offset:3072 sc1
  buffer_load_dwordx4 v[96:99], v181, s[12:15], s38 offen offset:0 sc1
  buffer_load_dwordx4 v[100:103], v239, s[12:15], s38 offen offset:0 sc1
  buffer_load_dwordx4 v[104:107], v181, s[12:15], s38 offen offset:1024 sc1
  buffer_load_dwordx4 v[108:111], v239, s[12:15], s38 offen offset:1024 sc1
  buffer_load_dwordx4 v[112:115], v181, s[12:15], s38 offen offset:2048 sc1
  buffer_load_dwordx4 v[116:119], v239, s[12:15], s38 offen offset:2048 sc1
  buffer_load_dwordx4 v[120:123], v181, s[12:15], s38 offen offset:3072 sc1
  buffer_load_dwordx4 v[124:127], v239, s[12:15], s38 offen offset:3072 sc1
  s_mov_b32 s37, 0x80008000
  s_mov_b32 s58, 0
  s_branch L_p2
.p2align 12
L_p2:
  s_waitcnt vmcnt(14)
  v_bitop3_b32 v168, v64, v68, v216 bitop3:0x7e
  v_bitop3_b32 v169, v65, v69, v217 bitop3:0x7e
  v_bitop3_b32 v170, v66, v70, v218 bitop3:0x7e
  v_bitop3_b32 v171, v67, v71, v219 bitop3:0x7e
  v_or3_b32 v168, v168, v169, v170
  v_bitop3_b32 v168, v168, v171, s37 bitop3:0xa8
  v_cmp_ne_u32 s[30:31], 0, v168
  s_nop 0
  s_cmp_lg_u64 s[30:31], 0
  s_cbranch_scc1 L_slow_27
L_back_28:
  v_mfma_f32_32x32x16_bf16 v[0:15], a[0:3], v[64:67], 0
  s_waitcnt vmcnt(12)
  v_bitop3_b32 v168, v72, v76, v216 bitop3:0x7e
  v_bitop3_b32 v169, v73, v77, v217 bitop3:0x7e
  v_bitop3_b32 v170, v74, v78, v218 bitop3:0x7e
  v_bitop3_b32 v171, v75, v79, v219 bitop3:0x7e
  v_mfma_f32_32x32x16_bf16 v[16:31], a[0:3], v[68:71], 0
  v_or3_b32 v168, v168, v169, v170
  v_bitop3_b32 v168, v168, v171, s37 bitop3:0xa8
  v_cmp_ne_u32 s[30:31], 0, v168
  v_mfma_f32_32x32x16_bf16 v[32:47], a[4:7], v[64:67], 0
  s_cmp_lg_u64 s[30:31], 0
  v_mfma_f32_32x32x16_bf16 v[48:63], a[4:7], v[68:71], 0
  s_cbranch_scc1 L_slow_29
L_back_30:
  buffer_load_dwordx4 v[64:67], v181, s[12:15], s39 offen offset:0 sc1
  buffer_load_dwordx4 v[68:71], v239, s[12:15], s39 offen offset:0 sc1
  v_mfma_f32_32x32x16_bf16 v[0:15], a[8:11], v[72:75], v[0:15]
  s_waitcnt vmcnt(12)
  v_bitop3_b32 v168, v80, v84, v216 bitop3:0x7e
  v_bitop3_b32 v169, v81, v85, v217 bitop3:0x7e
  v_bitop3_b32 v170, v82, v86, v218 bitop3:0x7e
  v_bitop3_b32 v171, v83, v87, v219 bitop3:0x7e
  v_mfma_f32_32x32x16_bf16 v[16:31], a[8:11], v[76:79], v[16:31]
  v_or3_b32 v168, v168, v169, v170
  v_bitop3_b32 v168, v168, v171, s37 bitop3:0xa8
  v_cmp_ne_u32 s[30:31], 0, v168
  v_mfma_f32_32x32x16_bf16 v[32:47], a[12:15], v[72:75], v[32:47]
  s_cmp_lg_u64 s[30:31], 0
  v_mfma_f32_32x32x16_bf16 v[48:63], a[12:15], v[76:79], v[48:63]
  s_cbranch_scc1 L_slow_31
L_back_32:
  buffer_load_dwordx4 v[72:75], v181, s[12:15], s39 offen offset:1024 sc1
  buffer_load_dwordx4 v[76:79], v239, s[12:15], s39 offen offset:1024 sc1
  v_mfma_f32_32x32x16_bf16 v[0:15], a[16:19], v[80:83], v[0:15]
  s_waitcnt vmcnt(12)
  v_bitop3_b32 v168, v88, v92, v216 bitop3:0x7e
  v_bitop3_b32 v169, v89, v93, v217 bitop3:0x7e
  v_bitop3_b32 v170, v90, v94, v218 bitop3:0x7e
  v_bitop3_b32 v171, v91, v95, v219 bitop3:0x7e
  v_mfma_f32_32x32x16_bf16 v[16:31], a[16:19], v[84:87], v[16:31]
  v_or3_b32 v168, v168, v169, v170
  v_bitop3_b32 v168, v168, v171, s37 bitop3:0xa8
  v_cmp_ne_u32 s[30:31], 0, v168
  v_mfma_f32_32x32x16_bf16 v[32:47], a[20:23], v[80:83], v[32:47]
  s_cmp_lg_u64 s[30:31], 0
  v_mfma_f32_32x32x16_bf16 v[48:63], a[20:23], v[84:87], v[48:63]
  s_cbranch_scc1 L_slow_33
L_back_34:
  buffer_load_dwordx4 v[80:83], v181, s[12:15], s39 offen offset:2048 sc1
  buffer_load_dwordx4 v[84:87], v239, s[12:15], s39 offen offset:2048 sc1
  v_mfma_f32_32x32x16_bf16 v[0:15], a[24:27], v[88:91], v[0:15]
  s_waitcnt vmcnt(12)
  v_bitop3_b32 v168, v96, v100, v216 bitop3:0x7e
  v_bitop3_b32 v169, v97, v101, v217 bitop3:0x7e
  v_bitop3_b32 v170, v98, v102, v218 bitop3:0x7e
  v_bitop3_b32 v171, v99, v103, v219 bitop3:0x7e
  v_mfma_f32_32x32x16_bf16 v[16:31], a[24:27], v[92:95], v[16:31]
  v_or3_b32 v168, v168, v169, v170
  v_bitop3_b32 v168, v168, v171, s37 bitop3:0xa8
  v_cmp_ne_u32 s[30:31], 0, v168
  v_mfma_f32_32x32x16_bf16 v[32:47], a[28:31], v[88:91], v[32:47]
  s_cmp_lg_u64 s[30:31], 0
  v_mfma_f32_32x32x16_bf16 v[48:63], a[28:31], v[92:95], v[48:63]
  s_cbranch_scc1 L_slow_35
L_back_36:
  buffer_load_dwordx4 v[88:91], v181, s[12:15], s39 offen offset:3072 sc1
  buffer_load_dwordx4 v[92:95], v239, s[12:15], s39 offen offset:3072 sc1
  v_mfma_f32_32x32x16_bf16 v[0:15], a[32:35], v[96:99], v[0:15]
  s_waitcnt vmcnt(12)
  v_bitop3_b32 v168, v104, v108, v216 bitop3:0x7e
  v_bitop3_b32 v169, v105, v109, v217 bitop3:0x7e
  v_bitop3_b32 v170, v106, v110, v218 bitop3:0x7e
  v_bitop3_b32 v171, v107, v111, v219 bitop3:0x7e
  v_mfma_f32_32x32x16_bf16 v[16:31], a[32:35], v[100:103], v[16:31]
  v_or3_b32 v168, v168, v169, v170
  v_bitop3_b32 v168, v168, v171, s37 bitop3:0xa8
  v_cmp_ne_u32 s[30:31], 0, v168
  v_mfma_f32_32x32x16_bf16 v[32:47], a[36:39], v[96:99], v[32:47]
  s_cmp_lg_u64 s[30:31], 0
  v_mfma_f32_32x32x16_bf16 v[48:63], a[36:39], v[100:103], v[48:63]
  s_cbranch_scc1 L_slow_37
L_back_38:
  buffer_load_dwordx4 v[96:99], v181, s[12:15], s1 offen offset:0 sc1
  buffer_load_dwordx4 v[100:103], v239, s[12:15], s1 offen offset:0 sc1
  v_mfma_f32_32x32x16_bf16 v[0:15], a[40:43], v[104:107], v[0:15]
  s_waitcnt vmcnt(12)
  v_bitop3_b32 v168, v112, v116, v216 bitop3:0x7e
  v_bitop3_b32 v169, v113, v117, v217 bitop3:0x7e
  v_bitop3_b32 v170, v114, v118, v218 bitop3:0x7e
  v_bitop3_b32 v171, v115, v119, v219 bitop3:0x7e
  v_mfma_f32_32x32x16_bf16 v[16:31], a[40:43], v[108:111], v[16:31]
  v_or3_b32 v168, v168, v169, v170
  v_bitop3_b32 v168, v168, v171, s37 bitop3:0xa8
  v_cmp_ne_u32 s[30:31], 0, v168
  v_mfma_f32_32x32x16_bf16 v[32:47], a[44:47], v[104:107], v[32:47]
  s_cmp_lg_u64 s[30:31], 0
  v_mfma_f32_32x32x16_bf16 v[48:63], a[44:47], v[108:111], v[48:63]
  s_cbranch_scc1 L_slow_39
L_back_40:
  buffer_load_dwordx4 v[104:107], v181, s[12:15], s1 offen offset:1024 sc1
  buffer_load_dwordx4 v[108:111], v239, s[12:15], s1 offen offset:1024 sc1
  v_mfma_f32_32x32x16_bf16 v[0:15], a[48:51], v[112:115], v[0:15]
  s_waitcnt vmcnt(12)
  v_bitop3_b32 v168, v120, v124, v216 bitop3:0x7e
  v_bitop3_b32 v169, v121, v125, v217 bitop3:0x7e
  v_bitop3_b32 v170, v122, v126, v218 bitop3:0x7e
  v_bitop3_b32 v171, v123, v127, v219 bitop3:0x7e
  v_mfma_f32_32x32x16_bf16 v[16:31], a[48:51], v[116:119], v[16:31]
  v_or3_b32 v168, v168, v169, v170
  v_bitop3_b32 v168, v168, v171, s37 bitop3:0xa8
  v_cmp_ne_u32 s[30:31], 0, v168
  v_mfma_f32_32x32x16_bf16 v[32:47], a[52:55], v[112:115], v[32:47]
  s_cmp_lg_u64 s[30:31], 0
  v_mfma_f32_32x32x16_bf16 v[48:63], a[52:55], v[116:119], v[48:63]
  s_cbranch_scc1 L_slow_41
L_back_42:
  buffer_load_dwordx4 v[112:115], v181, s[12:15], s1 offen offset:2048 sc1
  buffer_load_dwordx4 v[116:119], v239, s[12:15], s1 offen offset:2048 sc1
  v_mfma_f32_32x32x16_bf16 v[0:15], a[56:59], v[120:123], v[0:15]
  s_waitcnt vmcnt(12)
  v_bitop3_b32 v168, v64, v68, v216 bitop3:0x7e
  v_bitop3_b32 v169, v65, v69, v217 bitop3:0x7e
  v_bitop3_b32 v170, v66, v70, v218 bitop3:0x7e
  v_bitop3_b32 v171, v67, v71, v219 bitop3:0x7e
  v_mfma_f32_32x32x16_bf16 v[16:31], a[56:59], v[124:127], v[16:31]
  v_or3_b32 v168, v168, v169, v170
  v_bitop3_b32 v168, v168, v171, s37 bitop3:0xa8
  v_cmp_ne_u32 s[30:31], 0, v168
  v_mfma_f32_32x32x16_bf16 v[32:47], a[60:63], v[120:123], v[32:47]
  s_cmp_lg_u64 s[30:31], 0
  v_mfma_f32_32x32x16_bf16 v[48:63], a[60:63], v[124:127], v[48:63]
  s_cbranch_scc1 L_slow_43
L_back_44:
  buffer_load_dwordx4 v[120:123], v181, s[12:15], s1 offen offset:3072 sc1
  buffer_load_dwordx4 v[124:127], v239, s[12:15], s1 offen offset:3072 sc1
  buffer_load_dwordx2 v[254:255], v235, s[12:15], 0 offen sc1
  v_mfma_f32_32x32x16_bf16 v[0:15], a[64:67], v[64:67], v[0:15]
  s_waitcnt vmcnt(13)
  v_bitop3_b32 v168, v72, v76, v216 bitop3:0x7e
  v_bitop3_b32 v169, v73, v77, v217 bitop3:0x7e
  v_bitop3_b32 v170, v74, v78, v218 bitop3:0x7e
  v_bitop3_b32 v171, v75, v79, v219 bitop3:0x7e
  v_mfma_f32_32x32x16_bf16 v[16:31], a[64:67], v[68:71], v[16:31]
  v_or3_b32 v168, v168, v169, v170
  v_bitop3_b32 v168, v168, v171, s37 bitop3:0xa8
  v_cmp_ne_u32 s[30:31], 0, v168
  v_mfma_f32_32x32x16_bf16 v[32:47], a[68:71], v[64:67], v[32:47]
  s_cmp_lg_u64 s[30:31], 0
  v_mfma_f32_32x32x16_bf16 v[48:63], a[68:71], v[68:71], v[48:63]
  s_cbranch_scc1 L_slow_45
L_back_46:
  buffer_load_dwordx4 v[64:67], v181, s[12:15], s0 offen offset:0 sc1
  buffer_load_dwordx4 v[68:71], v239, s[12:15], s0 offen offset:0 sc1
  v_mfma_f32_32x32x16_bf16 v[0:15], a[72:75], v[72:75], v[0:15]
  s_waitcnt vmcnt(13)
  v_bitop3_b32 v168, v80, v84, v216 bitop3:0x7e
  v_bitop3_b32 v169, v81, v85, v217 bitop3:0x7e
  v_bitop3_b32 v170, v82, v86, v218 bitop3:0x7e
  v_bitop3_b32 v171, v83, v87, v219 bitop3:0x7e
  v_mfma_f32_32x32x16_bf16 v[16:31], a[72:75], v[76:79], v[16:31]
  v_or3_b32 v168, v168, v169, v170
  v_bitop3_b32 v168, v168, v171, s37 bitop3:0xa8
  v_cmp_ne_u32 s[30:31], 0, v168
  v_mfma_f32_32x32x16_bf16 v[32:47], a[76:79], v[72:75], v[32:47]
  s_cmp_lg_u64 s[30:31], 0
  v_mfma_f32_32x32x16_bf16 v[48:63], a[76:79], v[76:79], v[48:63]
  s_cbranch_scc1 L_slow_47
L_back_48:
  buffer_load_dwordx4 v[72:75], v181, s[12:15], s0 offen offset:1024 sc1
  buffer_load_dwordx4 v[76:79], v239, s[12:15], s0 offen offset:1024 sc1
  v_mfma_f32_32x32x16_bf16 v[0:15], a[80:83], v[80:83], v[0:15]
  s_waitcnt vmcnt(13)
  v_bitop3_b32 v168, v88, v92, v216 bitop3:0x7e
  v_bitop3_b32 v169, v89, v93, v217 bitop3:0x7e
  v_bitop3_b32 v170, v90, v94, v218 bitop3:0x7e
  v_bitop3_b32 v171, v91, v95, v219 bitop3:0x7e
  v_mfma_f32_32x32x16_bf16 v[16:31], a[80:83], v[84:87], v[16:31]
  v_or3_b32 v168, v168, v169, v170
  v_bitop3_b32 v168, v168, v171, s37 bitop3:0xa8
  v_cmp_ne_u32 s[30:31], 0, v168
  v_mfma_f32_32x32x16_bf16 v[32:47], a[84:87], v[80:83], v[32:47]
  s_cmp_lg_u64 s[30:31], 0
  v_mfma_f32_32x32x16_bf16 v[48:63], a[84:87], v[84:87], v[48:63]
  s_cbranch_scc1 L_slow_49
L_back_50:
  buffer_load_dwordx4 v[80:83], v181, s[12:15], s28 offen offset:0 sc1
  buffer_load_dwordx4 v[84:87], v239, s[12:15], s28 offen offset:0 sc1
  v_mfma_f32_32x32x16_bf16 v[0:15], a[88:91], v[88:91], v[0:15]
  s_waitcnt vmcnt(13)
  v_bitop3_b32 v168, v96, v100, v216 bitop3:0x7e
  v_bitop3_b32 v169, v97, v101, v217 bitop3:0x7e
  v_bitop3_b32 v170, v98, v102, v218 bitop3:0x7e
  v_bitop3_b32 v171, v99, v103, v219 bitop3:0x7e
  v_mfma_f32_32x32x16_bf16 v[16:31], a[88:91], v[92:95], v[16:31]
  v_or3_b32 v168, v168, v169, v170
  v_bitop3_b32 v168, v168, v171, s37 bitop3:0xa8
  v_cmp_ne_u32 s[30:31], 0, v168
  v_mfma_f32_32x32x16_bf16 v[32:47], a[92:95], v[88:91], v[32:47]
  s_cmp_lg_u64 s[30:31], 0
  v_mfma_f32_32x32x16_bf16 v[48:63], a[92:95], v[92:95], v[48:63]
  s_cbranch_scc1 L_slow_51
L_back_52:
  buffer_load_dwordx4 v[88:91], v181, s[12:15], s28 offen offset:1024 sc1
  buffer_load_dwordx4 v[92:95], v239, s[12:15], s28 offen offset:1024 sc1
  v_mfma_f32_32x32x16_bf16 v[0:15], a[96:99], v[96:99], v[0:15]
  s_waitcnt vmcnt(13)
  v_bitop3_b32 v168, v104, v108, v216 bitop3:0x7e
  v_bitop3_b32 v169, v105, v109, v217 bitop3:0x7e
  v_bitop3_b32 v170, v106, v110, v218 bitop3:0x7e
  v_bitop3_b32 v171, v107, v111, v219 bitop3:0x7e
  v_mfma_f32_32x32x16_bf16 v[16:31], a[96:99], v[100:103], v[16:31]
  v_or3_b32 v168, v168, v169, v170
  v_bitop3_b32 v168, v168, v171, s37 bitop3:0xa8
  v_cmp_ne_u32 s[30:31], 0, v168
  v_mfma_f32_32x32x16_bf16 v[32:47], a[100:103], v[96:99], v[32:47]
  s_cmp_lg_u64 s[30:31], 0
  v_mfma_f32_32x32x16_bf16 v[48:63], a[100:103], v[100:103], v[48:63]
  s_cbranch_scc1 L_slow_53
L_back_54:
  buffer_load_dwordx4 v[96:99], v181, s[12:15], s26 offen offset:0 sc1
  buffer_load_dwordx4 v[100:103], v239, s[12:15], s26 offen offset:0 sc1
  v_mfma_f32_32x32x16_bf16 v[0:15], a[104:107], v[104:107], v[0:15]
  s_waitcnt vmcnt(13)
  v_bitop3_b32 v168, v112, v116, v216 bitop3:0x7e
  v_bitop3_b32 v169, v113, v117, v217 bitop3:0x7e
  v_bitop3_b32 v170, v114, v118, v218 bitop3:0x7e
  v_bitop3_b32 v171, v115, v119, v219 bitop3:0x7e
  v_mfma_f32_32x32x16_bf16 v[16:31], a[104:107], v[108:111], v[16:31]
  v_or3_b32 v168, v168, v169, v170
  v_bitop3_b32 v168, v168, v171, s37 bitop3:0xa8
  v_cmp_ne_u32 s[30:31], 0, v168
  v_mfma_f32_32x32x16_bf16 v[32:47], a[108:111], v[104:107], v[32:47]
  s_cmp_lg_u64 s[30:31], 0
  v_mfma_f32_32x32x16_bf16 v[48:63], a[108:111], v[108:111], v[48:63]
  s_cbranch_scc1 L_slow_55
L_back_56:
  buffer_load_dwordx4 v[104:107], v181, s[12:15], s27 offen offset:0 sc1
  buffer_load_dwordx4 v[108:111], v239, s[12:15], s27 offen offset:0 sc1
  s_waitcnt vmcnt(12)
  s_mov_b32 s58, 0
L_fchk_57:
  v_cmp_eq_u32 s[30:31], s56, v254
  v_cmp_eq_u32 s[34:35], s57, v255
  s_nop 0
  s_and_b64 s[30:31], s[30:31], s[34:35]
  s_cmp_eq_u64 s[30:31], exec
  s_cbranch_scc1 L_fok_58
  s_add_u32 s58, s58, 1
  s_cmp_ge_u32 s58, 262144
  s_cbranch_scc1 L_fok_58
  buffer_load_dwordx2 v[254:255], v235, s[12:15], 0 offen sc1
  s_waitcnt vmcnt(0)
  s_branch L_fchk_57
L_fok_58:
  v_mfma_f32_32x32x16_bf16 v[0:15], a[112:115], v[112:115], v[0:15]
  s_waitcnt vmcnt(13)
  v_bitop3_b32 v168, v120, v124, v216 bitop3:0x7e
  v_bitop3_b32 v169, v121, v125, v217 bitop3:0x7e
  v_bitop3_b32 v170, v122, v126, v218 bitop3:0x7e
  v_bitop3_b32 v171, v123, v127, v219 bitop3:0x7e
  v_mfma_f32_32x32x16_bf16 v[16:31], a[112:115], v[116:119], v[16:31]
  v_or3_b32 v168, v168, v169, v170
  v_bitop3_b32 v168, v168, v171, s37 bitop3:0xa8
  v_cmp_ne_u32 s[30:31], 0, v168
  v_mfma_f32_32x32x16_bf16 v[32:47], a[116:119], v[112:115], v[32:47]
  s_cmp_lg_u64 s[30:31], 0
  v_mfma_f32_32x32x16_bf16 v[48:63], a[116:119], v[116:119], v[48:63]
  s_cbranch_scc1 L_slow_59
L_back_60:
  buffer_load_dwordx4 v[112:115], v181, s[12:15], s25 offen offset:0 sc1
  buffer_load_dwordx4 v[116:119], v239, s[12:15], s25 offen offset:0 sc1
  v_mfma_f32_32x32x16_bf16 v[0:15], a[120:123], v[120:123], v[0:15]
  s_waitcnt vmcnt(12)
  v_bitop3_b32 v168, v64, v68, v216 bitop3:0x7e
  v_bitop3_b32 v169, v65, v69, v217 bitop3:0x7e
  v_bitop3_b32 v170, v66, v70, v218 bitop3:0x7e
  v_bitop3_b32 v171, v67, v71, v219 bitop3:0x7e
  v_mfma_f32_32x32x16_bf16 v[16:31], a[120:123], v[124:127], v[16:31]
  v_or3_b32 v168, v168, v169, v170
  v_bitop3_b32 v168, v168, v171, s37 bitop3:0xa8
  v_cmp_ne_u32 s[30:31], 0, v168
  v_mfma_f32_32x32x16_bf16 v[32:47], a[124:127], v[120:123], v[32:47]
  s_cmp_lg_u64 s[30:31], 0
  v_mfma_f32_32x32x16_bf16 v[48:63], a[124:127], v[124:127], v[48:63]
  s_cbranch_scc1 L_slow_61
L_back_62:
  buffer_load_dwordx4 v[120:123], v181, s[12:15], s25 offen offset:1024 sc1
  buffer_load_dwordx4 v[124:127], v239, s[12:15], s25 offen offset:1024 sc1
  v_mfma_f32_32x32x16_bf16 v[0:15], a[128:131], v[64:67], v[0:15]
  s_waitcnt vmcnt(12)
  v_bitop3_b32 v168, v72, v76, v216 bitop3:0x7e
  v_bitop3_b32 v169, v73, v77, v217 bitop3:0x7e
  v_bitop3_b32 v170, v74, v78, v218 bitop3:0x7e
  v_bitop3_b32 v171, v75, v79, v219 bitop3:0x7e
  v_mfma_f32_32x32x16_bf16 v[16:31], a[128:131], v[68:71], v[16:31]
  v_or3_b32 v168, v168, v169, v170
  v_bitop3_b32 v168, v168, v171, s37 bitop3:0xa8
  v_cmp_ne_u32 s[30:31], 0, v168
  v_mfma_f32_32x32x16_bf16 v[32:47], a[132:135], v[64:67], v[32:47]
  s_cmp_lg_u64 s[30:31], 0
  v_mfma_f32_32x32x16_bf16 v[48:63], a[132:135], v[68:71], v[48:63]
  s_cbranch_scc1 L_slow_63
L_back_64:
  buffer_load_dwordx4 v[64:67], v239, s[12:15], s25 offen offset:2048 sc1
  buffer_load_dwordx4 v[68:71], v239, s[12:15], s25 offen offset:3072 sc1
  v_mfma_f32_32x32x16_bf16 v[0:15], a[136:139], v[72:75], v[0:15]
  s_waitcnt vmcnt(12)
  v_bitop3_b32 v168, v80, v84, v216 bitop3:0x7e
  v_bitop3_b32 v169, v81, v85, v217 bitop3:0x7e
  v_bitop3_b32 v170, v82, v86, v218 bitop3:0x7e
  v_bitop3_b32 v171, v83, v87, v219 bitop3:0x7e
  v_mfma_f32_32x32x16_bf16 v[16:31], a[136:139], v[76:79], v[16:31]
  v_or3_b32 v168, v168, v169, v170
  v_bitop3_b32 v168, v168, v171, s37 bitop3:0xa8
  v_cmp_ne_u32 s[30:31], 0, v168
  v_mfma_f32_32x32x16_bf16 v[32:47], a[140:143], v[72:75], v[32:47]
  s_cmp_lg_u64 s[30:31], 0
  v_mfma_f32_32x32x16_bf16 v[48:63], a[140:143], v[76:79], v[48:63]
  s_cbranch_scc1 L_slow_65
L_back_66:
  buffer_load_dwordx4 v[72:75], v239, s[12:15], s33 offen offset:0 sc1
  buffer_load_dwordx4 v[76:79], v239, s[12:15], s33 offen offset:1024 sc1
  v_mfma_f32_32x32x16_bf16 v[0:15], a[144:147], v[80:83], v[0:15]
  s_waitcnt vmcnt(12)
  v_bitop3_b32 v168, v88, v92, v216 bitop3:0x7e
  v_bitop3_b32 v169, v89, v93, v217 bitop3:0x7e
  v_bitop3_b32 v170, v90, v94, v218 bitop3:0x7e
  v_bitop3_b32 v171, v91, v95, v219 bitop3:0x7e
  v_mfma_f32_32x32x16_bf16 v[16:31], a[144:147], v[84:87], v[16:31]
  v_or3_b32 v168, v168, v169, v170
  v_bitop3_b32 v168, v168, v171, s37 bitop3:0xa8
  v_cmp_ne_u32 s[30:31], 0, v168
  v_mfma_f32_32x32x16_bf16 v[32:47], a[148:151], v[80:83], v[32:47]
  s_cmp_lg_u64 s[30:31], 0
  v_mfma_f32_32x32x16_bf16 v[48:63], a[148:151], v[84:87], v[48:63]
  s_cbranch_scc1 L_slow_67
L_back_68:
  buffer_load_dwordx4 v[80:83], v239, s[12:15], s33 offen offset:2048 sc1
  buffer_load_dwordx4 v[84:87], v239, s[12:15], s33 offen offset:3072 sc1
  v_mfma_f32_32x32x16_bf16 v[0:15], a[152:155], v[88:91], v[0:15]
  s_waitcnt vmcnt(12)
  v_bitop3_b32 v168, v96, v100, v216 bitop3:0x7e
  v_bitop3_b32 v169, v97, v101, v217 bitop3:0x7e
  v_bitop3_b32 v170, v98, v102, v218 bitop3:0x7e
  v_bitop3_b32 v171, v99, v103, v219 bitop3:0x7e
  v_mfma_f32_32x32x16_bf16 v[16:31], a[152:155], v[92:95], v[16:31]
  v_or3_b32 v168, v168, v169, v170
  v_bitop3_b32 v168, v168, v171, s37 bitop3:0xa8
  v_cmp_ne_u32 s[30:31], 0, v168
  v_mfma_f32_32x32x16_bf16 v[32:47], a[156:159], v[88:91], v[32:47]
  s_cmp_lg_u64 s[30:31], 0
  v_mfma_f32_32x32x16_bf16 v[48:63], a[156:159], v[92:95], v[48:63]
  s_cbranch_scc1 L_slow_69
L_back_70:
  buffer_load_dwordx4 v[88:91], v181, s[12:15], s25 offen offset:2048 sc1
  buffer_load_dwordx4 v[92:95], v181, s[12:15], s25 offen offset:3072 sc1
  v_mfma_f32_32x32x16_bf16 v[0:15], a[160:163], v[96:99], v[0:15]
  s_waitcnt vmcnt(12)
  v_bitop3_b32 v168, v104, v108, v216 bitop3:0x7e
  v_bitop3_b32 v169, v105, v109, v217 bitop3:0x7e
  v_bitop3_b32 v170, v106, v110, v218 bitop3:0x7e
  v_bitop3_b32 v171, v107, v111, v219 bitop3:0x7e
  v_mfma_f32_32x32x16_bf16 v[16:31], a[160:163], v[100:103], v[16:31]
  v_or3_b32 v168, v168, v169, v170
  v_bitop3_b32 v168, v168, v171, s37 bitop3:0xa8
  v_cmp_ne_u32 s[30:31], 0, v168
  v_mfma_f32_32x32x16_bf16 v[32:47], a[164:167], v[96:99], v[32:47]
  s_cmp_lg_u64 s[30:31], 0
  v_mfma_f32_32x32x16_bf16 v[48:63], a[164:167], v[100:103], v[48:63]
  s_cbranch_scc1 L_slow_71
L_back_72:
  buffer_load_dwordx4 v[96:99], v181, s[12:15], s33 offen offset:0 sc1
  buffer_load_dwordx4 v[100:103], v181, s[12:15], s33 offen offset:1024 sc1
  v_mfma_f32_32x32x16_bf16 v[0:15], a[168:171], v[104:107], v[0:15]
  v_mfma_f32_32x32x16_bf16 v[16:31], a[168:171], v[108:111], v[16:31]
  v_mfma_f32_32x32x16_bf16 v[32:47], a[172:175], v[104:107], v[32:47]
  v_mfma_f32_32x32x16_bf16 v[48:63], a[172:175], v[108:111], v[48:63]
  buffer_load_dwordx4 v[104:107], v181, s[12:15], s33 offen offset:2048 sc1
  buffer_load_dwordx4 v[108:111], v181, s[12:15], s33 offen offset:3072 sc1
  s_waitcnt vmcnt(14)
  buffer_load_dwordx4 v[240:243], v236, s[4:7], 0 offen
  buffer_load_dwordx4 v[244:247], v236, s[4:7], 0 offen offset:16
  buffer_load_dwordx4 v[248:251], v237, s[12:15], 0 offen sc1
  v_mfma_f32_32x32x16_bf16 v[0:15], a[176:179], v[112:115], v[0:15]
  s_mov_b32 s61, s3
  s_cmp_eq_u32 s61, 3
  s_cselect_b32 s96, 53248, 0
  s_mul_i32 s61, s61, 12288
  s_add_u32 s61, s61, s96
  v_add_u32 v176, s61, v208
  v_mfma_f32_32x32x16_bf16 v[16:31], a[176:179], v[116:119], v[16:31]
  s_xor_b32 s61, s3, 1
  s_cmp_eq_u32 s61, 3
  s_cselect_b32 s96, 53248, 0
  s_mul_i32 s61, s61, 12288
  s_add_u32 s61, s61, s96
  v_add_u32 v177, s61, v208
  s_xor_b32 s61, s3, 2
  v_mfma_f32_32x32x16_bf16 v[32:47], a[180:183], v[112:115], v[32:47]
  s_cmp_eq_u32 s61, 3
  s_cselect_b32 s96, 53248, 0
  s_mul_i32 s61, s61, 12288
  s_add_u32 s61, s61, s96
  s_add_u32 s61, s61, 4096
  v_add_u32 v178, s61, v208
  v_mfma_f32_32x32x16_bf16 v[48:63], a[180:183], v[116:119], v[48:63]
  s_xor_b32 s61, s3, 3
  s_cmp_eq_u32 s61, 3
  s_cselect_b32 s96, 53248, 0
  s_mul_i32 s61, s61, 12288
  s_add_u32 s61, s61, s96
  s_add_u32 s61, s61, 8192
  v_add_u32 v179, s61, v208
  s_waitcnt vmcnt(15)
  v_lshlrev_b32 v224, 3, v209
  s_or_b32 s61, s2, s3
  v_add_u32 v224, 12288, v224
  s_cmp_eq_u32 s61, 0
  s_cbranch_scc0 L_noepl_73
  buffer_load_dwordx2 v[216:217], v224, s[12:15], 0 offen offset:0 sc1
  buffer_load_dwordx2 v[218:219], v224, s[12:15], 0 offen offset:512 sc1
  buffer_load_dwordx2 v[220:221], v224, s[12:15], 0 offen offset:1024 sc1
  buffer_load_dwordx2 v[222:223], v224, s[12:15], 0 offen offset:1536 sc1
L_noepl_73:
  v_mfma_f32_32x32x16_bf16 v[0:15], a[184:187], v[120:123], v[0:15]
  v_mfma_f32_32x32x16_bf16 v[16:31], a[184:187], v[124:127], v[16:31]
  v_mfma_f32_32x32x16_bf16 v[32:47], a[188:191], v[120:123], v[32:47]
  v_mfma_f32_32x32x16_bf16 v[48:63], a[188:191], v[124:127], v[48:63]
  s_waitcnt vmcnt(14)
  v_mfma_f32_32x32x16_bf16 v[16:31], a[192:195], v[64:67], v[16:31]
  v_mfma_f32_32x32x16_bf16 v[48:63], a[196:199], v[64:67], v[48:63]
  s_waitcnt vmcnt(13)
  v_mfma_f32_32x32x16_bf16 v[16:31], a[200:203], v[68:71], v[16:31]
  v_mfma_f32_32x32x16_bf16 v[48:63], a[204:207], v[68:71], v[48:63]
  s_waitcnt vmcnt(12)
  v_mfma_f32_32x32x16_bf16 v[16:31], a[208:211], v[72:75], v[16:31]
  v_mfma_f32_32x32x16_bf16 v[48:63], a[212:215], v[72:75], v[48:63]
  s_waitcnt vmcnt(11)
  v_mfma_f32_32x32x16_bf16 v[16:31], a[216:219], v[76:79], v[16:31]
  v_mfma_f32_32x32x16_bf16 v[48:63], a[220:223], v[76:79], v[48:63]
  s_waitcnt vmcnt(10)
  v_mfma_f32_32x32x16_bf16 v[16:31], a[224:227], v[80:83], v[16:31]
  v_mfma_f32_32x32x16_bf16 v[48:63], a[228:231], v[80:83], v[48:63]
  s_waitcnt vmcnt(9)
  v_mfma_f32_32x32x16_bf16 v[16:31], a[232:235], v[84:87], v[16:31]
  v_mfma_f32_32x32x16_bf16 v[48:63], a[236:239], v[84:87], v[48:63]
  s_nop 10
  ds_write_b128 v177, v[16:19] offset:0
  s_waitcnt vmcnt(8)
  v_mfma_f32_32x32x16_bf16 v[32:47], a[196:199], v[88:91], v[32:47]
  ds_write_b128 v177, v[20:23] offset:1024
  v_mfma_f32_32x32x16_bf16 v[0:15], a[192:195], v[88:91], v[0:15]
  s_waitcnt vmcnt(7)
  v_mfma_f32_32x32x16_bf16 v[32:47], a[204:207], v[92:95], v[32:47]
  ds_write_b128 v177, v[24:27] offset:2048
  v_mfma_f32_32x32x16_bf16 v[0:15], a[200:203], v[92:95], v[0:15]
  ds_write_b128 v177, v[28:31] offset:3072
  s_waitcnt vmcnt(6)
  v_mfma_f32_32x32x16_bf16 v[32:47], a[212:215], v[96:99], v[32:47]
  v_mfma_f32_32x32x16_bf16 v[0:15], a[208:211], v[96:99], v[0:15]
  ds_write_b128 v179, v[48:51] offset:0
  s_waitcnt vmcnt(5)
  v_mfma_f32_32x32x16_bf16 v[32:47], a[220:223], v[100:103], v[32:47]
  v_mfma_f32_32x32x16_bf16 v[0:15], a[216:219], v[100:103], v[0:15]
  ds_write_b128 v179, v[52:55] offset:1024
  s_waitcnt vmcnt(4)
  v_mfma_f32_32x32x16_bf16 v[32:47], a[228:231], v[104:107], v[32:47]
  ds_write_b128 v179, v[56:59] offset:2048
  v_mfma_f32_32x32x16_bf16 v[0:15], a[224:227], v[104:107], v[0:15]
  s_waitcnt vmcnt(3)
  v_mfma_f32_32x32x16_bf16 v[32:47], a[236:239], v[108:111], v[32:47]
  ds_write_b128 v179, v[60:63] offset:3072
  v_mfma_f32_32x32x16_bf16 v[0:15], a[232:235], v[108:111], v[0:15]
  s_nop 9
  ds_write_b128 v178, v[32:35] offset:0
  ds_write_b128 v178, v[36:39] offset:1024
  ds_write_b128 v178, v[40:43] offset:2048
  ds_write_b128 v178, v[44:47] offset:3072
  s_waitcnt vmcnt(1)
  v_lshlrev_b32 v160, 16, v240
  v_and_b32 v161, 0xffff0000, v240
  v_lshlrev_b32 v162, 16, v241
  v_and_b32 v163, 0xffff0000, v241
  v_lshlrev_b32 v164, 16, v242
  v_and_b32 v165, 0xffff0000, v242
  v_lshlrev_b32 v166, 16, v243
  v_and_b32 v167, 0xffff0000, v243
  v_lshlrev_b32 v168, 16, v244
  v_and_b32 v169, 0xffff0000, v244
  v_lshlrev_b32 v170, 16, v245
  v_and_b32 v171, 0xffff0000, v245
  v_lshlrev_b32 v172, 16, v246
  v_and_b32 v173, 0xffff0000, v246
  v_lshlrev_b32 v174, 16, v247
  v_and_b32 v175, 0xffff0000, v247
  s_waitcnt vmcnt(0)
  s_mov_b32 s58, 0
L_g2chk_74:
  v_cmp_eq_u32 vcc, s56, v251
  s_nop 0
  s_cmp_eq_u64 vcc, exec
  s_cbranch_scc1 L_g2ok_75
  s_add_u32 s58, s58, 1
  s_cmp_ge_u32 s58, 262144
  s_cbranch_scc1 L_g2ok_75
  buffer_load_dwordx4 v[248:251], v237, s[12:15], 0 offen sc1
  s_waitcnt vmcnt(0)
  s_branch L_g2chk_74
L_g2ok_75:
  v_pk_fma_f32 v[0:1], v[0:1], v[250:251], v[160:161] op_sel_hi:[1,0,1]
  v_pk_fma_f32 v[2:3], v[2:3], v[250:251], v[162:163] op_sel_hi:[1,0,1]
  v_pk_fma_f32 v[4:5], v[4:5], v[250:251], v[164:165] op_sel_hi:[1,0,1]
  v_pk_fma_f32 v[6:7], v[6:7], v[250:251], v[166:167] op_sel_hi:[1,0,1]
  v_pk_fma_f32 v[8:9], v[8:9], v[250:251], v[168:169] op_sel_hi:[1,0,1]
  v_pk_fma_f32 v[10:11], v[10:11], v[250:251], v[170:171] op_sel_hi:[1,0,1]
  v_pk_fma_f32 v[12:13], v[12:13], v[250:251], v[172:173] op_sel_hi:[1,0,1]
  v_pk_fma_f32 v[14:15], v[14:15], v[250:251], v[174:175] op_sel_hi:[1,0,1]
  s_waitcnt lgkmcnt(0)
  s_barrier
  ds_read_b128 v[128:131], v176 offset:0
  ds_read_b128 v[132:135], v176 offset:1024
  ds_read_b128 v[144:147], v176 offset:4096
  ds_read_b128 v[148:151], v176 offset:5120
  ds_read_b128 v[182:185], v176 offset:8192
  ds_read_b128 v[186:189], v176 offset:9216
  ds_read_b128 v[136:139], v176 offset:2048
  ds_read_b128 v[140:143], v176 offset:3072
  ds_read_b128 v[152:155], v176 offset:6144
  ds_read_b128 v[156:159], v176 offset:7168
  ds_read_b128 v[190:193], v176 offset:10240
  ds_read_b128 v[194:197], v176 offset:11264
  s_waitcnt lgkmcnt(10)
  v_pk_fma_f32 v[0:1], v[128:129], v[250:251], v[0:1] op_sel_hi:[1,0,1]
  v_pk_fma_f32 v[2:3], v[130:131], v[250:251], v[2:3] op_sel_hi:[1,0,1]
  v_pk_fma_f32 v[4:5], v[132:133], v[250:251], v[4:5] op_sel_hi:[1,0,1]
  v_pk_fma_f32 v[6:7], v[134:135], v[250:251], v[6:7] op_sel_hi:[1,0,1]
  s_waitcnt lgkmcnt(8)
  v_pk_fma_f32 v[0:1], v[144:145], v[250:251], v[0:1] op_sel_hi:[1,0,1]
  v_pk_fma_f32 v[2:3], v[146:147], v[250:251], v[2:3] op_sel_hi:[1,0,1]
  v_pk_fma_f32 v[4:5], v[148:149], v[250:251], v[4:5] op_sel_hi:[1,0,1]
  v_pk_fma_f32 v[6:7], v[150:151], v[250:251], v[6:7] op_sel_hi:[1,0,1]
  s_waitcnt lgkmcnt(6)
  v_pk_fma_f32 v[0:1], v[182:183], v[250:251], v[0:1] op_sel_hi:[1,0,1]
  v_pk_fma_f32 v[2:3], v[184:185], v[250:251], v[2:3] op_sel_hi:[1,0,1]
  v_pk_fma_f32 v[4:5], v[186:187], v[250:251], v[4:5] op_sel_hi:[1,0,1]
  v_pk_fma_f32 v[6:7], v[188:189], v[250:251], v[6:7] op_sel_hi:[1,0,1]
  v_cvt_pk_bf16_f32 v16, v0, v1
  v_cvt_pk_bf16_f32 v17, v2, v3
  v_cvt_pk_bf16_f32 v18, v4, v5
  v_cvt_pk_bf16_f32 v19, v6, v7
  buffer_store_dwordx4 v[16:19], v236, s[16:19], 0 offen
  s_waitcnt lgkmcnt(4)
  v_pk_fma_f32 v[8:9], v[136:137], v[250:251], v[8:9] op_sel_hi:[1,0,1]
  v_pk_fma_f32 v[10:11], v[138:139], v[250:251], v[10:11] op_sel_hi:[1,0,1]
  v_pk_fma_f32 v[12:13], v[140:141], v[250:251], v[12:13] op_sel_hi:[1,0,1]
  v_pk_fma_f32 v[14:15], v[142:143], v[250:251], v[14:15] op_sel_hi:[1,0,1]
  s_waitcnt lgkmcnt(2)
  v_pk_fma_f32 v[8:9], v[152:153], v[250:251], v[8:9] op_sel_hi:[1,0,1]
  v_pk_fma_f32 v[10:11], v[154:155], v[250:251], v[10:11] op_sel_hi:[1,0,1]
  v_pk_fma_f32 v[12:13], v[156:157], v[250:251], v[12:13] op_sel_hi:[1,0,1]
  v_pk_fma_f32 v[14:15], v[158:159], v[250:251], v[14:15] op_sel_hi:[1,0,1]
  s_waitcnt lgkmcnt(0)
  v_pk_fma_f32 v[8:9], v[190:191], v[250:251], v[8:9] op_sel_hi:[1,0,1]
  v_pk_fma_f32 v[10:11], v[192:193], v[250:251], v[10:11] op_sel_hi:[1,0,1]
  v_pk_fma_f32 v[12:13], v[194:195], v[250:251], v[12:13] op_sel_hi:[1,0,1]
  v_pk_fma_f32 v[14:15], v[196:197], v[250:251], v[14:15] op_sel_hi:[1,0,1]
  v_cvt_pk_bf16_f32 v20, v8, v9
  v_cvt_pk_bf16_f32 v21, v10, v11
  v_cvt_pk_bf16_f32 v22, v12, v13
  v_cvt_pk_bf16_f32 v23, v14, v15
  buffer_store_dwordx4 v[20:23], v236, s[16:19], 0 offen offset:16
  s_or_b32 s61, s2, s3
  s_cmp_eq_u32 s61, 0
  s_cbranch_scc1 L_epoch
L_fin:
L_end:
  s_endpgm
L_epoch:
  s_mov_b32 s58, 0
  s_waitcnt vmcnt(2)
L_echk_77:
  s_mov_b64 s[30:31], exec
  v_cmp_eq_u32 vcc, s56, v216
  v_cmp_eq_u32 s[62:63], s57, v217
  s_and_b64 s[30:31], s[30:31], vcc
  s_and_b64 s[30:31], s[30:31], s[62:63]
  v_cmp_eq_u32 vcc, s56, v218
  v_cmp_eq_u32 s[62:63], s57, v219
  s_and_b64 s[30:31], s[30:31], vcc
  s_and_b64 s[30:31], s[30:31], s[62:63]
  v_cmp_eq_u32 vcc, s56, v220
  v_cmp_eq_u32 s[62:63], s57, v221
  s_and_b64 s[30:31], s[30:31], vcc
  s_and_b64 s[30:31], s[30:31], s[62:63]
  v_cmp_eq_u32 vcc, s56, v222
  v_cmp_eq_u32 s[62:63], s57, v223
  s_and_b64 s[30:31], s[30:31], vcc
  s_and_b64 s[30:31], s[30:31], s[62:63]
  s_cmp_eq_u64 s[30:31], exec
  s_cbranch_scc1 L_eok_78
  s_add_u32 s58, s58, 1
  s_cmp_ge_u32 s58, 262144
  s_cbranch_scc1 L_eok_78
  buffer_load_dwordx2 v[216:217], v224, s[12:15], 0 offen offset:0 sc1
  buffer_load_dwordx2 v[218:219], v224, s[12:15], 0 offen offset:512 sc1
  buffer_load_dwordx2 v[220:221], v224, s[12:15], 0 offen offset:1024 sc1
  buffer_load_dwordx2 v[222:223], v224, s[12:15], 0 offen offset:1536 sc1
  s_waitcnt vmcnt(0)
  s_branch L_echk_77
L_eok_78:
  v_mov_b32 v33, 0
  v_mov_b32 v252, 2147483392
  v_cmp_gt_u32 vcc, 1, v209
  s_nop 1
  v_cndmask_b32 v33, v252, v33, vcc
  v_mov_b32 v34, s56
  buffer_store_dword v34, v33, s[12:15], 0 offen sc1
  s_branch L_fin
L_slow_27:
  s_add_u32 s58, s58, 1
  s_cmp_ge_u32 s58, 262144
  s_cbranch_scc1 L_refresh_79
  buffer_load_dwordx4 v[64:67], v181, s[12:15], s24 offen offset:0 sc1
  buffer_load_dwordx4 v[68:71], v239, s[12:15], s24 offen offset:0 sc1
  s_waitcnt vmcnt(0)
  v_bitop3_b32 v168, v64, v68, v216 bitop3:0x7e
  v_bitop3_b32 v169, v65, v69, v217 bitop3:0x7e
  v_bitop3_b32 v170, v66, v70, v218 bitop3:0x7e
  v_bitop3_b32 v171, v67, v71, v219 bitop3:0x7e
  v_or3_b32 v168, v168, v169, v170
  v_bitop3_b32 v168, v168, v171, s37 bitop3:0xa8
  v_cmp_ne_u32 s[30:31], 0, v168
  s_nop 0
  s_cmp_lg_u64 s[30:31], 0
  s_cbranch_scc1 L_slow_27
L_refresh_79:
  buffer_load_dwordx4 v[72:75], v181, s[12:15], s24 offen offset:1024 sc1
  buffer_load_dwordx4 v[76:79], v239, s[12:15], s24 offen offset:1024 sc1
  buffer_load_dwordx4 v[80:83], v181, s[12:15], s24 offen offset:2048 sc1
  buffer_load_dwordx4 v[84:87], v239, s[12:15], s24 offen offset:2048 sc1
  buffer_load_dwordx4 v[88:91], v181, s[12:15], s24 offen offset:3072 sc1
  buffer_load_dwordx4 v[92:95], v239, s[12:15], s24 offen offset:3072 sc1
  buffer_load_dwordx4 v[96:99], v181, s[12:15], s38 offen offset:0 sc1
  buffer_load_dwordx4 v[100:103], v239, s[12:15], s38 offen offset:0 sc1
  buffer_load_dwordx4 v[104:107], v181, s[12:15], s38 offen offset:1024 sc1
  buffer_load_dwordx4 v[108:111], v239, s[12:15], s38 offen offset:1024 sc1
  buffer_load_dwordx4 v[112:115], v181, s[12:15], s38 offen offset:2048 sc1
  buffer_load_dwordx4 v[116:119], v239, s[12:15], s38 offen offset:2048 sc1
  buffer_load_dwordx4 v[120:123], v181, s[12:15], s38 offen offset:3072 sc1
  buffer_load_dwordx4 v[124:127], v239, s[12:15], s38 offen offset:3072 sc1
  s_branch L_back_28
L_slow_29:
  s_add_u32 s58, s58, 1
  s_cmp_ge_u32 s58, 262144
  s_cbranch_scc1 L_refresh_80
  buffer_load_dwordx4 v[72:75], v181, s[12:15], s24 offen offset:1024 sc1
  buffer_load_dwordx4 v[76:79], v239, s[12:15], s24 offen offset:1024 sc1
  s_waitcnt vmcnt(0)
  v_bitop3_b32 v168, v72, v76, v216 bitop3:0x7e
  v_bitop3_b32 v169, v73, v77, v217 bitop3:0x7e
  v_bitop3_b32 v170, v74, v78, v218 bitop3:0x7e
  v_bitop3_b32 v171, v75, v79, v219 bitop3:0x7e
  v_or3_b32 v168, v168, v169, v170
  v_bitop3_b32 v168, v168, v171, s37 bitop3:0xa8
  v_cmp_ne_u32 s[30:31], 0, v168
  s_nop 0
  s_cmp_lg_u64 s[30:31], 0
  s_cbranch_scc1 L_slow_29
L_refresh_80:
  buffer_load_dwordx4 v[80:83], v181, s[12:15], s24 offen offset:2048 sc1
  buffer_load_dwordx4 v[84:87], v239, s[12:15], s24 offen offset:2048 sc1
  buffer_load_dwordx4 v[88:91], v181, s[12:15], s24 offen offset:3072 sc1
  buffer_load_dwordx4 v[92:95], v239, s[12:15], s24 offen offset:3072 sc1
  buffer_load_dwordx4 v[96:99], v181, s[12:15], s38 offen offset:0 sc1
  buffer_load_dwordx4 v[100:103], v239, s[12:15], s38 offen offset:0 sc1
  buffer_load_dwordx4 v[104:107], v181, s[12:15], s38 offen offset:1024 sc1
  buffer_load_dwordx4 v[108:111], v239, s[12:15], s38 offen offset:1024 sc1
  buffer_load_dwordx4 v[112:115], v181, s[12:15], s38 offen offset:2048 sc1
  buffer_load_dwordx4 v[116:119], v239, s[12:15], s38 offen offset:2048 sc1
  buffer_load_dwordx4 v[120:123], v181, s[12:15], s38 offen offset:3072 sc1
  buffer_load_dwordx4 v[124:127], v239, s[12:15], s38 offen offset:3072 sc1
  s_branch L_back_30
L_slow_31:
  s_add_u32 s58, s58, 1
  s_cmp_ge_u32 s58, 262144
  s_cbranch_scc1 L_refresh_81
  buffer_load_dwordx4 v[80:83], v181, s[12:15], s24 offen offset:2048 sc1
  buffer_load_dwordx4 v[84:87], v239, s[12:15], s24 offen offset:2048 sc1
  s_waitcnt vmcnt(0)
  v_bitop3_b32 v168, v80, v84, v216 bitop3:0x7e
  v_bitop3_b32 v169, v81, v85, v217 bitop3:0x7e
  v_bitop3_b32 v170, v82, v86, v218 bitop3:0x7e
  v_bitop3_b32 v171, v83, v87, v219 bitop3:0x7e
  v_or3_b32 v168, v168, v169, v170
  v_bitop3_b32 v168, v168, v171, s37 bitop3:0xa8
  v_cmp_ne_u32 s[30:31], 0, v168
  s_nop 0
  s_cmp_lg_u64 s[30:31], 0
  s_cbranch_scc1 L_slow_31
L_refresh_81:
  buffer_load_dwordx4 v[88:91], v181, s[12:15], s24 offen offset:3072 sc1
  buffer_load_dwordx4 v[92:95], v239, s[12:15], s24 offen offset:3072 sc1
  buffer_load_dwordx4 v[96:99], v181, s[12:15], s38 offen offset:0 sc1
  buffer_load_dwordx4 v[100:103], v239, s[12:15], s38 offen offset:0 sc1
  buffer_load_dwordx4 v[104:107], v181, s[12:15], s38 offen offset:1024 sc1
  buffer_load_dwordx4 v[108:111], v239, s[12:15], s38 offen offset:1024 sc1
  buffer_load_dwordx4 v[112:115], v181, s[12:15], s38 offen offset:2048 sc1
  buffer_load_dwordx4 v[116:119], v239, s[12:15], s38 offen offset:2048 sc1
  buffer_load_dwordx4 v[120:123], v181, s[12:15], s38 offen offset:3072 sc1
  buffer_load_dwordx4 v[124:127], v239, s[12:15], s38 offen offset:3072 sc1
  buffer_load_dwordx4 v[64:67], v181, s[12:15], s39 offen offset:0 sc1
  buffer_load_dwordx4 v[68:71], v239, s[12:15], s39 offen offset:0 sc1
  s_branch L_back_32
L_slow_33:
  s_add_u32 s58, s58, 1
  s_cmp_ge_u32 s58, 262144
  s_cbranch_scc1 L_refresh_82
  buffer_load_dwordx4 v[88:91], v181, s[12:15], s24 offen offset:3072 sc1
  buffer_load_dwordx4 v[92:95], v239, s[12:15], s24 offen offset:3072 sc1
  s_waitcnt vmcnt(0)
  v_bitop3_b32 v168, v88, v92, v216 bitop3:0x7e
  v_bitop3_b32 v169, v89, v93, v217 bitop3:0x7e
  v_bitop3_b32 v170, v90, v94, v218 bitop3:0x7e
  v_bitop3_b32 v171, v91, v95, v219 bitop3:0x7e
  v_or3_b32 v168, v168, v169, v170
  v_bitop3_b32 v168, v168, v171, s37 bitop3:0xa8
  v_cmp_ne_u32 s[30:31], 0, v168
  s_nop 0
  s_cmp_lg_u64 s[30:31], 0
  s_cbranch_scc1 L_slow_33
L_refresh_82:
  buffer_load_dwordx4 v[96:99], v181, s[12:15], s38 offen offset:0 sc1
  buffer_load_dwordx4 v[100:103], v239, s[12:15], s38 offen offset:0 sc1
  buffer_load_dwordx4 v[104:107], v181, s[12:15], s38 offen offset:1024 sc1
  buffer_load_dwordx4 v[108:111], v239, s[12:15], s38 offen offset:1024 sc1
  buffer_load_dwordx4 v[112:115], v181, s[12:15], s38 offen offset:2048 sc1
  buffer_load_dwordx4 v[116:119], v239, s[12:15], s38 offen offset:2048 sc1
  buffer_load_dwordx4 v[120:123], v181, s[12:15], s38 offen offset:3072 sc1
  buffer_load_dwordx4 v[124:127], v239, s[12:15], s38 offen offset:3072 sc1
  buffer_load_dwordx4 v[64:67], v181, s[12:15], s39 offen offset:0 sc1
  buffer_load_dwordx4 v[68:71], v239, s[12:15], s39 offen offset:0 sc1
  buffer_load_dwordx4 v[72:75], v181, s[12:15], s39 offen offset:1024 sc1
  buffer_load_dwordx4 v[76:79], v239, s[12:15], s39 offen offset:1024 sc1
  s_branch L_back_34
L_slow_35:
  s_add_u32 s58, s58, 1
  s_cmp_ge_u32 s58, 262144
  s_cbranch_scc1 L_refresh_83
  buffer_load_dwordx4 v[96:99], v181, s[12:15], s38 offen offset:0 sc1
  buffer_load_dwordx4 v[100:103], v239, s[12:15], s38 offen offset:0 sc1
  s_waitcnt vmcnt(0)
  v_bitop3_b32 v168, v96, v100, v216 bitop3:0x7e
  v_bitop3_b32 v169, v97, v101, v217 bitop3:0x7e
  v_bitop3_b32 v170, v98, v102, v218 bitop3:0x7e
  v_bitop3_b32 v171, v99, v103, v219 bitop3:0x7e
  v_or3_b32 v168, v168, v169, v170
  v_bitop3_b32 v168, v168, v171, s37 bitop3:0xa8
  v_cmp_ne_u32 s[30:31], 0, v168
  s_nop 0
  s_cmp_lg_u64 s[30:31], 0
  s_cbranch_scc1 L_slow_35
L_refresh_83:
  buffer_load_dwordx4 v[104:107], v181, s[12:15], s38 offen offset:1024 sc1
  buffer_load_dwordx4 v[108:111], v239, s[12:15], s38 offen offset:1024 sc1
  buffer_load_dwordx4 v[112:115], v181, s[12:15], s38 offen offset:2048 sc1
  buffer_load_dwordx4 v[116:119], v239, s[12:15], s38 offen offset:2048 sc1
  buffer_load_dwordx4 v[120:123], v181, s[12:15], s38 offen offset:3072 sc1
  buffer_load_dwordx4 v[124:127], v239, s[12:15], s38 offen offset:3072 sc1
  buffer_load_dwordx4 v[64:67], v181, s[12:15], s39 offen offset:0 sc1
  buffer_load_dwordx4 v[68:71], v239, s[12:15], s39 offen offset:0 sc1
  buffer_load_dwordx4 v[72:75], v181, s[12:15], s39 offen offset:1024 sc1
  buffer_load_dwordx4 v[76:79], v239, s[12:15], s39 offen offset:1024 sc1
  buffer_load_dwordx4 v[80:83], v181, s[12:15], s39 offen offset:2048 sc1
  buffer_load_dwordx4 v[84:87], v239, s[12:15], s39 offen offset:2048 sc1
  s_branch L_back_36
L_slow_37:
  s_add_u32 s58, s58, 1
  s_cmp_ge_u32 s58, 262144
  s_cbranch_scc1 L_refresh_84
  buffer_load_dwordx4 v[104:107], v181, s[12:15], s38 offen offset:1024 sc1
  buffer_load_dwordx4 v[108:111], v239, s[12:15], s38 offen offset:1024 sc1
  s_waitcnt vmcnt(0)
  v_bitop3_b32 v168, v104, v108, v216 bitop3:0x7e
  v_bitop3_b32 v169, v105, v109, v217 bitop3:0x7e
  v_bitop3_b32 v170, v106, v110, v218 bitop3:0x7e
  v_bitop3_b32 v171, v107, v111, v219 bitop3:0x7e
  v_or3_b32 v168, v168, v169, v170
  v_bitop3_b32 v168, v168, v171, s37 bitop3:0xa8
  v_cmp_ne_u32 s[30:31], 0, v168
  s_nop 0
  s_cmp_lg_u64 s[30:31], 0
  s_cbranch_scc1 L_slow_37
L_refresh_84:
  buffer_load_dwordx4 v[112:115], v181, s[12:15], s38 offen offset:2048 sc1
  buffer_load_dwordx4 v[116:119], v239, s[12:15], s38 offen offset:2048 sc1
  buffer_load_dwordx4 v[120:123], v181, s[12:15], s38 offen offset:3072 sc1
  buffer_load_dwordx4 v[124:127], v239, s[12:15], s38 offen offset:3072 sc1
  buffer_load_dwordx4 v[64:67], v181, s[12:15], s39 offen offset:0 sc1
  buffer_load_dwordx4 v[68:71], v239, s[12:15], s39 offen offset:0 sc1
  buffer_load_dwordx4 v[72:75], v181, s[12:15], s39 offen offset:1024 sc1
  buffer_load_dwordx4 v[76:79], v239, s[12:15], s39 offen offset:1024 sc1
  buffer_load_dwordx4 v[80:83], v181, s[12:15], s39 offen offset:2048 sc1
  buffer_load_dwordx4 v[84:87], v239, s[12:15], s39 offen offset:2048 sc1
  buffer_load_dwordx4 v[88:91], v181, s[12:15], s39 offen offset:3072 sc1
  buffer_load_dwordx4 v[92:95], v239, s[12:15], s39 offen offset:3072 sc1
  s_branch L_back_38
L_slow_39:
  s_add_u32 s58, s58, 1
  s_cmp_ge_u32 s58, 262144
  s_cbranch_scc1 L_refresh_85
  buffer_load_dwordx4 v[112:115], v181, s[12:15], s38 offen offset:2048 sc1
  buffer_load_dwordx4 v[116:119], v239, s[12:15], s38 offen offset:2048 sc1
  s_waitcnt vmcnt(0)
  v_bitop3_b32 v168, v112, v116, v216 bitop3:0x7e
  v_bitop3_b32 v169, v113, v117, v217 bitop3:0x7e
  v_bitop3_b32 v170, v114, v118, v218 bitop3:0x7e
  v_bitop3_b32 v171, v115, v119, v219 bitop3:0x7e
  v_or3_b32 v168, v168, v169, v170
  v_bitop3_b32 v168, v168, v171, s37 bitop3:0xa8
  v_cmp_ne_u32 s[30:31], 0, v168
  s_nop 0
  s_cmp_lg_u64 s[30:31], 0
  s_cbranch_scc1 L_slow_39
L_refresh_85:
  buffer_load_dwordx4 v[120:123], v181, s[12:15], s38 offen offset:3072 sc1
  buffer_load_dwordx4 v[124:127], v239, s[12:15], s38 offen offset:3072 sc1
  buffer_load_dwordx4 v[64:67], v181, s[12:15], s39 offen offset:0 sc1
  buffer_load_dwordx4 v[68:71], v239, s[12:15], s39 offen offset:0 sc1
  buffer_load_dwordx4 v[72:75], v181, s[12:15], s39 offen offset:1024 sc1
  buffer_load_dwordx4 v[76:79], v239, s[12:15], s39 offen offset:1024 sc1
  buffer_load_dwordx4 v[80:83], v181, s[12:15], s39 offen offset:2048 sc1
  buffer_load_dwordx4 v[84:87], v239, s[12:15], s39 offen offset:2048 sc1
  buffer_load_dwordx4 v[88:91], v181, s[12:15], s39 offen offset:3072 sc1
  buffer_load_dwordx4 v[92:95], v239, s[12:15], s39 offen offset:3072 sc1
  buffer_load_dwordx4 v[96:99], v181, s[12:15], s1 offen offset:0 sc1
  buffer_load_dwordx4 v[100:103], v239, s[12:15], s1 offen offset:0 sc1
  s_branch L_back_40
L_slow_41:
  s_add_u32 s58, s58, 1
  s_cmp_ge_u32 s58, 262144
  s_cbranch_scc1 L_refresh_86
  buffer_load_dwordx4 v[120:123], v181, s[12:15], s38 offen offset:3072 sc1
  buffer_load_dwordx4 v[124:127], v239, s[12:15], s38 offen offset:3072 sc1
  s_waitcnt vmcnt(0)
  v_bitop3_b32 v168, v120, v124, v216 bitop3:0x7e
  v_bitop3_b32 v169, v121, v125, v217 bitop3:0x7e
  v_bitop3_b32 v170, v122, v126, v218 bitop3:0x7e
  v_bitop3_b32 v171, v123, v127, v219 bitop3:0x7e
  v_or3_b32 v168, v168, v169, v170
  v_bitop3_b32 v168, v168, v171, s37 bitop3:0xa8
  v_cmp_ne_u32 s[30:31], 0, v168
  s_nop 0
  s_cmp_lg_u64 s[30:31], 0
  s_cbranch_scc1 L_slow_41
L_refresh_86:
  buffer_load_dwordx4 v[64:67], v181, s[12:15], s39 offen offset:0 sc1
  buffer_load_dwordx4 v[68:71], v239, s[12:15], s39 offen offset:0 sc1
  buffer_load_dwordx4 v[72:75], v181, s[12:15], s39 offen offset:1024 sc1
  buffer_load_dwordx4 v[76:79], v239, s[12:15], s39 offen offset:1024 sc1
  buffer_load_dwordx4 v[80:83], v181, s[12:15], s39 offen offset:2048 sc1
  buffer_load_dwordx4 v[84:87], v239, s[12:15], s39 offen offset:2048 sc1
  buffer_load_dwordx4 v[88:91], v181, s[12:15], s39 offen offset:3072 sc1
  buffer_load_dwordx4 v[92:95], v239, s[12:15], s39 offen offset:3072 sc1
  buffer_load_dwordx4 v[96:99], v181, s[12:15], s1 offen offset:0 sc1
  buffer_load_dwordx4 v[100:103], v239, s[12:15], s1 offen offset:0 sc1
  buffer_load_dwordx4 v[104:107], v181, s[12:15], s1 offen offset:1024 sc1
  buffer_load_dwordx4 v[108:111], v239, s[12:15], s1 offen offset:1024 sc1
  s_branch L_back_42
L_slow_43:
  s_add_u32 s58, s58, 1
  s_cmp_ge_u32 s58, 262144
  s_cbranch_scc1 L_refresh_87
  buffer_load_dwordx4 v[64:67], v181, s[12:15], s39 offen offset:0 sc1
  buffer_load_dwordx4 v[68:71], v239, s[12:15], s39 offen offset:0 sc1
  s_waitcnt vmcnt(0)
  v_bitop3_b32 v168, v64, v68, v216 bitop3:0x7e
  v_bitop3_b32 v169, v65, v69, v217 bitop3:0x7e
  v_bitop3_b32 v170, v66, v70, v218 bitop3:0x7e
  v_bitop3_b32 v171, v67, v71, v219 bitop3:0x7e
  v_or3_b32 v168, v168, v169, v170
  v_bitop3_b32 v168, v168, v171, s37 bitop3:0xa8
  v_cmp_ne_u32 s[30:31], 0, v168
  s_nop 0
  s_cmp_lg_u64 s[30:31], 0
  s_cbranch_scc1 L_slow_43
L_refresh_87:
  buffer_load_dwordx4 v[72:75], v181, s[12:15], s39 offen offset:1024 sc1
  buffer_load_dwordx4 v[76:79], v239, s[12:15], s39 offen offset:1024 sc1
  buffer_load_dwordx4 v[80:83], v181, s[12:15], s39 offen offset:2048 sc1
  buffer_load_dwordx4 v[84:87], v239, s[12:15], s39 offen offset:2048 sc1
  buffer_load_dwordx4 v[88:91], v181, s[12:15], s39 offen offset:3072 sc1
  buffer_load_dwordx4 v[92:95], v239, s[12:15], s39 offen offset:3072 sc1
  buffer_load_dwordx4 v[96:99], v181, s[12:15], s1 offen offset:0 sc1
  buffer_load_dwordx4 v[100:103], v239, s[12:15], s1 offen offset:0 sc1
  buffer_load_dwordx4 v[104:107], v181, s[12:15], s1 offen offset:1024 sc1
  buffer_load_dwordx4 v[108:111], v239, s[12:15], s1 offen offset:1024 sc1
  buffer_load_dwordx4 v[112:115], v181, s[12:15], s1 offen offset:2048 sc1
  buffer_load_dwordx4 v[116:119], v239, s[12:15], s1 offen offset:2048 sc1
  s_branch L_back_44
L_slow_45:
  s_add_u32 s58, s58, 1
  s_cmp_ge_u32 s58, 262144
  s_cbranch_scc1 L_refresh_88
  buffer_load_dwordx4 v[72:75], v181, s[12:15], s39 offen offset:1024 sc1
  buffer_load_dwordx4 v[76:79], v239, s[12:15], s39 offen offset:1024 sc1
  s_waitcnt vmcnt(0)
  v_bitop3_b32 v168, v72, v76, v216 bitop3:0x7e
  v_bitop3_b32 v169, v73, v77, v217 bitop3:0x7e
  v_bitop3_b32 v170, v74, v78, v218 bitop3:0x7e
  v_bitop3_b32 v171, v75, v79, v219 bitop3:0x7e
  v_or3_b32 v168, v168, v169, v170
  v_bitop3_b32 v168, v168, v171, s37 bitop3:0xa8
  v_cmp_ne_u32 s[30:31], 0, v168
  s_nop 0
  s_cmp_lg_u64 s[30:31], 0
  s_cbranch_scc1 L_slow_45
L_refresh_88:
  buffer_load_dwordx4 v[80:83], v181, s[12:15], s39 offen offset:2048 sc1
  buffer_load_dwordx4 v[84:87], v239, s[12:15], s39 offen offset:2048 sc1
  buffer_load_dwordx4 v[88:91], v181, s[12:15], s39 offen offset:3072 sc1
  buffer_load_dwordx4 v[92:95], v239, s[12:15], s39 offen offset:3072 sc1
  buffer_load_dwordx4 v[96:99], v181, s[12:15], s1 offen offset:0 sc1
  buffer_load_dwordx4 v[100:103], v239, s[12:15], s1 offen offset:0 sc1
  buffer_load_dwordx4 v[104:107], v181, s[12:15], s1 offen offset:1024 sc1
  buffer_load_dwordx4 v[108:111], v239, s[12:15], s1 offen offset:1024 sc1
  buffer_load_dwordx4 v[112:115], v181, s[12:15], s1 offen offset:2048 sc1
  buffer_load_dwordx4 v[116:119], v239, s[12:15], s1 offen offset:2048 sc1
  buffer_load_dwordx4 v[120:123], v181, s[12:15], s1 offen offset:3072 sc1
  buffer_load_dwordx4 v[124:127], v239, s[12:15], s1 offen offset:3072 sc1
  buffer_load_dwordx2 v[254:255], v235, s[12:15], 0 offen sc1
  s_branch L_back_46
L_slow_47:
  s_add_u32 s58, s58, 1
  s_cmp_ge_u32 s58, 262144
  s_cbranch_scc1 L_refresh_89
  buffer_load_dwordx4 v[80:83], v181, s[12:15], s39 offen offset:2048 sc1
  buffer_load_dwordx4 v[84:87], v239, s[12:15], s39 offen offset:2048 sc1
  s_waitcnt vmcnt(0)
  v_bitop3_b32 v168, v80, v84, v216 bitop3:0x7e
  v_bitop3_b32 v169, v81, v85, v217 bitop3:0x7e
  v_bitop3_b32 v170, v82, v86, v218 bitop3:0x7e
  v_bitop3_b32 v171, v83, v87, v219 bitop3:0x7e
  v_or3_b32 v168, v168, v169, v170
  v_bitop3_b32 v168, v168, v171, s37 bitop3:0xa8
  v_cmp_ne_u32 s[30:31], 0, v168
  s_nop 0
  s_cmp_lg_u64 s[30:31], 0
  s_cbranch_scc1 L_slow_47
L_refresh_89:
  buffer_load_dwordx4 v[88:91], v181, s[12:15], s39 offen offset:3072 sc1
  buffer_load_dwordx4 v[92:95], v239, s[12:15], s39 offen offset:3072 sc1
  buffer_load_dwordx4 v[96:99], v181, s[12:15], s1 offen offset:0 sc1
  buffer_load_dwordx4 v[100:103], v239, s[12:15], s1 offen offset:0 sc1
  buffer_load_dwordx4 v[104:107], v181, s[12:15], s1 offen offset:1024 sc1
  buffer_load_dwordx4 v[108:111], v239, s[12:15], s1 offen offset:1024 sc1
  buffer_load_dwordx4 v[112:115], v181, s[12:15], s1 offen offset:2048 sc1
  buffer_load_dwordx4 v[116:119], v239, s[12:15], s1 offen offset:2048 sc1
  buffer_load_dwordx4 v[120:123], v181, s[12:15], s1 offen offset:3072 sc1
  buffer_load_dwordx4 v[124:127], v239, s[12:15], s1 offen offset:3072 sc1
  buffer_load_dwordx2 v[254:255], v235, s[12:15], 0 offen sc1
  buffer_load_dwordx4 v[64:67], v181, s[12:15], s0 offen offset:0 sc1
  buffer_load_dwordx4 v[68:71], v239, s[12:15], s0 offen offset:0 sc1
  s_branch L_back_48
L_slow_49:
  s_add_u32 s58, s58, 1
  s_cmp_ge_u32 s58, 262144
  s_cbranch_scc1 L_refresh_90
  buffer_load_dwordx4 v[88:91], v181, s[12:15], s39 offen offset:3072 sc1
  buffer_load_dwordx4 v[92:95], v239, s[12:15], s39 offen offset:3072 sc1
  s_waitcnt vmcnt(0)
  v_bitop3_b32 v168, v88, v92, v216 bitop3:0x7e
  v_bitop3_b32 v169, v89, v93, v217 bitop3:0x7e
  v_bitop3_b32 v170, v90, v94, v218 bitop3:0x7e
  v_bitop3_b32 v171, v91, v95, v219 bitop3:0x7e
  v_or3_b32 v168, v168, v169, v170
  v_bitop3_b32 v168, v168, v171, s37 bitop3:0xa8
  v_cmp_ne_u32 s[30:31], 0, v168
  s_nop 0
  s_cmp_lg_u64 s[30:31], 0
  s_cbranch_scc1 L_slow_49
L_refresh_90:
  buffer_load_dwordx4 v[96:99], v181, s[12:15], s1 offen offset:0 sc1
  buffer_load_dwordx4 v[100:103], v239, s[12:15], s1 offen offset:0 sc1
  buffer_load_dwordx4 v[104:107], v181, s[12:15], s1 offen offset:1024 sc1
  buffer_load_dwordx4 v[108:111], v239, s[12:15], s1 offen offset:1024 sc1
  buffer_load_dwordx4 v[112:115], v181, s[12:15], s1 offen offset:2048 sc1
  buffer_load_dwordx4 v[116:119], v239, s[12:15], s1 offen offset:2048 sc1
  buffer_load_dwordx4 v[120:123], v181, s[12:15], s1 offen offset:3072 sc1
  buffer_load_dwordx4 v[124:127], v239, s[12:15], s1 offen offset:3072 sc1
  buffer_load_dwordx2 v[254:255], v235, s[12:15], 0 offen sc1
  buffer_load_dwordx4 v[64:67], v181, s[12:15], s0 offen offset:0 sc1
  buffer_load_dwordx4 v[68:71], v239, s[12:15], s0 offen offset:0 sc1
  buffer_load_dwordx4 v[72:75], v181, s[12:15], s0 offen offset:1024 sc1
  buffer_load_dwordx4 v[76:79], v239, s[12:15], s0 offen offset:1024 sc1
  s_branch L_back_50
L_slow_51:
  s_add_u32 s58, s58, 1
  s_cmp_ge_u32 s58, 262144
  s_cbranch_scc1 L_refresh_91
  buffer_load_dwordx4 v[96:99], v181, s[12:15], s1 offen offset:0 sc1
  buffer_load_dwordx4 v[100:103], v239, s[12:15], s1 offen offset:0 sc1
  s_waitcnt vmcnt(0)
  v_bitop3_b32 v168, v96, v100, v216 bitop3:0x7e
  v_bitop3_b32 v169, v97, v101, v217 bitop3:0x7e
  v_bitop3_b32 v170, v98, v102, v218 bitop3:0x7e
  v_bitop3_b32 v171, v99, v103, v219 bitop3:0x7e
  v_or3_b32 v168, v168, v169, v170
  v_bitop3_b32 v168, v168, v171, s37 bitop3:0xa8
  v_cmp_ne_u32 s[30:31], 0, v168
  s_nop 0
  s_cmp_lg_u64 s[30:31], 0
  s_cbranch_scc1 L_slow_51
L_refresh_91:
  buffer_load_dwordx4 v[104:107], v181, s[12:15], s1 offen offset:1024 sc1
  buffer_load_dwordx4 v[108:111], v239, s[12:15], s1 offen offset:1024 sc1
  buffer_load_dwordx4 v[112:115], v181, s[12:15], s1 offen offset:2048 sc1
  buffer_load_dwordx4 v[116:119], v239, s[12:15], s1 offen offset:2048 sc1
  buffer_load_dwordx4 v[120:123], v181, s[12:15], s1 offen offset:3072 sc1
  buffer_load_dwordx4 v[124:127], v239, s[12:15], s1 offen offset:3072 sc1
  buffer_load_dwordx2 v[254:255], v235, s[12:15], 0 offen sc1
  buffer_load_dwordx4 v[64:67], v181, s[12:15], s0 offen offset:0 sc1
  buffer_load_dwordx4 v[68:71], v239, s[12:15], s0 offen offset:0 sc1
  buffer_load_dwordx4 v[72:75], v181, s[12:15], s0 offen offset:1024 sc1
  buffer_load_dwordx4 v[76:79], v239, s[12:15], s0 offen offset:1024 sc1
  buffer_load_dwordx4 v[80:83], v181, s[12:15], s28 offen offset:0 sc1
  buffer_load_dwordx4 v[84:87], v239, s[12:15], s28 offen offset:0 sc1
  s_branch L_back_52
L_slow_53:
  s_add_u32 s58, s58, 1
  s_cmp_ge_u32 s58, 262144
  s_cbranch_scc1 L_refresh_92
  buffer_load_dwordx4 v[104:107], v181, s[12:15], s1 offen offset:1024 sc1
  buffer_load_dwordx4 v[108:111], v239, s[12:15], s1 offen offset:1024 sc1
  s_waitcnt vmcnt(0)
  v_bitop3_b32 v168, v104, v108, v216 bitop3:0x7e
  v_bitop3_b32 v169, v105, v109, v217 bitop3:0x7e
  v_bitop3_b32 v170, v106, v110, v218 bitop3:0x7e
  v_bitop3_b32 v171, v107, v111, v219 bitop3:0x7e
  v_or3_b32 v168, v168, v169, v170
  v_bitop3_b32 v168, v168, v171, s37 bitop3:0xa8
  v_cmp_ne_u32 s[30:31], 0, v168
  s_nop 0
  s_cmp_lg_u64 s[30:31], 0
  s_cbranch_scc1 L_slow_53
L_refresh_92:
  buffer_load_dwordx4 v[112:115], v181, s[12:15], s1 offen offset:2048 sc1
  buffer_load_dwordx4 v[116:119], v239, s[12:15], s1 offen offset:2048 sc1
  buffer_load_dwordx4 v[120:123], v181, s[12:15], s1 offen offset:3072 sc1
  buffer_load_dwordx4 v[124:127], v239, s[12:15], s1 offen offset:3072 sc1
  buffer_load_dwordx2 v[254:255], v235, s[12:15], 0 offen sc1
  buffer_load_dwordx4 v[64:67], v181, s[12:15], s0 offen offset:0 sc1
  buffer_load_dwordx4 v[68:71], v239, s[12:15], s0 offen offset:0 sc1
  buffer_load_dwordx4 v[72:75], v181, s[12:15], s0 offen offset:1024 sc1
  buffer_load_dwordx4 v[76:79], v239, s[12:15], s0 offen offset:1024 sc1
  buffer_load_dwordx4 v[80:83], v181, s[12:15], s28 offen offset:0 sc1
  buffer_load_dwordx4 v[84:87], v239, s[12:15], s28 offen offset:0 sc1
  buffer_load_dwordx4 v[88:91], v181, s[12:15], s28 offen offset:1024 sc1
  buffer_load_dwordx4 v[92:95], v239, s[12:15], s28 offen offset:1024 sc1
  s_branch L_back_54
L_slow_55:
  s_add_u32 s58, s58, 1
  s_cmp_ge_u32 s58, 262144
  s_cbranch_scc1 L_refresh_93
  buffer_load_dwordx4 v[112:115], v181, s[12:15], s1 offen offset:2048 sc1
  buffer_load_dwordx4 v[116:119], v239, s[12:15], s1 offen offset:2048 sc1
  s_waitcnt vmcnt(0)
  v_bitop3_b32 v168, v112, v116, v216 bitop3:0x7e
  v_bitop3_b32 v169, v113, v117, v217 bitop3:0x7e
  v_bitop3_b32 v170, v114, v118, v218 bitop3:0x7e
  v_bitop3_b32 v171, v115, v119, v219 bitop3:0x7e
  v_or3_b32 v168, v168, v169, v170
  v_bitop3_b32 v168, v168, v171, s37 bitop3:0xa8
  v_cmp_ne_u32 s[30:31], 0, v168
  s_nop 0
  s_cmp_lg_u64 s[30:31], 0
  s_cbranch_scc1 L_slow_55
L_refresh_93:
  buffer_load_dwordx4 v[120:123], v181, s[12:15], s1 offen offset:3072 sc1
  buffer_load_dwordx4 v[124:127], v239, s[12:15], s1 offen offset:3072 sc1
  buffer_load_dwordx2 v[254:255], v235, s[12:15], 0 offen sc1
  buffer_load_dwordx4 v[64:67], v181, s[12:15], s0 offen offset:0 sc1
  buffer_load_dwordx4 v[68:71], v239, s[12:15], s0 offen offset:0 sc1
  buffer_load_dwordx4 v[72:75], v181, s[12:15], s0 offen offset:1024 sc1
  buffer_load_dwordx4 v[76:79], v239, s[12:15], s0 offen offset:1024 sc1
  buffer_load_dwordx4 v[80:83], v181, s[12:15], s28 offen offset:0 sc1
  buffer_load_dwordx4 v[84:87], v239, s[12:15], s28 offen offset:0 sc1
  buffer_load_dwordx4 v[88:91], v181, s[12:15], s28 offen offset:1024 sc1
  buffer_load_dwordx4 v[92:95], v239, s[12:15], s28 offen offset:1024 sc1
  buffer_load_dwordx4 v[96:99], v181, s[12:15], s26 offen offset:0 sc1
  buffer_load_dwordx4 v[100:103], v239, s[12:15], s26 offen offset:0 sc1
  s_branch L_back_56
L_slow_59:
  s_add_u32 s58, s58, 1
  s_cmp_ge_u32 s58, 262144
  s_cbranch_scc1 L_refresh_94
  buffer_load_dwordx4 v[120:123], v181, s[12:15], s1 offen offset:3072 sc1
  buffer_load_dwordx4 v[124:127], v239, s[12:15], s1 offen offset:3072 sc1
  s_waitcnt vmcnt(0)
  v_bitop3_b32 v168, v120, v124, v216 bitop3:0x7e
  v_bitop3_b32 v169, v121, v125, v217 bitop3:0x7e
  v_bitop3_b32 v170, v122, v126, v218 bitop3:0x7e
  v_bitop3_b32 v171, v123, v127, v219 bitop3:0x7e
  v_or3_b32 v168, v168, v169, v170
  v_bitop3_b32 v168, v168, v171, s37 bitop3:0xa8
  v_cmp_ne_u32 s[30:31], 0, v168
  s_nop 0
  s_cmp_lg_u64 s[30:31], 0
  s_cbranch_scc1 L_slow_59
L_refresh_94:
  buffer_load_dwordx2 v[254:255], v235, s[12:15], 0 offen sc1
  buffer_load_dwordx4 v[64:67], v181, s[12:15], s0 offen offset:0 sc1
  buffer_load_dwordx4 v[68:71], v239, s[12:15], s0 offen offset:0 sc1
  buffer_load_dwordx4 v[72:75], v181, s[12:15], s0 offen offset:1024 sc1
  buffer_load_dwordx4 v[76:79], v239, s[12:15], s0 offen offset:1024 sc1
  buffer_load_dwordx4 v[80:83], v181, s[12:15], s28 offen offset:0 sc1
  buffer_load_dwordx4 v[84:87], v239, s[12:15], s28 offen offset:0 sc1
  buffer_load_dwordx4 v[88:91], v181, s[12:15], s28 offen offset:1024 sc1
  buffer_load_dwordx4 v[92:95], v239, s[12:15], s28 offen offset:1024 sc1
  buffer_load_dwordx4 v[96:99], v181, s[12:15], s26 offen offset:0 sc1
  buffer_load_dwordx4 v[100:103], v239, s[12:15], s26 offen offset:0 sc1
  buffer_load_dwordx4 v[104:107], v181, s[12:15], s27 offen offset:0 sc1
  buffer_load_dwordx4 v[108:111], v239, s[12:15], s27 offen offset:0 sc1
  s_branch L_back_60
L_slow_61:
  s_add_u32 s58, s58, 1
  s_cmp_ge_u32 s58, 262144
  s_cbranch_scc1 L_refresh_95
  buffer_load_dwordx4 v[64:67], v181, s[12:15], s0 offen offset:0 sc1
  buffer_load_dwordx4 v[68:71], v239, s[12:15], s0 offen offset:0 sc1
  s_waitcnt vmcnt(0)
  v_bitop3_b32 v168, v64, v68, v216 bitop3:0x7e
  v_bitop3_b32 v169, v65, v69, v217 bitop3:0x7e
  v_bitop3_b32 v170, v66, v70, v218 bitop3:0x7e
  v_bitop3_b32 v171, v67, v71, v219 bitop3:0x7e
  v_or3_b32 v168, v168, v169, v170
  v_bitop3_b32 v168, v168, v171, s37 bitop3:0xa8
  v_cmp_ne_u32 s[30:31], 0, v168
  s_nop 0
  s_cmp_lg_u64 s[30:31], 0
  s_cbranch_scc1 L_slow_61
L_refresh_95:
  buffer_load_dwordx4 v[72:75], v181, s[12:15], s0 offen offset:1024 sc1
  buffer_load_dwordx4 v[76:79], v239, s[12:15], s0 offen offset:1024 sc1
  buffer_load_dwordx4 v[80:83], v181, s[12:15], s28 offen offset:0 sc1
  buffer_load_dwordx4 v[84:87], v239, s[12:15], s28 offen offset:0 sc1
  buffer_load_dwordx4 v[88:91], v181, s[12:15], s28 offen offset:1024 sc1
  buffer_load_dwordx4 v[92:95], v239, s[12:15], s28 offen offset:1024 sc1
  buffer_load_dwordx4 v[96:99], v181, s[12:15], s26 offen offset:0 sc1
  buffer_load_dwordx4 v[100:103], v239, s[12:15], s26 offen offset:0 sc1
  buffer_load_dwordx4 v[104:107], v181, s[12:15], s27 offen offset:0 sc1
  buffer_load_dwordx4 v[108:111], v239, s[12:15], s27 offen offset:0 sc1
  buffer_load_dwordx4 v[112:115], v181, s[12:15], s25 offen offset:0 sc1
  buffer_load_dwordx4 v[116:119], v239, s[12:15], s25 offen offset:0 sc1
  s_branch L_back_62
L_slow_63:
  s_add_u32 s58, s58, 1
  s_cmp_ge_u32 s58, 262144
  s_cbranch_scc1 L_refresh_96
  buffer_load_dwordx4 v[72:75], v181, s[12:15], s0 offen offset:1024 sc1
  buffer_load_dwordx4 v[76:79], v239, s[12:15], s0 offen offset:1024 sc1
  s_waitcnt vmcnt(0)
  v_bitop3_b32 v168, v72, v76, v216 bitop3:0x7e
  v_bitop3_b32 v169, v73, v77, v217 bitop3:0x7e
  v_bitop3_b32 v170, v74, v78, v218 bitop3:0x7e
  v_bitop3_b32 v171, v75, v79, v219 bitop3:0x7e
  v_or3_b32 v168, v168, v169, v170
  v_bitop3_b32 v168, v168, v171, s37 bitop3:0xa8
  v_cmp_ne_u32 s[30:31], 0, v168
  s_nop 0
  s_cmp_lg_u64 s[30:31], 0
  s_cbranch_scc1 L_slow_63
L_refresh_96:
  buffer_load_dwordx4 v[80:83], v181, s[12:15], s28 offen offset:0 sc1
  buffer_load_dwordx4 v[84:87], v239, s[12:15], s28 offen offset:0 sc1
  buffer_load_dwordx4 v[88:91], v181, s[12:15], s28 offen offset:1024 sc1
  buffer_load_dwordx4 v[92:95], v239, s[12:15], s28 offen offset:1024 sc1
  buffer_load_dwordx4 v[96:99], v181, s[12:15], s26 offen offset:0 sc1
  buffer_load_dwordx4 v[100:103], v239, s[12:15], s26 offen offset:0 sc1
  buffer_load_dwordx4 v[104:107], v181, s[12:15], s27 offen offset:0 sc1
  buffer_load_dwordx4 v[108:111], v239, s[12:15], s27 offen offset:0 sc1
  buffer_load_dwordx4 v[112:115], v181, s[12:15], s25 offen offset:0 sc1
  buffer_load_dwordx4 v[116:119], v239, s[12:15], s25 offen offset:0 sc1
  buffer_load_dwordx4 v[120:123], v181, s[12:15], s25 offen offset:1024 sc1
  buffer_load_dwordx4 v[124:127], v239, s[12:15], s25 offen offset:1024 sc1
  s_branch L_back_64
L_slow_65:
  s_add_u32 s58, s58, 1
  s_cmp_ge_u32 s58, 262144
  s_cbranch_scc1 L_refresh_97
  buffer_load_dwordx4 v[80:83], v181, s[12:15], s28 offen offset:0 sc1
  buffer_load_dwordx4 v[84:87], v239, s[12:15], s28 offen offset:0 sc1
  s_waitcnt vmcnt(0)
  v_bitop3_b32 v168, v80, v84, v216 bitop3:0x7e
  v_bitop3_b32 v169, v81, v85, v217 bitop3:0x7e
  v_bitop3_b32 v170, v82, v86, v218 bitop3:0x7e
  v_bitop3_b32 v171, v83, v87, v219 bitop3:0x7e
  v_or3_b32 v168, v168, v169, v170
  v_bitop3_b32 v168, v168, v171, s37 bitop3:0xa8
  v_cmp_ne_u32 s[30:31], 0, v168
  s_nop 0
  s_cmp_lg_u64 s[30:31], 0
  s_cbranch_scc1 L_slow_65
L_refresh_97:
  buffer_load_dwordx4 v[88:91], v181, s[12:15], s28 offen offset:1024 sc1
  buffer_load_dwordx4 v[92:95], v239, s[12:15], s28 offen offset:1024 sc1
  buffer_load_dwordx4 v[96:99], v181, s[12:15], s26 offen offset:0 sc1
  buffer_load_dwordx4 v[100:103], v239, s[12:15], s26 offen offset:0 sc1
  buffer_load_dwordx4 v[104:107], v181, s[12:15], s27 offen offset:0 sc1
  buffer_load_dwordx4 v[108:111], v239, s[12:15], s27 offen offset:0 sc1
  buffer_load_dwordx4 v[112:115], v181, s[12:15], s25 offen offset:0 sc1
  buffer_load_dwordx4 v[116:119], v239, s[12:15], s25 offen offset:0 sc1
  buffer_load_dwordx4 v[120:123], v181, s[12:15], s25 offen offset:1024 sc1
  buffer_load_dwordx4 v[124:127], v239, s[12:15], s25 offen offset:1024 sc1
  buffer_load_dwordx4 v[64:67], v239, s[12:15], s25 offen offset:2048 sc1
  buffer_load_dwordx4 v[68:71], v239, s[12:15], s25 offen offset:3072 sc1
  s_branch L_back_66
L_slow_67:
  s_add_u32 s58, s58, 1
  s_cmp_ge_u32 s58, 262144
  s_cbranch_scc1 L_refresh_98
  buffer_load_dwordx4 v[88:91], v181, s[12:15], s28 offen offset:1024 sc1
  buffer_load_dwordx4 v[92:95], v239, s[12:15], s28 offen offset:1024 sc1
  s_waitcnt vmcnt(0)
  v_bitop3_b32 v168, v88, v92, v216 bitop3:0x7e
  v_bitop3_b32 v169, v89, v93, v217 bitop3:0x7e
  v_bitop3_b32 v170, v90, v94, v218 bitop3:0x7e
  v_bitop3_b32 v171, v91, v95, v219 bitop3:0x7e
  v_or3_b32 v168, v168, v169, v170
  v_bitop3_b32 v168, v168, v171, s37 bitop3:0xa8
  v_cmp_ne_u32 s[30:31], 0, v168
  s_nop 0
  s_cmp_lg_u64 s[30:31], 0
  s_cbranch_scc1 L_slow_67
L_refresh_98:
  buffer_load_dwordx4 v[96:99], v181, s[12:15], s26 offen offset:0 sc1
  buffer_load_dwordx4 v[100:103], v239, s[12:15], s26 offen offset:0 sc1
  buffer_load_dwordx4 v[104:107], v181, s[12:15], s27 offen offset:0 sc1
  buffer_load_dwordx4 v[108:111], v239, s[12:15], s27 offen offset:0 sc1
  buffer_load_dwordx4 v[112:115], v181, s[12:15], s25 offen offset:0 sc1
  buffer_load_dwordx4 v[116:119], v239, s[12:15], s25 offen offset:0 sc1
  buffer_load_dwordx4 v[120:123], v181, s[12:15], s25 offen offset:1024 sc1
  buffer_load_dwordx4 v[124:127], v239, s[12:15], s25 offen offset:1024 sc1
  buffer_load_dwordx4 v[64:67], v239, s[12:15], s25 offen offset:2048 sc1
  buffer_load_dwordx4 v[68:71], v239, s[12:15], s25 offen offset:3072 sc1
  buffer_load_dwordx4 v[72:75], v239, s[12:15], s33 offen offset:0 sc1
  buffer_load_dwordx4 v[76:79], v239, s[12:15], s33 offen offset:1024 sc1
  s_branch L_back_68
L_slow_69:
  s_add_u32 s58, s58, 1
  s_cmp_ge_u32 s58, 262144
  s_cbranch_scc1 L_refresh_99
  buffer_load_dwordx4 v[96:99], v181, s[12:15], s26 offen offset:0 sc1
  buffer_load_dwordx4 v[100:103], v239, s[12:15], s26 offen offset:0 sc1
  s_waitcnt vmcnt(0)
  v_bitop3_b32 v168, v96, v100, v216 bitop3:0x7e
  v_bitop3_b32 v169, v97, v101, v217 bitop3:0x7e
  v_bitop3_b32 v170, v98, v102, v218 bitop3:0x7e
  v_bitop3_b32 v171, v99, v103, v219 bitop3:0x7e
  v_or3_b32 v168, v168, v169, v170
  v_bitop3_b32 v168, v168, v171, s37 bitop3:0xa8
  v_cmp_ne_u32 s[30:31], 0, v168
  s_nop 0
  s_cmp_lg_u64 s[30:31], 0
  s_cbranch_scc1 L_slow_69
L_refresh_99:
  buffer_load_dwordx4 v[104:107], v181, s[12:15], s27 offen offset:0 sc1
  buffer_load_dwordx4 v[108:111], v239, s[12:15], s27 offen offset:0 sc1
  buffer_load_dwordx4 v[112:115], v181, s[12:15], s25 offen offset:0 sc1
  buffer_load_dwordx4 v[116:119], v239, s[12:15], s25 offen offset:0 sc1
  buffer_load_dwordx4 v[120:123], v181, s[12:15], s25 offen offset:1024 sc1
  buffer_load_dwordx4 v[124:127], v239, s[12:15], s25 offen offset:1024 sc1
  buffer_load_dwordx4 v[64:67], v239, s[12:15], s25 offen offset:2048 sc1
  buffer_load_dwordx4 v[68:71], v239, s[12:15], s25 offen offset:3072 sc1
  buffer_load_dwordx4 v[72:75], v239, s[12:15], s33 offen offset:0 sc1
  buffer_load_dwordx4 v[76:79], v239, s[12:15], s33 offen offset:1024 sc1
  buffer_load_dwordx4 v[80:83], v239, s[12:15], s33 offen offset:2048 sc1
  buffer_load_dwordx4 v[84:87], v239, s[12:15], s33 offen offset:3072 sc1
  s_branch L_back_70
L_slow_71:
  s_add_u32 s58, s58, 1
  s_cmp_ge_u32 s58, 262144
  s_cbranch_scc1 L_refresh_100
  buffer_load_dwordx4 v[104:107], v181, s[12:15], s27 offen offset:0 sc1
  buffer_load_dwordx4 v[108:111], v239, s[12:15], s27 offen offset:0 sc1
  s_waitcnt vmcnt(0)
  v_bitop3_b32 v168, v104, v108, v216 bitop3:0x7e
  v_bitop3_b32 v169, v105, v109, v217 bitop3:0x7e
  v_bitop3_b32 v170, v106, v110, v218 bitop3:0x7e
  v_bitop3_b32 v171, v107, v111, v219 bitop3:0x7e
  v_or3_b32 v168, v168, v169, v170
  v_bitop3_b32 v168, v168, v171, s37 bitop3:0xa8
  v_cmp_ne_u32 s[30:31], 0, v168
  s_nop 0
  s_cmp_lg_u64 s[30:31], 0
  s_cbranch_scc1 L_slow_71
L_refresh_100:
  buffer_load_dwordx4 v[112:115], v181, s[12:15], s25 offen offset:0 sc1
  buffer_load_dwordx4 v[116:119], v239, s[12:15], s25 offen offset:0 sc1
  buffer_load_dwordx4 v[120:123], v181, s[12:15], s25 offen offset:1024 sc1
  buffer_load_dwordx4 v[124:127], v239, s[12:15], s25 offen offset:1024 sc1
  buffer_load_dwordx4 v[64:67], v239, s[12:15], s25 offen offset:2048 sc1
  buffer_load_dwordx4 v[68:71], v239, s[12:15], s25 offen offset:3072 sc1
  buffer_load_dwordx4 v[72:75], v239, s[12:15], s33 offen offset:0 sc1
  buffer_load_dwordx4 v[76:79], v239, s[12:15], s33 offen offset:1024 sc1
  buffer_load_dwordx4 v[80:83], v239, s[12:15], s33 offen offset:2048 sc1
  buffer_load_dwordx4 v[84:87], v239, s[12:15], s33 offen offset:3072 sc1
  buffer_load_dwordx4 v[88:91], v181, s[12:15], s25 offen offset:2048 sc1
  buffer_load_dwordx4 v[92:95], v181, s[12:15], s25 offen offset:3072 sc1
  s_branch L_back_72

.section .rodata,"a"
.p2align 6
.amdhsa_kernel parallel_sum__sliding_local_dilated__dense_activation_relu__prompt_kernel
  .amdhsa_next_free_vgpr 512
  .amdhsa_next_free_sgpr 102
  .amdhsa_accum_offset 256
  .amdhsa_group_segment_fixed_size 0
  .amdhsa_kernarg_size 72
  .amdhsa_user_sgpr_count 2
  .amdhsa_user_sgpr_kernarg_segment_ptr 1
  .amdhsa_system_sgpr_workgroup_id_x 1
.end_amdhsa_kernel
```
